```python
import torch

def _softmax(x, axis=-1):
    return torch.softmax(x, dim=axis)
def _gelu(x):
    return torch.nn.functional.gelu(x, approximate="tanh")
def _silu(x):
    return torch.nn.functional.silu(x)
def _sigmoid(x):
    return torch.sigmoid(x)
def _layernorm(x, axis=-1, eps=1e-5):
    m = x.mean(dim=axis, keepdim=True)
    v = x.var(dim=axis, keepdim=True, unbiased=False)
    return (x - m) / torch.sqrt(v + eps)
def _scatter_add(tgt, idx, src, axis=0):
    return tgt.clone().index_add_(axis, idx, src)
def _segment_sum(src, seg, n):
    out = torch.zeros((n,) + src.shape[1:], dtype=src.dtype)
    return out.index_add_(0, seg, src)
def _pad(x, pw):
    flat = tuple(v for pair in reversed(pw) for v in pair)
    return torch.nn.functional.pad(x, flat)

kernel_name = 'parallel_sum__sliding_block__glu_gated_geglu__prompt'

def setup_inputs():

    _w = (lambda a: (lambda t: t.to(torch.bfloat16) if t.is_floating_point() else t)(torch.as_tensor(a)))
    def _A_setup():
        B, S, D = 1, 2048, 640
        return {
            "x": _w((lambda *s: torch.randn(*s, dtype=torch.bfloat16) * 0.05)(B, S, D)),
            "wqkv": _w((lambda *s: torch.randn(*s, dtype=torch.bfloat16) * 0.05)(D, 3 * D)),
            "wo": _w((lambda *s: torch.randn(*s, dtype=torch.bfloat16) * 0.05)(D, D)),
        }
    _A_in = _A_setup()

    def _B_setup():
        B, S, Dm, Df = 1, 2048, 640, 1536
        return {
            "x": _w((lambda *s: torch.randn(*s, dtype=torch.bfloat16) * 0.05)(B, S, Dm)),
            "w_gate": _w((lambda *s: torch.randn(*s, dtype=torch.bfloat16) * 0.8)(Dm, Df) * (Dm ** -0.5)),
            "w_up": _w((lambda *s: torch.randn(*s, dtype=torch.bfloat16) * 0.8)(Dm, Df) * (Dm ** -0.5)),
            "w_down": _w((lambda *s: torch.randn(*s, dtype=torch.bfloat16) * 0.8)(Df, Dm) * (Df ** -0.5)),
        }
    _B_in = _B_setup()

    return {
        "A_x": _A_in["x"],
        "A_wqkv": _A_in["wqkv"],
        "A_wo": _A_in["wo"],
        "B_x": _B_in["x"],
        "B_w_gate": _B_in["w_gate"],
        "B_w_up": _B_in["w_up"],
        "B_w_down": _B_in["w_down"],
    }

def reference(A_x, A_wqkv, A_wo, B_x, B_w_gate, B_w_up, B_w_down):
    def _A_ref(x, wqkv, wo):
        B, S, D = x.shape
        H = 32; Dh = D // H; W = 256
        qkv = (lambda x, *d: x.permute(*d))((x @ wqkv).reshape(B, S, 3, H, Dh), 2, 0, 3, 1, 4)
        q, k, v = qkv[0], qkv[1], qkv[2]
        scores = torch.einsum("bhqd,bhkd->bhqk", q, k) * (Dh ** -0.5)
        idx = torch.arange(S)
        mask = (idx[:, None] - idx[None, :] >= 0) & (idx[:, None] - idx[None, :] < W)
        scores = torch.where(mask[None, None], scores, -1e9)
        p = _softmax(scores, axis=-1)
        o = torch.einsum("bhqk,bhkd->bhqd", p, v)
        return (lambda x, *d: x.permute(*d))(o, 0, 2, 1, 3).reshape(B, S, D) @ wo

    def _B_ref(x, w_gate, w_up, w_down):
        g = torch.einsum("bsd,df->bsf", x, w_gate)
        u = torch.einsum("bsd,df->bsf", x, w_up)
        h = _gelu(g) * u
        return torch.einsum("bsf,fd->bsd", h, w_down)

    x = A_x
    xn = _layernorm(x, axis=-1)
    return x + _A_ref(xn, A_wqkv, A_wo) + _B_ref(xn, B_w_gate, B_w_up, B_w_down)
```

```asm
; @launch grid=(256,1,1) block=(256,1,1) lds=163840
.amdgcn_target "amdgcn-amd-amdhsa--gfx950"
.text
.globl parallel_sum__sliding_block__glu_gated_geglu__prompt_kernel
.p2align 8
.type parallel_sum__sliding_block__glu_gated_geglu__prompt_kernel,@function
parallel_sum__sliding_block__glu_gated_geglu__prompt_kernel:
L_top:
  s_cmp_ge_u32 s2, 256
  s_cbranch_scc1 L_end
  s_load_dwordx2 s[4:5], s[0:1], 0
  s_load_dwordx4 s[84:87], s[0:1], 64
  s_load_dwordx4 s[72:75], s[0:1], 8
  s_load_dwordx4 s[76:79], s[0:1], 32
  s_load_dwordx4 s[80:83], s[0:1], 48
  s_memrealtime s[90:91]
  s_getpc_b64 s[88:89]
  v_lshrrev_b32 v64, 3, v0
  v_lshlrev_b32 v64, 7, v64
  global_load_dword v157, v64, s[88:89]
  s_lshr_b32 s58, s2, 3
  s_mul_i32 s58, s58, 12
  s_add_u32 s58, s58, 32
  v_mul_u32_u24 v64, 3, v0
  v_lshrrev_b32 v64, 6, v64
  v_add_u32 v64, s58, v64
  v_lshlrev_b32 v64, 7, v64
  v_min_u32 v64, L_end-L_top-64, v64
  global_load_dword v158, v64, s[88:89]
  v_and_b32 v14, 63, v0
  v_lshrrev_b32 v64, 6, v0
  s_nop 0
  v_readfirstlane_b32 s3, v64
  v_lshlrev_b32 v17, 4, v14
  s_and_b32 s61, s2, 7
  s_lshr_b32 s62, s2, 3
  s_lshr_b32 s63, s61, 2
  s_and_b32 s64, s61, 3
  s_lshr_b32 s65, s62, 2
  s_and_b32 s66, s62, 3
  s_lshl_b32 s58, s63, 3
  s_add_u32 s65, s65, s58
  s_lshr_b32 s68, s3, 1
  v_lshrrev_b32 v65, 4, v14
  v_and_b32 v66, 15, v14
  v_mul_u32_u24 v67, 1280, v65
  v_lshl_add_u32 v67, v66, 4, v67
  s_and_b32 s67, s3, 1
  s_cmp_eq_u32 s67, 0
  v_mov_b32 v68, 0
  s_waitcnt lgkmcnt(0)
  s_mov_b32 s36, s84
  s_mov_b32 s37, s85
  s_mov_b32 s38, 0x100
  s_mov_b32 s39, 0x20000
  s_cbranch_scc0 L_wsetup
  s_lshl_b32 s58, s65, 4
  s_lshl_b32 s59, s64, 2
  s_add_u32 s58, s58, s59
  s_add_u32 s58, s58, s66
  s_lshl_b32 s58, s58, 1
  s_add_u32 s58, s58, s68
  s_mul_i32 s69, s58, 5120
  s_waitcnt lgkmcnt(0)
  s_mov_b32 s32, s4
  s_mov_b32 s33, s5
  s_mov_b32 s34, 0x280000
  s_mov_b32 s35, 0x20000
  buffer_load_dwordx4 v[70:73], v67, s[32:35], s69 offen offset:0
  buffer_load_dwordx4 v[74:77], v67, s[32:35], s69 offen offset:256
  buffer_load_dwordx4 v[78:81], v67, s[32:35], s69 offen offset:512
  buffer_load_dwordx4 v[82:85], v67, s[32:35], s69 offen offset:768
  buffer_load_dwordx4 v[86:89], v67, s[32:35], s69 offen offset:1024
  s_lshr_b32 s58, s2, 3
  s_or_b32 s58, s58, s3
  s_cbranch_scc1 L_noinit
  s_lshl_b32 s58, s90, 4
  s_or_b32 s58, s58, 8
  v_mov_b32 v154, s58
  v_mov_b32 v155, 0
  s_mov_b64 exec, 1
  buffer_atomic_cmpswap v[154:155], v68, s[36:39], 0 offen sc1
  s_mov_b64 exec, -1
L_noinit:
  s_add_u32 s16, s86, 0x10000
  s_addc_u32 s17, s87, 0
  s_mov_b32 s18, 0x280000
  s_mov_b32 s19, 0x20000
  s_mov_b32 s59, 0
  v_mov_b32 v156, 0x3f803f80
L_ln:
  v_mov_b32 v150, 0
  v_mov_b32 v151, 0
  v_mov_b32 v152, 0
  v_mov_b32 v153, 0
  v_dot2c_f32_bf16 v150, v70, v156
  v_dot2c_f32_bf16 v152, v70, v70
  v_dot2c_f32_bf16 v151, v71, v156
  v_dot2c_f32_bf16 v153, v71, v71
  v_dot2c_f32_bf16 v150, v72, v156
  v_dot2c_f32_bf16 v152, v72, v72
  v_dot2c_f32_bf16 v151, v73, v156
  v_dot2c_f32_bf16 v153, v73, v73
  v_dot2c_f32_bf16 v150, v74, v156
  v_dot2c_f32_bf16 v152, v74, v74
  v_dot2c_f32_bf16 v151, v75, v156
  v_dot2c_f32_bf16 v153, v75, v75
  v_dot2c_f32_bf16 v150, v76, v156
  v_dot2c_f32_bf16 v152, v76, v76
  v_dot2c_f32_bf16 v151, v77, v156
  v_dot2c_f32_bf16 v153, v77, v77
  v_dot2c_f32_bf16 v150, v78, v156
  v_dot2c_f32_bf16 v152, v78, v78
  v_dot2c_f32_bf16 v151, v79, v156
  v_dot2c_f32_bf16 v153, v79, v79
  v_dot2c_f32_bf16 v150, v80, v156
  v_dot2c_f32_bf16 v152, v80, v80
  v_dot2c_f32_bf16 v151, v81, v156
  v_dot2c_f32_bf16 v153, v81, v81
  v_dot2c_f32_bf16 v150, v82, v156
  v_dot2c_f32_bf16 v152, v82, v82
  v_dot2c_f32_bf16 v151, v83, v156
  v_dot2c_f32_bf16 v153, v83, v83
  v_dot2c_f32_bf16 v150, v84, v156
  v_dot2c_f32_bf16 v152, v84, v84
  v_dot2c_f32_bf16 v151, v85, v156
  v_dot2c_f32_bf16 v153, v85, v85
  v_dot2c_f32_bf16 v150, v86, v156
  v_dot2c_f32_bf16 v152, v86, v86
  v_dot2c_f32_bf16 v151, v87, v156
  v_dot2c_f32_bf16 v153, v87, v87
  v_dot2c_f32_bf16 v150, v88, v156
  v_dot2c_f32_bf16 v152, v88, v88
  v_dot2c_f32_bf16 v151, v89, v156
  v_dot2c_f32_bf16 v153, v89, v89
  v_lshlrev_b32 v90, 16, v70
  v_and_b32 v91, 0xffff0000, v70
  v_lshlrev_b32 v92, 16, v71
  v_add_f32 v150, v150, v151
  v_add_f32 v152, v152, v153
  v_and_b32 v93, 0xffff0000, v71
  v_lshlrev_b32 v94, 16, v72
  v_add_f32_dpp v150, v150, v150 quad_perm:[1,0,3,2] row_mask:0xf bank_mask:0xf
  v_add_f32_dpp v152, v152, v152 quad_perm:[1,0,3,2] row_mask:0xf bank_mask:0xf
  v_and_b32 v95, 0xffff0000, v72
  v_add_f32_dpp v150, v150, v150 quad_perm:[2,3,0,1] row_mask:0xf bank_mask:0xf
  v_add_f32_dpp v152, v152, v152 quad_perm:[2,3,0,1] row_mask:0xf bank_mask:0xf
  v_lshlrev_b32 v96, 16, v73
  v_add_f32_dpp v150, v150, v150 row_half_mirror row_mask:0xf bank_mask:0xf
  v_add_f32_dpp v152, v152, v152 row_half_mirror row_mask:0xf bank_mask:0xf
  v_and_b32 v97, 0xffff0000, v73
  v_add_f32_dpp v150, v150, v150 row_mirror row_mask:0xf bank_mask:0xf
  v_add_f32_dpp v152, v152, v152 row_mirror row_mask:0xf bank_mask:0xf
  v_lshlrev_b32 v98, 16, v74
  v_mul_f32 v150, 0x3acccccd, v150
  v_mul_f32 v152, 0x3acccccd, v152
  v_fma_f32 v152, -v150, v150, v152
  v_and_b32 v99, 0xffff0000, v74
  v_max_f32 v152, 0, v152
  v_lshlrev_b32 v100, 16, v75
  v_cvt_pk_bf16_f32 v151, v150, v152
  v_and_b32 v101, 0xffff0000, v75
  v_lshlrev_b32 v150, 16, v151
  v_and_b32 v152, 0xffff0000, v151
  v_lshlrev_b32 v102, 16, v76
  v_add_f32 v152, 0x3727c5ac, v152
  v_and_b32 v103, 0xffff0000, v76
  v_cvt_pk_bf16_f32 v152, v152, v152
  v_lshlrev_b32 v104, 16, v77
  v_and_b32 v152, 0xffff0000, v152
  v_and_b32 v105, 0xffff0000, v77
  v_sqrt_f32 v152, v152
  v_lshlrev_b32 v106, 16, v78
  v_and_b32 v107, 0xffff0000, v78
  v_cvt_pk_bf16_f32 v152, v152, v152
  v_lshlrev_b32 v108, 16, v79
  v_and_b32 v152, 0xffff0000, v152
  v_and_b32 v109, 0xffff0000, v79
  v_rcp_f32 v152, v152
  v_lshlrev_b32 v110, 16, v80
  v_and_b32 v111, 0xffff0000, v80
  v_mul_f32 v152, 0x3eeff558, v152
  v_lshlrev_b32 v112, 16, v81
  v_mul_f32 v153, -v150, v152
  v_and_b32 v113, 0xffff0000, v81
  v_lshlrev_b32 v114, 16, v82
  v_and_b32 v115, 0xffff0000, v82
  v_lshlrev_b32 v116, 16, v83
  v_and_b32 v117, 0xffff0000, v83
  v_lshlrev_b32 v118, 16, v84
  v_and_b32 v119, 0xffff0000, v84
  v_lshlrev_b32 v120, 16, v85
  v_and_b32 v121, 0xffff0000, v85
  v_lshlrev_b32 v122, 16, v86
  v_and_b32 v123, 0xffff0000, v86
  v_lshlrev_b32 v124, 16, v87
  v_and_b32 v125, 0xffff0000, v87
  v_lshlrev_b32 v126, 16, v88
  v_and_b32 v127, 0xffff0000, v88
  v_lshlrev_b32 v128, 16, v89
  v_and_b32 v129, 0xffff0000, v89
  v_pk_fma_f32 v[90:91], v[90:91], v[152:153], v[152:153] op_sel:[0,0,1] op_sel_hi:[1,0,1]
  v_pk_fma_f32 v[92:93], v[92:93], v[152:153], v[152:153] op_sel:[0,0,1] op_sel_hi:[1,0,1]
  v_pk_fma_f32 v[94:95], v[94:95], v[152:153], v[152:153] op_sel:[0,0,1] op_sel_hi:[1,0,1]
  v_pk_fma_f32 v[96:97], v[96:97], v[152:153], v[152:153] op_sel:[0,0,1] op_sel_hi:[1,0,1]
  v_pk_fma_f32 v[98:99], v[98:99], v[152:153], v[152:153] op_sel:[0,0,1] op_sel_hi:[1,0,1]
  v_pk_fma_f32 v[100:101], v[100:101], v[152:153], v[152:153] op_sel:[0,0,1] op_sel_hi:[1,0,1]
  v_pk_fma_f32 v[102:103], v[102:103], v[152:153], v[152:153] op_sel:[0,0,1] op_sel_hi:[1,0,1]
  v_pk_fma_f32 v[104:105], v[104:105], v[152:153], v[152:153] op_sel:[0,0,1] op_sel_hi:[1,0,1]
  v_pk_fma_f32 v[106:107], v[106:107], v[152:153], v[152:153] op_sel:[0,0,1] op_sel_hi:[1,0,1]
  v_pk_fma_f32 v[108:109], v[108:109], v[152:153], v[152:153] op_sel:[0,0,1] op_sel_hi:[1,0,1]
  v_pk_fma_f32 v[110:111], v[110:111], v[152:153], v[152:153] op_sel:[0,0,1] op_sel_hi:[1,0,1]
  v_pk_fma_f32 v[112:113], v[112:113], v[152:153], v[152:153] op_sel:[0,0,1] op_sel_hi:[1,0,1]
  v_pk_fma_f32 v[114:115], v[114:115], v[152:153], v[152:153] op_sel:[0,0,1] op_sel_hi:[1,0,1]
  v_pk_fma_f32 v[116:117], v[116:117], v[152:153], v[152:153] op_sel:[0,0,1] op_sel_hi:[1,0,1]
  v_pk_fma_f32 v[118:119], v[118:119], v[152:153], v[152:153] op_sel:[0,0,1] op_sel_hi:[1,0,1]
  v_pk_fma_f32 v[120:121], v[120:121], v[152:153], v[152:153] op_sel:[0,0,1] op_sel_hi:[1,0,1]
  v_pk_fma_f32 v[122:123], v[122:123], v[152:153], v[152:153] op_sel:[0,0,1] op_sel_hi:[1,0,1]
  v_pk_fma_f32 v[124:125], v[124:125], v[152:153], v[152:153] op_sel:[0,0,1] op_sel_hi:[1,0,1]
  v_pk_fma_f32 v[126:127], v[126:127], v[152:153], v[152:153] op_sel:[0,0,1] op_sel_hi:[1,0,1]
  v_pk_fma_f32 v[128:129], v[128:129], v[152:153], v[152:153] op_sel:[0,0,1] op_sel_hi:[1,0,1]
  v_cvt_pk_bf16_f32 v130, v90, v91
  v_cvt_pk_bf16_f32 v131, v92, v93
  v_cvt_pk_bf16_f32 v132, v94, v95
  v_cvt_pk_bf16_f32 v133, v96, v97
  v_cvt_pk_bf16_f32 v134, v98, v99
  v_cvt_pk_bf16_f32 v135, v100, v101
  v_cvt_pk_bf16_f32 v136, v102, v103
  v_cvt_pk_bf16_f32 v137, v104, v105
  v_cvt_pk_bf16_f32 v138, v106, v107
  v_cvt_pk_bf16_f32 v139, v108, v109
  v_cvt_pk_bf16_f32 v140, v110, v111
  v_cvt_pk_bf16_f32 v141, v112, v113
  v_cvt_pk_bf16_f32 v142, v114, v115
  v_cvt_pk_bf16_f32 v143, v116, v117
  v_cvt_pk_bf16_f32 v144, v118, v119
  v_cvt_pk_bf16_f32 v145, v120, v121
  v_cvt_pk_bf16_f32 v146, v122, v123
  v_cvt_pk_bf16_f32 v147, v124, v125
  v_cvt_pk_bf16_f32 v148, v126, v127
  v_cvt_pk_bf16_f32 v149, v128, v129
  s_cmp_lg_u32 s59, 0
  s_cbranch_scc1 L_lnst
  s_mov_b32 s59, 1
  s_waitcnt vmcnt(0)
  s_branch L_ln
L_lnst:
  buffer_store_dwordx4 v[130:133], v67, s[16:19], s69 offen offset:0 sc1
  buffer_store_dwordx4 v[134:137], v67, s[16:19], s69 offen offset:256 sc1
  buffer_store_dwordx4 v[138:141], v67, s[16:19], s69 offen offset:512 sc1
  buffer_store_dwordx4 v[142:145], v67, s[16:19], s69 offen offset:768 sc1
  buffer_store_dwordx4 v[146:149], v67, s[16:19], s69 offen offset:1024 sc1
  s_load_dword s85, s[36:37], 0
L_wsetup:
  s_lshr_b32 s57, s66, 1
  s_lshl_b32 s47, s3, 12
  s_bitcmp1_b32 s64, 0
  s_mov_b32 s88, 0xb0a0100
  s_mov_b32 s89, 0x16151402
  s_cselect_b32 s88, 0xd0c0403, s88
  s_cselect_b32 s89, 0xc8170e18, s89
  s_lshr_b32 s70, s64, 1
  s_mul_i32 s70, s70, 5
  s_mul_i32 s71, s66, 3
  s_sub_u32 s71, s71, 2
  s_cmp_eq_u32 s57, 0
  s_cselect_b32 s71, s66, s71
  s_add_u32 s58, s71, 6
  s_and_b32 s58, s58, 7
  s_lshl_b32 s58, s58, 3
  s_lshr_b64 s[90:91], s[88:89], s58
  s_and_b32 s52, s90, 0xff
  s_add_u32 s52, s52, s70
  s_add_u32 s58, s71, 7
  s_and_b32 s58, s58, 7
  s_lshl_b32 s58, s58, 3
  s_lshr_b64 s[90:91], s[88:89], s58
  s_and_b32 s53, s90, 0xff
  s_add_u32 s53, s53, s70
  s_add_u32 s58, s71, 0
  s_and_b32 s58, s58, 7
  s_lshl_b32 s58, s58, 3
  s_lshr_b64 s[90:91], s[88:89], s58
  s_and_b32 s54, s90, 0xff
  s_add_u32 s54, s54, s70
  s_mul_i32 s58, s64, 6
  s_lshl_b32 s55, s66, 1
  s_add_u32 s55, s55, s58
  s_add_u32 s56, s55, 1
  s_add_u32 s59, s58, s66
  s_add_u32 s59, s59, 2
  s_cmp_eq_u32 s57, 0
  s_cselect_b32 s56, s56, s59
  s_cmp_eq_u32 s68, 0
  s_cselect_b32 s28, s76, s78
  s_cselect_b32 s29, s77, s79
  s_mov_b32 s30, 1966080
  s_mov_b32 s31, 0x20000
  s_cselect_b32 s59, s52, s53
  s_mov_b32 s24, s72
  s_mov_b32 s25, s73
  s_mov_b32 s26, 0x258000
  s_mov_b32 s27, 0x20000
  s_cmp_eq_u32 s57, 0
  s_cselect_b32 s20, s28, s72
  s_cselect_b32 s21, s29, s73
  s_cselect_b32 s22, s30, s26
  s_mov_b32 s23, 0x20000
  s_movk_i32 s58, 3840
  s_cselect_b32 s48, 3072, s58
  s_cselect_b32 s59, s55, s59
  s_lshl_b32 s41, s59, 7
  s_lshl_b32 s42, s54, 7
  s_lshl_b32 s43, s56, 7
  s_cmp_lt_u32 s54, 30
  s_cselect_b32 s26, s26, 0
  s_mov_b64 s[6:7], s[86:87]
  s_mov_b64 s[92:93], s[82:83]
  s_mul_i32 s58, s65, 40
  v_min_u32 v70, 39, v14
  v_add_u32 v70, s58, v70
  v_mul_u32_u24 v100, s48, v70
  v_add_u32 v100, s41, v100
  s_mul_i32 s59, s68, 20
  s_add_u32 s58, s58, s59
  v_min_u32 v72, 19, v14
  v_add_u32 v72, s58, v72
  v_mul_u32_u24 v101, 3840, v72
  v_add_u32 v101, s42, v101
  v_mul_u32_u24 v102, 3072, v70
  v_add_u32 v102, s43, v102
  s_mul_i32 s58, s65, 40
  s_mul_i32 s59, s67, 20
  s_add_u32 s59, s59, s58
  v_min_u32 v72, 19, v14
  v_add_u32 v72, s59, v72
  v_mul_u32_u24 v186, 3072, v72
  v_add_u32 v186, s43, v186
  s_mul_i32 s59, s3, 10
  s_add_u32 s59, s59, s58
  v_min_u32 v72, 9, v14
  v_add_u32 v72, s59, v72
  v_mul_u32_u24 v185, 3840, v72
  v_add_u32 v185, s42, v185
  s_cmp_eq_u32 s67, 0
  s_cbranch_scc1 L_common
  buffer_load_dword v74, v100, s[20:23], 0 offen
  buffer_load_dword v75, v101, s[24:27], 0 offen
L_common:
  s_add_u32 s12, s6, 0x1700000
  s_addc_u32 s13, s7, 0
  s_mov_b32 s14, 0x70000
  s_mov_b32 s15, 0x20000
  v_cmp_gt_u32 vcc, 32, v0
  s_lshl_b32 s58, s2, 7
  v_lshl_add_u32 v70, v0, 2, s58
  v_bfrev_b32 v71, 1
  v_cndmask_b32 v13, v71, v70, vcc
  s_lshl_b32 s58, s3, 8
  s_add_u32 s58, s58, s2
  s_mul_hi_u32 s70, s58, 429496730
  s_mul_i32 s59, s70, 10
  s_sub_u32 s59, s58, s59
  s_mul_i32 s78, s70, 5
  s_lshl_b32 s79, s59, 2
  s_cmp_lt_u32 s70, 68
  s_cselect_b32 s78, s78, 0x100000
  s_cmp_lt_u32 s70, 48
  s_cselect_b32 s32, s80, s74
  s_cselect_b32 s33, s81, s75
  s_mov_b32 s88, 819200
  s_cselect_b32 s34, 1966080, s88
  s_mov_b32 s35, 0x20000
  s_cselect_b32 s88, 32, 40
  s_cselect_b32 s89, 0, 48
  s_cselect_b32 s90, 8, 20
  s_cselect_b32 s91, 16, 8
  s_cmp_lt_u32 s70, 64
  s_cselect_b32 s88, s88, 160
  s_cselect_b32 s89, s89, 64
  s_cselect_b32 s90, s90, 80
  s_cselect_b32 s91, s91, 20
  s_cselect_b32 s71, 4, 40
  s_cselect_b32 s58, 0, 16
  s_sub_u32 s70, s70, s89
  s_mul_i32 s70, s70, s88
  s_add_u32 s70, s70, s58
  s_mul_i32 s70, s70, 1280
  s_lshl_b32 s59, s59, 7
  s_add_u32 s80, s70, s59
  s_mulk_i32 s90, 1280
  s_mulk_i32 s71, 1280
  s_sub_u32 s71, s71, 1024
  s_sub_u32 s90, s90, 2048
  v_lshrrev_b32 v84, 5, v14
  v_mul_u32_u24 v84, s91, v84
  v_bfe_u32 v85, v14, 3, 2
  v_add_u32 v84, v84, v85
  v_mul_u32_u24 v84, 1280, v84
  v_and_b32 v85, 7, v14
  v_lshl_add_u32 v160, v85, 4, v84
  v_add_u32 v161, s71, v160
  v_add_u32 v162, s90, v160
  v_add_u32 v163, s90, v161
  s_add_u32 m0, s47, 49152
  s_nop 0
  buffer_load_dwordx4 v160, s[32:35], s80 offen offset:0 lds
  buffer_load_dwordx4 v161, s[32:35], s80 offen offset:1024 lds
  buffer_load_dwordx4 v162, s[32:35], s80 offen offset:2048 lds
  buffer_load_dwordx4 v163, s[32:35], s80 offen offset:3072 lds
  s_add_u32 s32, s6, 0x300000
  s_addc_u32 s33, s7, 0
  s_mov_b32 s34, 0x780000
  s_mov_b32 s35, 0x20000
  v_bfe_u32 v18, v14, 2, 3
  v_lshrrev_b32 v84, 5, v14
  v_and_b32 v85, 3, v14
  v_lshlrev_b32 v85, 4, v85
  v_lshl_add_u32 v19, v84, 6, v85
  s_lshl_b32 s44, s48, 6
  s_mov_b32 s45, 491520
  s_mov_b32 s46, 196608
  s_lshl_b32 s70, s67, 5
  s_mul_i32 s59, s70, s48
  s_add_u32 s41, s41, s59
  s_mul_i32 s59, s70, 3072
  s_add_u32 s43, s43, s59
  s_mul_i32 s59, s3, 122880
  s_add_u32 s42, s42, s59
  v_mul_u32_u24 v5, s48, v18
  s_lshl_b32 s58, s48, 3
  s_sub_u32 s58, s58, 1024
  v_add_u32 v5, v5, v19
  v_xor_b32 v6, 32, v5
  v_add_u32 v6, s58, v6
  s_lshl_b32 s58, s58, 1
  v_add_u32 v7, s58, v5
  v_add_u32 v8, s58, v6
  s_lshl_b32 s58, s65, 7
  s_lshl_b32 s59, s3, 5
  s_add_u32 s59, s59, s58
  s_mul_i32 s40, s59, 1280
  v_lshrrev_b32 v84, 3, v14
  v_and_b32 v85, 7, v14
  v_lshrrev_b32 v86, 1, v84
  v_xor_b32 v85, v85, v86
  v_mul_u32_u24 v84, 2560, v84
  v_lshl_add_u32 v130, v85, 4, v84
  v_xor_b32 v85, 4, v85
  v_lshl_add_u32 v131, v85, 4, v84
  v_add_u32 v131, 19456, v131
  v_add_u32 v132, 3328, v130
  v_add_u32 v133, 3328, v131
  v_add_u32 v130, 4096, v130
  v_add_u32 v131, 4096, v131
  s_add_u32 s16, s6, 0xf000
  s_addc_u32 s17, s7, 0
  s_mov_b32 s18, 0x281000
  s_mov_b32 s19, 0x20000
  s_and_b32 s58, s65, 7
  s_lshl_b32 s58, s58, 5
  s_lshl_b32 s59, s63, 2
  s_add_u32 s58, s58, s59
  s_add_u32 s58, s58, s3
  s_lshl_b32 s58, s58, 7
  s_add_u32 s0, s12, s58
  s_addc_u32 s1, s13, 0
  s_add_u32 s8, s6, 0x1400000
  s_addc_u32 s9, s7, 0
  s_mov_b32 s10, 0x2a8000
  s_mov_b32 s11, 0x20000
  v_lshlrev_b32 v1, 10, v65
  v_bfe_u32 v86, v14, 2, 2
  v_lshl_add_u32 v1, v86, 6, v1
  v_lshlrev_b32 v87, 10, v65
  v_lshl_add_u32 v87, v86, 7, v87
  v_bfe_u32 v86, v14, 4, 1
  v_lshl_add_u32 v1, v86, 5, v1
  v_and_b32 v86, 3, v14
  v_lshl_add_u32 v1, v86, 3, v1
  v_lshl_add_u32 v87, v86, 3, v87
  v_add_u32 v136, s47, v87
  s_lshl_b32 s58, s68, 9
  s_add_u32 s58, s58, 65536
  v_add_u32 v1, s58, v1
  v_xor_b32 v2, 32, v1
  v_add_u32 v3, 0x10000, v1
  v_add_u32 v4, 0x10000, v2
  v_lshrrev_b32 v86, 1, v66
  v_xor_b32 v86, v86, v65
  v_lshlrev_b32 v86, 4, v86
  v_lshl_add_u32 v128, v66, 7, v86
  s_lshl_b32 s58, s67, 13
  v_add_u32 v128, s58, v128
  v_xor_b32 v129, 64, v128
  v_lshlrev_b32 v86, 4, v66
  v_lshl_add_u32 v9, v65, 14, v86
  v_lshl_add_u32 v10, v65, 10, v86
  v_mov_b32 v11, 0xc09d30fc
  v_mov_b32 v12, 0x3e60ec05
  v_lshrrev_b32 v86, 5, v14
  v_lshlrev_b32 v86, 2, v86
  v_bfe_u32 v87, v14, 4, 1
  v_lshl_add_u32 v87, v66, 1, v87
  v_sub_u32 v86, v87, v86
  s_lshl_b32 s58, s67, 4
  v_subrev_u32 v86, s58, v86
  s_mov_b32 s59, 0xf149f2ca
  s_cmp_eq_u32 s68, 0
  s_cselect_b32 s70, s59, 0
  v_subrev_u32 v87, 0, v86
  v_ashrrev_i32 v87, 31, v87
  v_and_b32 v87, s59, v87
  v_xor_b32 v88, s70, v87
  v_subrev_u32 v87, 1, v86
  v_ashrrev_i32 v87, 31, v87
  v_and_b32 v87, s59, v87
  v_xor_b32 v89, s70, v87
  v_subrev_u32 v87, 2, v86
  v_ashrrev_i32 v87, 31, v87
  v_and_b32 v87, s59, v87
  v_xor_b32 v90, s70, v87
  v_subrev_u32 v87, 3, v86
  v_ashrrev_i32 v87, 31, v87
  v_and_b32 v87, s59, v87
  v_xor_b32 v91, s70, v87
  v_subrev_u32 v87, 8, v86
  v_ashrrev_i32 v87, 31, v87
  v_and_b32 v87, s59, v87
  v_xor_b32 v92, s70, v87
  v_subrev_u32 v87, 9, v86
  v_ashrrev_i32 v87, 31, v87
  v_and_b32 v87, s59, v87
  v_xor_b32 v93, s70, v87
  v_subrev_u32 v87, 10, v86
  v_ashrrev_i32 v87, 31, v87
  v_and_b32 v87, s59, v87
  v_xor_b32 v94, s70, v87
  v_subrev_u32 v87, 11, v86
  v_ashrrev_i32 v87, 31, v87
  v_and_b32 v87, s59, v87
  v_xor_b32 v95, s70, v87
  s_lshl_b32 s58, s3, 11
  s_add_u32 s58, s58, 147456
  v_add_u32 v86, s58, v17
  ds_write_b128 v86, v[88:91]
  ds_write_b128 v86, v[92:95] offset:1024
  s_waitcnt lgkmcnt(0)
  s_cmp_eq_u32 s67, 0
  s_cbranch_scc0 L_odd
  v_mov_b32 v15, s85
  v_cmp_ne_u32 vcc, 0, v15
  s_nop 0
  s_cmp_eq_u64 vcc, -1
  s_cbranch_scc0 L_slow0
L_back0:
  v_add_u32 v70, 1, v15
  v_readfirstlane_b32 s85, v15
  v_cmp_gt_u32 vcc, 32, v14
  s_lshl_b32 s58, s2, 7
  s_lshl_b32 s59, s3, 15
  s_add_u32 s58, s58, s59
  v_lshl_add_u32 v72, v14, 2, s58
  v_bfrev_b32 v71, 1
  v_cndmask_b32 v71, v71, v72, vcc
  s_waitcnt vmcnt(4)
  buffer_store_dword v70, v71, s[12:15], 0 offen sc1
  s_branch L_after
L_odd:
  s_mov_b32 s86, 1
  s_mov_b64 exec, 0
  s_cmp_eq_u32 s68, 0
  s_cbranch_scc1 L_pad0
  s_branch L_pad1
L_padret:
  s_cmp_eq_u32 s86, 1
  s_cbranch_scc0 L_end
  s_mov_b32 s86, 0
  s_mov_b64 exec, -1
  s_waitcnt vmcnt(0)
L_after:
  s_add_u32 m0, s47, 65536
  s_nop 0
  buffer_load_dwordx4 v5, s[20:23], s41 offen offset:0 sc1 lds
  buffer_load_dwordx4 v6, s[20:23], s41 offen offset:1024 sc1 lds
  buffer_load_dwordx4 v7, s[20:23], s41 offen offset:2048 sc1 lds
  buffer_load_dwordx4 v8, s[20:23], s41 offen offset:3072 sc1 lds
  s_add_u32 s41, s41, s44
  s_add_u32 m0, s47, 81920
  s_nop 0
  buffer_load_dwordx4 v5, s[20:23], s41 offen offset:0 sc1 lds
  buffer_load_dwordx4 v6, s[20:23], s41 offen offset:1024 sc1 lds
  buffer_load_dwordx4 v7, s[20:23], s41 offen offset:2048 sc1 lds
  buffer_load_dwordx4 v8, s[20:23], s41 offen offset:3072 sc1 lds
  s_add_u32 s41, s41, s44
  s_add_u32 m0, s47, 98304
  s_nop 0
  buffer_load_dwordx4 v5, s[20:23], s41 offen offset:0 sc1 lds
  buffer_load_dwordx4 v6, s[20:23], s41 offen offset:1024 sc1 lds
  buffer_load_dwordx4 v7, s[20:23], s41 offen offset:2048 sc1 lds
  buffer_load_dwordx4 v8, s[20:23], s41 offen offset:3072 sc1 lds
  s_add_u32 s41, s41, s44
  s_add_u32 m0, s47, 114688
  s_nop 0
  buffer_load_dwordx4 v5, s[20:23], s41 offen offset:0 sc1 lds
  buffer_load_dwordx4 v6, s[20:23], s41 offen offset:1024 sc1 lds
  buffer_load_dwordx4 v7, s[20:23], s41 offen offset:2048 sc1 lds
  buffer_load_dwordx4 v8, s[20:23], s41 offen offset:3072 sc1 lds
  s_add_u32 s41, s41, s44
  s_and_b32 s70, s62, 7
  s_lshl_b32 s58, s64, 3
  s_add_u32 s70, s70, s58
  s_lshr_b32 s71, s62, 3
  s_lshl_b32 s58, s63, 2
  s_add_u32 s71, s71, s58
  s_lshl_b32 s58, s71, 1
  s_add_u32 s58, s58, s3
  s_sub_u32 s58, s58, 2
  s_max_i32 s58, s58, 0
  s_and_b32 s84, s58, 7
  s_lshl_b32 s84, s84, 5
  s_lshr_b32 s58, s58, 3
  s_lshl_b32 s58, s58, 2
  s_add_u32 s84, s84, s58
  s_lshl_b32 s71, s71, 8
  s_lshr_b32 s72, s61, 1
  s_lshl_b32 s72, s72, 3
  s_lshr_b32 s58, s62, 2
  s_add_u32 s72, s72, s58
  s_and_b32 s73, s61, 1
  s_lshl_b32 s73, s73, 2
  s_add_u32 s73, s73, s66
  s_lshr_b32 s76, s72, 1
  s_and_b32 s76, s76, 7
  s_lshl_b32 s76, s76, 5
  s_lshl_b32 s58, s63, 2
  s_add_u32 s76, s76, s58
  s_lshr_b32 s77, s72, 2
  s_and_b32 s77, s77, 3
  s_lshl_b32 s77, s77, 6
  s_add_u32 s77, s77, s58
  s_lshl_b32 s77, s77, 7
  s_and_b32 s59, s72, 3
  s_lshl_b32 s59, s59, 15
  s_add_u32 s77, s77, s59
  s_lshl_b32 s58, s65, 7
  s_lshl_b32 s59, s67, 6
  s_add_u32 s81, s58, s59
  s_lshl_b32 s58, s81, 3
  s_lshl_b32 s59, s68, 17
  s_add_u32 s58, s58, s59
  s_lshl_b32 s49, s52, 18
  s_add_u32 s49, s49, s58
  s_mov_b32 s59, 0x40088e99
  s_cmp_lt_u32 s52, 10
  s_cselect_b32 s52, 0x3f303613, s59
  s_lshl_b32 s50, s53, 18
  s_add_u32 s50, s50, s58
  s_mov_b32 s59, 0x40088e99
  s_cmp_lt_u32 s53, 10
  s_cselect_b32 s53, 0x3f303613, s59
  s_lshl_b32 s51, s54, 18
  s_add_u32 s51, s51, s58
  s_mov_b32 s59, 0x40088e99
  s_cmp_lt_u32 s54, 10
  s_cselect_b32 s54, 0x3f303613, s59
  s_lshr_b32 s58, s81, 6
  s_mul_i32 s58, s58, 278528
  s_lshl_b32 s59, s68, 12
  s_add_u32 s58, s58, s59
  s_lshl_b32 s55, s55, 13
  s_add_u32 s55, s55, s58
  s_lshl_b32 s56, s56, 13
  s_add_u32 s56, s56, s58
  s_mul_i32 s82, s70, 81920
  s_lshl_b32 s58, s3, 7
  s_add_u32 s58, s58, s71
  s_sub_u32 s58, s58, 256
  s_cmp_lt_i32 s58, 0
  s_cselect_b32 s64, 0xf149, 0
  s_or_b32 s64, s64, 0x3f800000
  s_max_i32 s58, s58, 0
  s_lshl_b32 s58, s58, 3
  s_add_u32 s58, s58, s82
  s_add_u32 s61, s58, 2621440
  s_add_u32 s62, s58, 5242880
  s_lshl_b32 s58, s3, 6
  s_add_u32 s58, s58, s71
  s_lshl_b32 s63, s58, 3
  s_add_u32 s63, s63, s82
  s_lshr_b32 s58, s58, 6
  s_mul_i32 s58, s58, 278528
  s_lshl_b32 s65, s70, 11
  s_add_u32 s65, s65, s58
  s_add_u32 s65, s65, 196608
  s_lshl_b32 s66, s70, 9
  s_add_u32 s66, s66, s58
  s_add_u32 s66, s66, 262144
  s_mul_i32 s58, s72, 278528
  s_mul_i32 s59, s3, 49152
  s_add_u32 s68, s58, s59
  s_add_u32 s75, s58, 196608
  s_mul_i32 s58, s73, 348160
  s_mul_i32 s59, s3, 61440
  s_add_u32 s69, s58, s59
  s_mul_i32 s59, s3, 25600
  s_add_u32 s74, s58, s59
  s_add_u32 s74, s74, 245760
  s_lshr_b32 s58, s3, 1
  s_lshl_b32 s58, s58, 5
  s_add_u32 s58, s58, s67
  s_lshl_b32 s59, s72, 6
  s_add_u32 s58, s58, s59
  s_mul_i32 s58, s58, 1280
  s_mul_i32 s59, s73, 160
  s_add_u32 s70, s58, s59
  s_mul_i32 s83, s3, 25600
  s_add_u32 s83, s83, 61440
  s_cmp_eq_u32 s67, 0
  s_cbranch_scc1 L_havetag
  s_load_dword s85, s[36:37], 0
  s_waitcnt lgkmcnt(0)
  v_mov_b32 v15, s85
  v_cmp_ne_u32 vcc, 0, v15
  s_nop 0
  s_cmp_eq_u64 vcc, -1
  s_cbranch_scc0 L_slow1
L_back1:
  v_readfirstlane_b32 s85, v15
  s_nop 0
L_havetag:
  s_add_u32 s87, s85, 1
  s_mov_b32 s86, 0
  s_branch L_xn1
L_xnw:
  s_sleep 4
L_xn1:
  s_load_dword s36, s[0:1], 0 glc
  s_load_dword s37, s[0:1], 65536 glc
  s_load_dword s38, s[0:1], 1024 glc
  s_load_dword s39, s[0:1], 66560 glc
  s_load_dword s88, s[0:1], 2048 glc
  s_load_dword s89, s[0:1], 67584 glc
  s_load_dword s90, s[0:1], 3072 glc
  s_load_dword s91, s[0:1], 68608 glc
  s_add_u32 s86, s86, 1
  s_cmp_gt_u32 s86, 0x40000
  s_cbranch_scc1 L_end
  s_waitcnt lgkmcnt(0)
  s_sub_u32 s36, s36, s87
  s_sub_u32 s37, s37, s87
  s_sub_u32 s38, s38, s87
  s_sub_u32 s39, s39, s87
  s_sub_u32 s88, s88, s87
  s_sub_u32 s89, s89, s87
  s_sub_u32 s90, s90, s87
  s_sub_u32 s91, s91, s87
  s_max_u32 s36, s36, s37
  s_max_u32 s36, s36, s38
  s_max_u32 s36, s36, s39
  s_max_u32 s36, s36, s88
  s_max_u32 s36, s36, s89
  s_max_u32 s36, s36, s90
  s_max_u32 s36, s36, s91
  s_cmp_lt_u32 s36, 7
  s_cbranch_scc0 L_xnw
  s_add_u32 s36, s6, 0xb00000
  s_addc_u32 s37, s7, 0
  s_mov_b32 s38, 0x880000
  s_mov_b32 s39, 0x20000
  s_add_u32 m0, s47, 0
  s_nop 0
  buffer_load_dwordx4 v130, s[16:19], s40 offen offset:0 sc1 lds
  buffer_load_dwordx4 v131, s[16:19], s40 offen offset:1024 sc1 lds
  buffer_load_dwordx4 v132, s[16:19], s40 offen offset:2048 sc1 lds
  buffer_load_dwordx4 v133, s[16:19], s40 offen offset:3072 sc1 lds
  s_add_u32 s40, s40, 128
  s_add_u32 m0, s47, 16384
  s_nop 0
  buffer_load_dwordx4 v130, s[16:19], s40 offen offset:0 sc1 lds
  buffer_load_dwordx4 v131, s[16:19], s40 offen offset:1024 sc1 lds
  buffer_load_dwordx4 v132, s[16:19], s40 offen offset:2048 sc1 lds
  buffer_load_dwordx4 v133, s[16:19], s40 offen offset:3072 sc1 lds
  s_add_u32 s40, s40, 128
  s_add_u32 m0, s47, 32768
  s_nop 0
  buffer_load_dwordx4 v130, s[16:19], s40 offen offset:0 sc1 lds
  buffer_load_dwordx4 v131, s[16:19], s40 offen offset:1024 sc1 lds
  buffer_load_dwordx4 v132, s[16:19], s40 offen offset:2048 sc1 lds
  buffer_load_dwordx4 v133, s[16:19], s40 offen offset:3072 sc1 lds
  s_add_u32 s40, s40, 128
  s_waitcnt vmcnt(28)
  ds_read_b64_tr_b16 v[140:141], v136 offset:49152
  ds_read_b64_tr_b16 v[142:143], v136 offset:49664
  ds_read_b64_tr_b16 v[144:145], v136 offset:49184
  ds_read_b64_tr_b16 v[146:147], v136 offset:49696
  ds_read_b64_tr_b16 v[148:149], v136 offset:49216
  ds_read_b64_tr_b16 v[150:151], v136 offset:49728
  ds_read_b64_tr_b16 v[152:153], v136 offset:49248
  ds_read_b64_tr_b16 v[154:155], v136 offset:49760
  s_mul_hi_u32 s58, s79, 858993460
  s_mul_i32 s58, s58, 335
  s_add_u32 s58, s58, s78
  s_add_u32 s58, s58, s79
  s_lshl_b32 s58, s58, 10
  s_waitcnt lgkmcnt(6)
  buffer_store_dwordx4 v[140:143], v17, s[8:11], s58 offen sc1
  s_add_u32 s79, s79, 1
  s_mul_hi_u32 s58, s79, 858993460
  s_mul_i32 s58, s58, 335
  s_add_u32 s58, s58, s78
  s_add_u32 s58, s58, s79
  s_lshl_b32 s58, s58, 10
  s_waitcnt lgkmcnt(4)
  buffer_store_dwordx4 v[144:147], v17, s[8:11], s58 offen sc1
  s_add_u32 s79, s79, 1
  s_mul_hi_u32 s58, s79, 858993460
  s_mul_i32 s58, s58, 335
  s_add_u32 s58, s58, s78
  s_add_u32 s58, s58, s79
  s_lshl_b32 s58, s58, 10
  s_waitcnt lgkmcnt(2)
  buffer_store_dwordx4 v[148:151], v17, s[8:11], s58 offen sc1
  s_add_u32 s79, s79, 1
  s_mul_hi_u32 s58, s79, 858993460
  s_mul_i32 s58, s58, 335
  s_add_u32 s58, s58, s78
  s_add_u32 s58, s58, s79
  s_lshl_b32 s58, s58, 10
  s_waitcnt lgkmcnt(0)
  buffer_store_dwordx4 v[152:155], v17, s[8:11], s58 offen sc1
  s_add_u32 s79, s79, 1
  s_branch L_hot
.p2align 12
L_hot:
L_pad0:
  s_cbranch_execz L_pad2
  s_waitcnt vmcnt(12)
  s_barrier
  ds_read_b128 a[0:3], v128 offset:0
  ds_read_b128 a[4:7], v128 offset:2048
  ds_read_b128 a[8:11], v128 offset:4096
  ds_read_b128 a[12:15], v128 offset:6144
  ds_read_b64_tr_b16 v[48:49], v1 offset:0
  ds_read_b64_tr_b16 v[50:51], v1 offset:256
  ds_read_b64_tr_b16 v[52:53], v2 offset:0
  ds_read_b64_tr_b16 v[54:55], v2 offset:256
  s_waitcnt lgkmcnt(2)
  v_mfma_f32_16x16x32_bf16 v[64:67], v[48:51], a[0:3], 0
  ds_read_b64_tr_b16 v[56:57], v1 offset:8192
  s_add_u32 m0, s47, 49152
  v_mfma_f32_16x16x32_bf16 v[68:71], v[48:51], a[4:7], 0
  ds_read_b64_tr_b16 v[58:59], v1 offset:8448
  v_mfma_f32_16x16x32_bf16 v[96:99], v[48:51], a[8:11], 0
  ds_read_b128 a[16:19], v129 offset:0
  v_mfma_f32_16x16x32_bf16 v[100:103], v[48:51], a[12:15], 0
  s_waitcnt lgkmcnt(3)
  buffer_load_dwordx4 v130, s[16:19], s40 offen offset:0 sc1 lds
  v_mfma_f32_16x16x32_bf16 v[108:111], v[52:55], a[12:15], 0
  ds_read_b64_tr_b16 v[60:61], v2 offset:8192
  v_mfma_f32_16x16x32_bf16 v[104:107], v[52:55], a[8:11], 0
  ds_read_b64_tr_b16 v[62:63], v2 offset:8448
  v_mfma_f32_16x16x32_bf16 v[76:79], v[52:55], a[4:7], 0
  ds_read_b128 a[20:23], v129 offset:2048
  v_mfma_f32_16x16x32_bf16 v[72:75], v[52:55], a[0:3], 0
  s_waitcnt lgkmcnt(4)
  buffer_load_dwordx4 v131, s[16:19], s40 offen offset:1024 sc1 lds
  v_mfma_f32_16x16x32_bf16 v[80:83], v[56:59], a[0:3], 0
  ds_read_b64_tr_b16 v[48:49], v1 offset:4096
  v_mfma_f32_16x16x32_bf16 v[84:87], v[56:59], a[4:7], 0
  ds_read_b64_tr_b16 v[50:51], v1 offset:4352
  v_mfma_f32_16x16x32_bf16 v[112:115], v[56:59], a[8:11], 0
  ds_read_b128 a[24:27], v129 offset:4096
  v_mfma_f32_16x16x32_bf16 v[116:119], v[56:59], a[12:15], 0
  s_waitcnt lgkmcnt(4)
  buffer_load_dwordx4 v132, s[16:19], s40 offen offset:2048 sc1 lds
  v_mfma_f32_16x16x32_bf16 v[124:127], v[60:63], a[12:15], 0
  ds_read_b64_tr_b16 v[52:53], v2 offset:4096
  v_mfma_f32_16x16x32_bf16 v[120:123], v[60:63], a[8:11], 0
  ds_read_b64_tr_b16 v[54:55], v2 offset:4352
  v_mfma_f32_16x16x32_bf16 v[92:95], v[60:63], a[4:7], 0
  ds_read_b128 a[28:31], v129 offset:6144
  v_mfma_f32_16x16x32_bf16 v[88:91], v[60:63], a[0:3], 0
  s_waitcnt lgkmcnt(4)
  s_waitcnt vmcnt(11)
  s_barrier
  v_mfma_f32_16x16x32_bf16 v[64:67], v[48:51], a[16:19], v[64:67]
  ds_read_b64_tr_b16 v[56:57], v1 offset:12288
  v_mfma_f32_16x16x32_bf16 v[68:71], v[48:51], a[20:23], v[68:71]
  ds_read_b64_tr_b16 v[58:59], v1 offset:12544
  s_waitcnt lgkmcnt(5)
  v_mfma_f32_16x16x32_bf16 v[96:99], v[48:51], a[24:27], v[96:99]
  ds_read_b128 a[32:35], v128 offset:16384
  s_waitcnt lgkmcnt(3)
  v_mfma_f32_16x16x32_bf16 v[100:103], v[48:51], a[28:31], v[100:103]
  buffer_load_dwordx4 v133, s[16:19], s40 offen offset:3072 sc1 lds
  v_mfma_f32_16x16x32_bf16 v[108:111], v[52:55], a[28:31], v[108:111]
  ds_read_b64_tr_b16 v[60:61], v2 offset:12288
  s_add_u32 s40, s40, 128
  v_mfma_f32_16x16x32_bf16 v[104:107], v[52:55], a[24:27], v[104:107]
  ds_read_b64_tr_b16 v[62:63], v2 offset:12544
  s_add_u32 m0, s47, 131072
  v_mfma_f32_16x16x32_bf16 v[76:79], v[52:55], a[20:23], v[76:79]
  ds_read_b128 a[36:39], v128 offset:18432
  v_mfma_f32_16x16x32_bf16 v[72:75], v[52:55], a[16:19], v[72:75]
  s_waitcnt lgkmcnt(4)
  buffer_load_dwordx4 v5, s[20:23], s41 offen offset:0 sc1 lds
  v_mfma_f32_16x16x32_bf16 v[80:83], v[56:59], a[16:19], v[80:83]
  ds_read_b64_tr_b16 v[48:49], v1 offset:16384
  v_mfma_f32_16x16x32_bf16 v[84:87], v[56:59], a[20:23], v[84:87]
  ds_read_b64_tr_b16 v[50:51], v1 offset:16640
  v_mfma_f32_16x16x32_bf16 v[112:115], v[56:59], a[24:27], v[112:115]
  ds_read_b128 a[40:43], v128 offset:20480
  v_mfma_f32_16x16x32_bf16 v[116:119], v[56:59], a[28:31], v[116:119]
  s_waitcnt lgkmcnt(4)
  buffer_load_dwordx4 v6, s[20:23], s41 offen offset:1024 sc1 lds
  v_mfma_f32_16x16x32_bf16 v[124:127], v[60:63], a[28:31], v[124:127]
  ds_read_b64_tr_b16 v[52:53], v2 offset:16384
  v_mfma_f32_16x16x32_bf16 v[120:123], v[60:63], a[24:27], v[120:123]
  ds_read_b64_tr_b16 v[54:55], v2 offset:16640
  v_mfma_f32_16x16x32_bf16 v[92:95], v[60:63], a[20:23], v[92:95]
  ds_read_b128 a[44:47], v128 offset:22528
  v_mfma_f32_16x16x32_bf16 v[88:91], v[60:63], a[16:19], v[88:91]
  s_waitcnt lgkmcnt(4)
  buffer_load_dwordx4 v7, s[20:23], s41 offen offset:2048 sc1 lds
  v_mfma_f32_16x16x32_bf16 v[64:67], v[48:51], a[32:35], v[64:67]
  ds_read_b64_tr_b16 v[56:57], v1 offset:24576
  v_mfma_f32_16x16x32_bf16 v[68:71], v[48:51], a[36:39], v[68:71]
  ds_read_b64_tr_b16 v[58:59], v1 offset:24832
  s_waitcnt lgkmcnt(5)
  v_mfma_f32_16x16x32_bf16 v[96:99], v[48:51], a[40:43], v[96:99]
  ds_read_b128 a[48:51], v129 offset:16384
  s_waitcnt lgkmcnt(3)
  v_mfma_f32_16x16x32_bf16 v[100:103], v[48:51], a[44:47], v[100:103]
  buffer_load_dwordx4 v8, s[20:23], s41 offen offset:3072 sc1 lds
  v_mfma_f32_16x16x32_bf16 v[108:111], v[52:55], a[44:47], v[108:111]
  ds_read_b64_tr_b16 v[60:61], v2 offset:24576
  s_add_u32 s41, s41, s44
  v_mfma_f32_16x16x32_bf16 v[104:107], v[52:55], a[40:43], v[104:107]
  ds_read_b64_tr_b16 v[62:63], v2 offset:24832
  v_mfma_f32_16x16x32_bf16 v[76:79], v[52:55], a[36:39], v[76:79]
  ds_read_b128 a[52:55], v129 offset:18432
  v_mfma_f32_16x16x32_bf16 v[72:75], v[52:55], a[32:35], v[72:75]
  s_waitcnt lgkmcnt(4)
  v_mfma_f32_16x16x32_bf16 v[80:83], v[56:59], a[32:35], v[80:83]
  ds_read_b64_tr_b16 v[48:49], v1 offset:20480
  v_mfma_f32_16x16x32_bf16 v[84:87], v[56:59], a[36:39], v[84:87]
  ds_read_b64_tr_b16 v[50:51], v1 offset:20736
  v_mfma_f32_16x16x32_bf16 v[112:115], v[56:59], a[40:43], v[112:115]
  ds_read_b128 a[56:59], v129 offset:20480
  v_mfma_f32_16x16x32_bf16 v[116:119], v[56:59], a[44:47], v[116:119]
  s_waitcnt lgkmcnt(4)
  v_mfma_f32_16x16x32_bf16 v[124:127], v[60:63], a[44:47], v[124:127]
  ds_read_b64_tr_b16 v[52:53], v2 offset:20480
  v_mfma_f32_16x16x32_bf16 v[120:123], v[60:63], a[40:43], v[120:123]
  ds_read_b64_tr_b16 v[54:55], v2 offset:20736
  v_mfma_f32_16x16x32_bf16 v[92:95], v[60:63], a[36:39], v[92:95]
  ds_read_b128 a[60:63], v129 offset:22528
  v_mfma_f32_16x16x32_bf16 v[88:91], v[60:63], a[32:35], v[88:91]
  s_waitcnt lgkmcnt(4)
  s_waitcnt vmcnt(12)
  s_barrier
  s_add_u32 m0, s47, 0
  v_mfma_f32_16x16x32_bf16 v[64:67], v[48:51], a[48:51], v[64:67]
  ds_read_b64_tr_b16 v[56:57], v1 offset:28672
  v_mfma_f32_16x16x32_bf16 v[68:71], v[48:51], a[52:55], v[68:71]
  ds_read_b64_tr_b16 v[58:59], v1 offset:28928
  buffer_load_dwordx4 v130, s[16:19], s40 offen offset:0 sc1 lds
  s_waitcnt lgkmcnt(5)
  v_mfma_f32_16x16x32_bf16 v[96:99], v[48:51], a[56:59], v[96:99]
  ds_read_b128 a[64:67], v128 offset:32768
  s_waitcnt lgkmcnt(3)
  v_mfma_f32_16x16x32_bf16 v[100:103], v[48:51], a[60:63], v[100:103]
  buffer_load_dwordx4 v131, s[16:19], s40 offen offset:1024 sc1 lds
  v_mfma_f32_16x16x32_bf16 v[108:111], v[52:55], a[60:63], v[108:111]
  ds_read_b64_tr_b16 v[60:61], v2 offset:28672
  v_mfma_f32_16x16x32_bf16 v[104:107], v[52:55], a[56:59], v[104:107]
  ds_read_b64_tr_b16 v[62:63], v2 offset:28928
  v_mfma_f32_16x16x32_bf16 v[76:79], v[52:55], a[52:55], v[76:79]
  ds_read_b128 a[68:71], v128 offset:34816
  v_mfma_f32_16x16x32_bf16 v[72:75], v[52:55], a[48:51], v[72:75]
  s_waitcnt lgkmcnt(4)
  buffer_load_dwordx4 v132, s[16:19], s40 offen offset:2048 sc1 lds
  v_mfma_f32_16x16x32_bf16 v[80:83], v[56:59], a[48:51], v[80:83]
  ds_read_b64_tr_b16 v[48:49], v1 offset:32768
  v_mfma_f32_16x16x32_bf16 v[84:87], v[56:59], a[52:55], v[84:87]
  ds_read_b64_tr_b16 v[50:51], v1 offset:33024
  v_mfma_f32_16x16x32_bf16 v[112:115], v[56:59], a[56:59], v[112:115]
  ds_read_b128 a[72:75], v128 offset:36864
  v_mfma_f32_16x16x32_bf16 v[116:119], v[56:59], a[60:63], v[116:119]
  s_waitcnt lgkmcnt(4)
  buffer_load_dwordx4 v133, s[16:19], s40 offen offset:3072 sc1 lds
  v_mfma_f32_16x16x32_bf16 v[124:127], v[60:63], a[60:63], v[124:127]
  ds_read_b64_tr_b16 v[52:53], v2 offset:32768
  s_add_u32 s40, s40, 128
  v_mfma_f32_16x16x32_bf16 v[120:123], v[60:63], a[56:59], v[120:123]
  ds_read_b64_tr_b16 v[54:55], v2 offset:33024
  s_add_u32 m0, s47, 65536
  v_mfma_f32_16x16x32_bf16 v[92:95], v[60:63], a[52:55], v[92:95]
  ds_read_b128 a[76:79], v128 offset:38912
  v_mfma_f32_16x16x32_bf16 v[88:91], v[60:63], a[48:51], v[88:91]
  s_waitcnt lgkmcnt(4)
  buffer_load_dwordx4 v5, s[20:23], s41 offen offset:0 sc1 lds
  v_mfma_f32_16x16x32_bf16 v[64:67], v[48:51], a[64:67], v[64:67]
  ds_read_b64_tr_b16 v[56:57], v1 offset:40960
  v_mfma_f32_16x16x32_bf16 v[68:71], v[48:51], a[68:71], v[68:71]
  ds_read_b64_tr_b16 v[58:59], v1 offset:41216
  s_waitcnt lgkmcnt(5)
  v_mfma_f32_16x16x32_bf16 v[96:99], v[48:51], a[72:75], v[96:99]
  ds_read_b128 a[80:83], v129 offset:32768
  s_waitcnt lgkmcnt(3)
  v_mfma_f32_16x16x32_bf16 v[100:103], v[48:51], a[76:79], v[100:103]
  buffer_load_dwordx4 v6, s[20:23], s41 offen offset:1024 sc1 lds
  v_mfma_f32_16x16x32_bf16 v[108:111], v[52:55], a[76:79], v[108:111]
  ds_read_b64_tr_b16 v[60:61], v2 offset:40960
  v_mfma_f32_16x16x32_bf16 v[104:107], v[52:55], a[72:75], v[104:107]
  ds_read_b64_tr_b16 v[62:63], v2 offset:41216
  v_mfma_f32_16x16x32_bf16 v[76:79], v[52:55], a[68:71], v[76:79]
  ds_read_b128 a[84:87], v129 offset:34816
  v_mfma_f32_16x16x32_bf16 v[72:75], v[52:55], a[64:67], v[72:75]
  s_waitcnt lgkmcnt(4)
  buffer_load_dwordx4 v7, s[20:23], s41 offen offset:2048 sc1 lds
  v_mfma_f32_16x16x32_bf16 v[80:83], v[56:59], a[64:67], v[80:83]
  ds_read_b64_tr_b16 v[48:49], v1 offset:36864
  v_mfma_f32_16x16x32_bf16 v[84:87], v[56:59], a[68:71], v[84:87]
  ds_read_b64_tr_b16 v[50:51], v1 offset:37120
  v_mfma_f32_16x16x32_bf16 v[112:115], v[56:59], a[72:75], v[112:115]
  ds_read_b128 a[88:91], v129 offset:36864
  v_mfma_f32_16x16x32_bf16 v[116:119], v[56:59], a[76:79], v[116:119]
  s_waitcnt lgkmcnt(4)
  buffer_load_dwordx4 v8, s[20:23], s41 offen offset:3072 sc1 lds
  v_mfma_f32_16x16x32_bf16 v[124:127], v[60:63], a[76:79], v[124:127]
  ds_read_b64_tr_b16 v[52:53], v2 offset:36864
  s_add_u32 s41, s41, s44
  v_mfma_f32_16x16x32_bf16 v[120:123], v[60:63], a[72:75], v[120:123]
  ds_read_b64_tr_b16 v[54:55], v2 offset:37120
  v_mfma_f32_16x16x32_bf16 v[92:95], v[60:63], a[68:71], v[92:95]
  ds_read_b128 a[92:95], v129 offset:38912
  v_mfma_f32_16x16x32_bf16 v[88:91], v[60:63], a[64:67], v[88:91]
  s_waitcnt lgkmcnt(4)
  s_waitcnt vmcnt(12)
  s_barrier
  s_add_u32 m0, s47, 16384
  v_mfma_f32_16x16x32_bf16 v[64:67], v[48:51], a[80:83], v[64:67]
  ds_read_b64_tr_b16 v[56:57], v1 offset:45056
  v_mfma_f32_16x16x32_bf16 v[68:71], v[48:51], a[84:87], v[68:71]
  ds_read_b64_tr_b16 v[58:59], v1 offset:45312
  buffer_load_dwordx4 v130, s[16:19], s40 offen offset:0 sc1 lds
  s_waitcnt lgkmcnt(5)
  v_mfma_f32_16x16x32_bf16 v[96:99], v[48:51], a[88:91], v[96:99]
  ds_read_b128 a[96:99], v128 offset:49152
  s_waitcnt lgkmcnt(3)
  v_mfma_f32_16x16x32_bf16 v[100:103], v[48:51], a[92:95], v[100:103]
  buffer_load_dwordx4 v131, s[16:19], s40 offen offset:1024 sc1 lds
  v_mfma_f32_16x16x32_bf16 v[108:111], v[52:55], a[92:95], v[108:111]
  ds_read_b64_tr_b16 v[60:61], v2 offset:45056
  v_mfma_f32_16x16x32_bf16 v[104:107], v[52:55], a[88:91], v[104:107]
  ds_read_b64_tr_b16 v[62:63], v2 offset:45312
  v_mfma_f32_16x16x32_bf16 v[76:79], v[52:55], a[84:87], v[76:79]
  ds_read_b128 a[100:103], v128 offset:51200
  v_mfma_f32_16x16x32_bf16 v[72:75], v[52:55], a[80:83], v[72:75]
  s_waitcnt lgkmcnt(4)
  buffer_load_dwordx4 v132, s[16:19], s40 offen offset:2048 sc1 lds
  v_mfma_f32_16x16x32_bf16 v[80:83], v[56:59], a[80:83], v[80:83]
  ds_read_b64_tr_b16 v[48:49], v1 offset:49152
  v_mfma_f32_16x16x32_bf16 v[84:87], v[56:59], a[84:87], v[84:87]
  ds_read_b64_tr_b16 v[50:51], v1 offset:49408
  v_mfma_f32_16x16x32_bf16 v[112:115], v[56:59], a[88:91], v[112:115]
  ds_read_b128 a[104:107], v128 offset:53248
  v_mfma_f32_16x16x32_bf16 v[116:119], v[56:59], a[92:95], v[116:119]
  s_waitcnt lgkmcnt(4)
  buffer_load_dwordx4 v133, s[16:19], s40 offen offset:3072 sc1 lds
  v_mfma_f32_16x16x32_bf16 v[124:127], v[60:63], a[92:95], v[124:127]
  ds_read_b64_tr_b16 v[52:53], v2 offset:49152
  s_add_u32 s40, s40, 128
  v_mfma_f32_16x16x32_bf16 v[120:123], v[60:63], a[88:91], v[120:123]
  ds_read_b64_tr_b16 v[54:55], v2 offset:49408
  s_add_u32 m0, s47, 81920
  v_mfma_f32_16x16x32_bf16 v[92:95], v[60:63], a[84:87], v[92:95]
  ds_read_b128 a[108:111], v128 offset:55296
  v_mfma_f32_16x16x32_bf16 v[88:91], v[60:63], a[80:83], v[88:91]
  s_waitcnt lgkmcnt(4)
  buffer_load_dwordx4 v5, s[20:23], s41 offen offset:0 sc1 lds
  v_mfma_f32_16x16x32_bf16 v[64:67], v[48:51], a[96:99], v[64:67]
  ds_read_b64_tr_b16 v[56:57], v1 offset:57344
  v_mfma_f32_16x16x32_bf16 v[68:71], v[48:51], a[100:103], v[68:71]
  ds_read_b64_tr_b16 v[58:59], v1 offset:57600
  s_waitcnt lgkmcnt(5)
  v_mfma_f32_16x16x32_bf16 v[96:99], v[48:51], a[104:107], v[96:99]
  ds_read_b128 a[112:115], v129 offset:49152
  s_waitcnt lgkmcnt(3)
  v_mfma_f32_16x16x32_bf16 v[100:103], v[48:51], a[108:111], v[100:103]
  buffer_load_dwordx4 v6, s[20:23], s41 offen offset:1024 sc1 lds
  v_mfma_f32_16x16x32_bf16 v[108:111], v[52:55], a[108:111], v[108:111]
  ds_read_b64_tr_b16 v[60:61], v2 offset:57344
  v_mfma_f32_16x16x32_bf16 v[104:107], v[52:55], a[104:107], v[104:107]
  ds_read_b64_tr_b16 v[62:63], v2 offset:57600
  v_mfma_f32_16x16x32_bf16 v[76:79], v[52:55], a[100:103], v[76:79]
  ds_read_b128 a[116:119], v129 offset:51200
  v_mfma_f32_16x16x32_bf16 v[72:75], v[52:55], a[96:99], v[72:75]
  s_waitcnt lgkmcnt(4)
  buffer_load_dwordx4 v7, s[20:23], s41 offen offset:2048 sc1 lds
  v_mfma_f32_16x16x32_bf16 v[80:83], v[56:59], a[96:99], v[80:83]
  ds_read_b64_tr_b16 v[48:49], v1 offset:53248
  v_mfma_f32_16x16x32_bf16 v[84:87], v[56:59], a[100:103], v[84:87]
  ds_read_b64_tr_b16 v[50:51], v1 offset:53504
  v_mfma_f32_16x16x32_bf16 v[112:115], v[56:59], a[104:107], v[112:115]
  ds_read_b128 a[120:123], v129 offset:53248
  v_mfma_f32_16x16x32_bf16 v[116:119], v[56:59], a[108:111], v[116:119]
  s_waitcnt lgkmcnt(4)
  buffer_load_dwordx4 v8, s[20:23], s41 offen offset:3072 sc1 lds
  v_mfma_f32_16x16x32_bf16 v[124:127], v[60:63], a[108:111], v[124:127]
  ds_read_b64_tr_b16 v[52:53], v2 offset:53248
  s_add_u32 s41, s41, s44
  v_mfma_f32_16x16x32_bf16 v[120:123], v[60:63], a[104:107], v[120:123]
  ds_read_b64_tr_b16 v[54:55], v2 offset:53504
  v_mfma_f32_16x16x32_bf16 v[92:95], v[60:63], a[100:103], v[92:95]
  ds_read_b128 a[124:127], v129 offset:55296
  v_mfma_f32_16x16x32_bf16 v[88:91], v[60:63], a[96:99], v[88:91]
  s_waitcnt lgkmcnt(4)
  s_waitcnt vmcnt(12)
  s_barrier
  s_add_u32 m0, s47, 32768
  v_mfma_f32_16x16x32_bf16 v[64:67], v[48:51], a[112:115], v[64:67]
  ds_read_b64_tr_b16 v[56:57], v1 offset:61440
  v_mfma_f32_16x16x32_bf16 v[68:71], v[48:51], a[116:119], v[68:71]
  ds_read_b64_tr_b16 v[58:59], v1 offset:61696
  buffer_load_dwordx4 v130, s[16:19], s40 offen offset:0 sc1 lds
  s_waitcnt lgkmcnt(5)
  v_mfma_f32_16x16x32_bf16 v[96:99], v[48:51], a[120:123], v[96:99]
  ds_read_b128 a[128:131], v128 offset:0
  s_waitcnt lgkmcnt(3)
  v_mfma_f32_16x16x32_bf16 v[100:103], v[48:51], a[124:127], v[100:103]
  buffer_load_dwordx4 v131, s[16:19], s40 offen offset:1024 sc1 lds
  v_mfma_f32_16x16x32_bf16 v[108:111], v[52:55], a[124:127], v[108:111]
  ds_read_b64_tr_b16 v[60:61], v2 offset:61440
  v_mfma_f32_16x16x32_bf16 v[104:107], v[52:55], a[120:123], v[104:107]
  ds_read_b64_tr_b16 v[62:63], v2 offset:61696
  v_mfma_f32_16x16x32_bf16 v[76:79], v[52:55], a[116:119], v[76:79]
  ds_read_b128 a[132:135], v128 offset:2048
  v_mfma_f32_16x16x32_bf16 v[72:75], v[52:55], a[112:115], v[72:75]
  s_waitcnt lgkmcnt(4)
  buffer_load_dwordx4 v132, s[16:19], s40 offen offset:2048 sc1 lds
  v_mfma_f32_16x16x32_bf16 v[80:83], v[56:59], a[112:115], v[80:83]
  ds_read_b64_tr_b16 v[48:49], v3 offset:0
  v_mfma_f32_16x16x32_bf16 v[84:87], v[56:59], a[116:119], v[84:87]
  ds_read_b64_tr_b16 v[50:51], v3 offset:256
  v_mfma_f32_16x16x32_bf16 v[112:115], v[56:59], a[120:123], v[112:115]
  ds_read_b128 a[136:139], v128 offset:4096
  v_mfma_f32_16x16x32_bf16 v[116:119], v[56:59], a[124:127], v[116:119]
  s_waitcnt lgkmcnt(4)
  buffer_load_dwordx4 v133, s[16:19], s40 offen offset:3072 sc1 lds
  v_mfma_f32_16x16x32_bf16 v[124:127], v[60:63], a[124:127], v[124:127]
  ds_read_b64_tr_b16 v[52:53], v4 offset:0
  s_add_u32 s40, s40, 128
  v_mfma_f32_16x16x32_bf16 v[120:123], v[60:63], a[120:123], v[120:123]
  ds_read_b64_tr_b16 v[54:55], v4 offset:256
  s_add_u32 m0, s47, 98304
  v_mfma_f32_16x16x32_bf16 v[92:95], v[60:63], a[116:119], v[92:95]
  ds_read_b128 a[140:143], v128 offset:6144
  v_mfma_f32_16x16x32_bf16 v[88:91], v[60:63], a[112:115], v[88:91]
  s_waitcnt lgkmcnt(4)
  buffer_load_dwordx4 v5, s[20:23], s41 offen offset:0 sc1 lds
  v_mfma_f32_16x16x32_bf16 v[64:67], v[48:51], a[128:131], v[64:67]
  ds_read_b64_tr_b16 v[56:57], v3 offset:8192
  v_mfma_f32_16x16x32_bf16 v[68:71], v[48:51], a[132:135], v[68:71]
  ds_read_b64_tr_b16 v[58:59], v3 offset:8448
  s_waitcnt lgkmcnt(5)
  v_mfma_f32_16x16x32_bf16 v[96:99], v[48:51], a[136:139], v[96:99]
  ds_read_b128 a[144:147], v129 offset:0
  s_waitcnt lgkmcnt(3)
  v_mfma_f32_16x16x32_bf16 v[100:103], v[48:51], a[140:143], v[100:103]
  buffer_load_dwordx4 v6, s[20:23], s41 offen offset:1024 sc1 lds
  v_mfma_f32_16x16x32_bf16 v[108:111], v[52:55], a[140:143], v[108:111]
  ds_read_b64_tr_b16 v[60:61], v4 offset:8192
  v_mfma_f32_16x16x32_bf16 v[104:107], v[52:55], a[136:139], v[104:107]
  ds_read_b64_tr_b16 v[62:63], v4 offset:8448
  v_mfma_f32_16x16x32_bf16 v[76:79], v[52:55], a[132:135], v[76:79]
  ds_read_b128 a[148:151], v129 offset:2048
  v_mfma_f32_16x16x32_bf16 v[72:75], v[52:55], a[128:131], v[72:75]
  s_waitcnt lgkmcnt(4)
  buffer_load_dwordx4 v7, s[20:23], s41 offen offset:2048 sc1 lds
  v_mfma_f32_16x16x32_bf16 v[80:83], v[56:59], a[128:131], v[80:83]
  ds_read_b64_tr_b16 v[48:49], v3 offset:4096
  v_mfma_f32_16x16x32_bf16 v[84:87], v[56:59], a[132:135], v[84:87]
  ds_read_b64_tr_b16 v[50:51], v3 offset:4352
  v_mfma_f32_16x16x32_bf16 v[112:115], v[56:59], a[136:139], v[112:115]
  ds_read_b128 a[152:155], v129 offset:4096
  v_mfma_f32_16x16x32_bf16 v[116:119], v[56:59], a[140:143], v[116:119]
  s_waitcnt lgkmcnt(4)
  buffer_load_dwordx4 v8, s[20:23], s41 offen offset:3072 sc1 lds
  v_mfma_f32_16x16x32_bf16 v[124:127], v[60:63], a[140:143], v[124:127]
  ds_read_b64_tr_b16 v[52:53], v4 offset:4096
  s_add_u32 s41, s41, s44
  v_mfma_f32_16x16x32_bf16 v[120:123], v[60:63], a[136:139], v[120:123]
  ds_read_b64_tr_b16 v[54:55], v4 offset:4352
  v_mfma_f32_16x16x32_bf16 v[92:95], v[60:63], a[132:135], v[92:95]
  ds_read_b128 a[156:159], v129 offset:6144
  v_mfma_f32_16x16x32_bf16 v[88:91], v[60:63], a[128:131], v[88:91]
  s_waitcnt lgkmcnt(4)
  s_waitcnt vmcnt(12)
  s_barrier
  s_add_u32 m0, s47, 49152
  v_mfma_f32_16x16x32_bf16 v[64:67], v[48:51], a[144:147], v[64:67]
  ds_read_b64_tr_b16 v[56:57], v3 offset:12288
  v_mfma_f32_16x16x32_bf16 v[68:71], v[48:51], a[148:151], v[68:71]
  ds_read_b64_tr_b16 v[58:59], v3 offset:12544
  buffer_load_dwordx4 v130, s[16:19], s40 offen offset:0 sc1 lds
  s_waitcnt lgkmcnt(5)
  v_mfma_f32_16x16x32_bf16 v[96:99], v[48:51], a[152:155], v[96:99]
  ds_read_b128 a[160:163], v128 offset:16384
  s_waitcnt lgkmcnt(3)
  v_mfma_f32_16x16x32_bf16 v[100:103], v[48:51], a[156:159], v[100:103]
  buffer_load_dwordx4 v131, s[16:19], s40 offen offset:1024 sc1 lds
  v_mfma_f32_16x16x32_bf16 v[108:111], v[52:55], a[156:159], v[108:111]
  ds_read_b64_tr_b16 v[60:61], v4 offset:12288
  v_mfma_f32_16x16x32_bf16 v[104:107], v[52:55], a[152:155], v[104:107]
  ds_read_b64_tr_b16 v[62:63], v4 offset:12544
  v_mfma_f32_16x16x32_bf16 v[76:79], v[52:55], a[148:151], v[76:79]
  ds_read_b128 a[164:167], v128 offset:18432
  v_mfma_f32_16x16x32_bf16 v[72:75], v[52:55], a[144:147], v[72:75]
  s_waitcnt lgkmcnt(4)
  buffer_load_dwordx4 v132, s[16:19], s40 offen offset:2048 sc1 lds
  v_mfma_f32_16x16x32_bf16 v[80:83], v[56:59], a[144:147], v[80:83]
  ds_read_b64_tr_b16 v[48:49], v1 offset:0
  v_mfma_f32_16x16x32_bf16 v[84:87], v[56:59], a[148:151], v[84:87]
  ds_read_b64_tr_b16 v[50:51], v1 offset:256
  v_mfma_f32_16x16x32_bf16 v[112:115], v[56:59], a[152:155], v[112:115]
  ds_read_b128 a[168:171], v128 offset:20480
  v_mfma_f32_16x16x32_bf16 v[116:119], v[56:59], a[156:159], v[116:119]
  s_waitcnt lgkmcnt(4)
  buffer_load_dwordx4 v133, s[16:19], s40 offen offset:3072 sc1 lds
  v_mfma_f32_16x16x32_bf16 v[124:127], v[60:63], a[156:159], v[124:127]
  ds_read_b64_tr_b16 v[52:53], v2 offset:0
  s_add_u32 s40, s40, 128
  v_mfma_f32_16x16x32_bf16 v[120:123], v[60:63], a[152:155], v[120:123]
  ds_read_b64_tr_b16 v[54:55], v2 offset:256
  s_add_u32 m0, s47, 114688
  v_mfma_f32_16x16x32_bf16 v[92:95], v[60:63], a[148:151], v[92:95]
  ds_read_b128 a[172:175], v128 offset:22528
  v_mfma_f32_16x16x32_bf16 v[88:91], v[60:63], a[144:147], v[88:91]
  s_waitcnt lgkmcnt(4)
  buffer_load_dwordx4 v5, s[20:23], s41 offen offset:0 sc1 lds
  v_mfma_f32_16x16x32_bf16 v[64:67], v[48:51], a[160:163], v[64:67]
  ds_read_b64_tr_b16 v[56:57], v1 offset:8192
  v_mfma_f32_16x16x32_bf16 v[68:71], v[48:51], a[164:167], v[68:71]
  ds_read_b64_tr_b16 v[58:59], v1 offset:8448
  s_waitcnt lgkmcnt(5)
  v_mfma_f32_16x16x32_bf16 v[96:99], v[48:51], a[168:171], v[96:99]
  ds_read_b128 a[176:179], v129 offset:16384
  s_waitcnt lgkmcnt(3)
  v_mfma_f32_16x16x32_bf16 v[100:103], v[48:51], a[172:175], v[100:103]
  buffer_load_dwordx4 v6, s[20:23], s41 offen offset:1024 sc1 lds
  v_mfma_f32_16x16x32_bf16 v[108:111], v[52:55], a[172:175], v[108:111]
  ds_read_b64_tr_b16 v[60:61], v2 offset:8192
  v_mfma_f32_16x16x32_bf16 v[104:107], v[52:55], a[168:171], v[104:107]
  ds_read_b64_tr_b16 v[62:63], v2 offset:8448
  v_mfma_f32_16x16x32_bf16 v[76:79], v[52:55], a[164:167], v[76:79]
  ds_read_b128 a[180:183], v129 offset:18432
  v_mfma_f32_16x16x32_bf16 v[72:75], v[52:55], a[160:163], v[72:75]
  s_waitcnt lgkmcnt(4)
  buffer_load_dwordx4 v7, s[20:23], s41 offen offset:2048 sc1 lds
  v_mfma_f32_16x16x32_bf16 v[80:83], v[56:59], a[160:163], v[80:83]
  ds_read_b64_tr_b16 v[48:49], v1 offset:4096
  v_mfma_f32_16x16x32_bf16 v[84:87], v[56:59], a[164:167], v[84:87]
  ds_read_b64_tr_b16 v[50:51], v1 offset:4352
  v_mfma_f32_16x16x32_bf16 v[112:115], v[56:59], a[168:171], v[112:115]
  ds_read_b128 a[184:187], v129 offset:20480
  v_mfma_f32_16x16x32_bf16 v[116:119], v[56:59], a[172:175], v[116:119]
  s_waitcnt lgkmcnt(4)
  buffer_load_dwordx4 v8, s[20:23], s41 offen offset:3072 sc1 lds
  v_mfma_f32_16x16x32_bf16 v[124:127], v[60:63], a[172:175], v[124:127]
  ds_read_b64_tr_b16 v[52:53], v2 offset:4096
  s_add_u32 s41, s41, s44
  v_mfma_f32_16x16x32_bf16 v[120:123], v[60:63], a[168:171], v[120:123]
  ds_read_b64_tr_b16 v[54:55], v2 offset:4352
  v_mfma_f32_16x16x32_bf16 v[92:95], v[60:63], a[164:167], v[92:95]
  ds_read_b128 a[188:191], v129 offset:22528
  v_mfma_f32_16x16x32_bf16 v[88:91], v[60:63], a[160:163], v[88:91]
  s_waitcnt lgkmcnt(4)
  s_waitcnt vmcnt(12)
  s_barrier
  s_add_u32 m0, s47, 0
  v_mfma_f32_16x16x32_bf16 v[64:67], v[48:51], a[176:179], v[64:67]
  ds_read_b64_tr_b16 v[56:57], v1 offset:12288
  v_mfma_f32_16x16x32_bf16 v[68:71], v[48:51], a[180:183], v[68:71]
  ds_read_b64_tr_b16 v[58:59], v1 offset:12544
  buffer_load_dwordx4 v130, s[16:19], s40 offen offset:0 sc1 lds
  s_waitcnt lgkmcnt(5)
  v_mfma_f32_16x16x32_bf16 v[96:99], v[48:51], a[184:187], v[96:99]
  ds_read_b128 a[192:195], v128 offset:32768
  s_waitcnt lgkmcnt(3)
  v_mfma_f32_16x16x32_bf16 v[100:103], v[48:51], a[188:191], v[100:103]
  buffer_load_dwordx4 v131, s[16:19], s40 offen offset:1024 sc1 lds
  v_mfma_f32_16x16x32_bf16 v[108:111], v[52:55], a[188:191], v[108:111]
  ds_read_b64_tr_b16 v[60:61], v2 offset:12288
  v_mfma_f32_16x16x32_bf16 v[104:107], v[52:55], a[184:187], v[104:107]
  ds_read_b64_tr_b16 v[62:63], v2 offset:12544
  v_mfma_f32_16x16x32_bf16 v[76:79], v[52:55], a[180:183], v[76:79]
  ds_read_b128 a[196:199], v128 offset:34816
  v_mfma_f32_16x16x32_bf16 v[72:75], v[52:55], a[176:179], v[72:75]
  s_waitcnt lgkmcnt(4)
  buffer_load_dwordx4 v132, s[16:19], s40 offen offset:2048 sc1 lds
  v_mfma_f32_16x16x32_bf16 v[80:83], v[56:59], a[176:179], v[80:83]
  ds_read_b64_tr_b16 v[48:49], v1 offset:16384
  v_mfma_f32_16x16x32_bf16 v[84:87], v[56:59], a[180:183], v[84:87]
  ds_read_b64_tr_b16 v[50:51], v1 offset:16640
  v_mfma_f32_16x16x32_bf16 v[112:115], v[56:59], a[184:187], v[112:115]
  ds_read_b128 a[200:203], v128 offset:36864
  v_mfma_f32_16x16x32_bf16 v[116:119], v[56:59], a[188:191], v[116:119]
  s_waitcnt lgkmcnt(4)
  buffer_load_dwordx4 v133, s[16:19], s40 offen offset:3072 sc1 lds
  v_mfma_f32_16x16x32_bf16 v[124:127], v[60:63], a[188:191], v[124:127]
  ds_read_b64_tr_b16 v[52:53], v2 offset:16384
  s_add_u32 s40, s40, 128
  v_mfma_f32_16x16x32_bf16 v[120:123], v[60:63], a[184:187], v[120:123]
  ds_read_b64_tr_b16 v[54:55], v2 offset:16640
  s_add_u32 m0, s47, 131072
  v_mfma_f32_16x16x32_bf16 v[92:95], v[60:63], a[180:183], v[92:95]
  ds_read_b128 a[204:207], v128 offset:38912
  v_mfma_f32_16x16x32_bf16 v[88:91], v[60:63], a[176:179], v[88:91]
  s_waitcnt lgkmcnt(4)
  buffer_load_dwordx4 v5, s[20:23], s41 offen offset:0 sc1 lds
  v_mfma_f32_16x16x32_bf16 v[64:67], v[48:51], a[192:195], v[64:67]
  ds_read_b64_tr_b16 v[56:57], v1 offset:24576
  v_mfma_f32_16x16x32_bf16 v[68:71], v[48:51], a[196:199], v[68:71]
  ds_read_b64_tr_b16 v[58:59], v1 offset:24832
  s_waitcnt lgkmcnt(5)
  v_mfma_f32_16x16x32_bf16 v[96:99], v[48:51], a[200:203], v[96:99]
  ds_read_b128 a[208:211], v129 offset:32768
  s_waitcnt lgkmcnt(3)
  v_mfma_f32_16x16x32_bf16 v[100:103], v[48:51], a[204:207], v[100:103]
  buffer_load_dwordx4 v6, s[20:23], s41 offen offset:1024 sc1 lds
  v_mfma_f32_16x16x32_bf16 v[108:111], v[52:55], a[204:207], v[108:111]
  ds_read_b64_tr_b16 v[60:61], v2 offset:24576
  v_mfma_f32_16x16x32_bf16 v[104:107], v[52:55], a[200:203], v[104:107]
  ds_read_b64_tr_b16 v[62:63], v2 offset:24832
  v_mfma_f32_16x16x32_bf16 v[76:79], v[52:55], a[196:199], v[76:79]
  ds_read_b128 a[212:215], v129 offset:34816
  v_mfma_f32_16x16x32_bf16 v[72:75], v[52:55], a[192:195], v[72:75]
  s_waitcnt lgkmcnt(4)
  buffer_load_dwordx4 v7, s[20:23], s41 offen offset:2048 sc1 lds
  v_mfma_f32_16x16x32_bf16 v[80:83], v[56:59], a[192:195], v[80:83]
  ds_read_b64_tr_b16 v[48:49], v1 offset:20480
  v_mfma_f32_16x16x32_bf16 v[84:87], v[56:59], a[196:199], v[84:87]
  ds_read_b64_tr_b16 v[50:51], v1 offset:20736
  v_mfma_f32_16x16x32_bf16 v[112:115], v[56:59], a[200:203], v[112:115]
  ds_read_b128 a[216:219], v129 offset:36864
  v_mfma_f32_16x16x32_bf16 v[116:119], v[56:59], a[204:207], v[116:119]
  s_waitcnt lgkmcnt(4)
  buffer_load_dwordx4 v8, s[20:23], s41 offen offset:3072 sc1 lds
  v_mfma_f32_16x16x32_bf16 v[124:127], v[60:63], a[204:207], v[124:127]
  ds_read_b64_tr_b16 v[52:53], v2 offset:20480
  s_add_u32 s41, s41, s44
  v_mfma_f32_16x16x32_bf16 v[120:123], v[60:63], a[200:203], v[120:123]
  ds_read_b64_tr_b16 v[54:55], v2 offset:20736
  v_mfma_f32_16x16x32_bf16 v[92:95], v[60:63], a[196:199], v[92:95]
  ds_read_b128 a[220:223], v129 offset:38912
  v_mfma_f32_16x16x32_bf16 v[88:91], v[60:63], a[192:195], v[88:91]
  s_waitcnt lgkmcnt(4)
  s_waitcnt vmcnt(12)
  s_barrier
  s_add_u32 m0, s47, 16384
  v_mfma_f32_16x16x32_bf16 v[64:67], v[48:51], a[208:211], v[64:67]
  ds_read_b64_tr_b16 v[56:57], v1 offset:28672
  v_mfma_f32_16x16x32_bf16 v[68:71], v[48:51], a[212:215], v[68:71]
  ds_read_b64_tr_b16 v[58:59], v1 offset:28928
  buffer_load_dwordx4 v130, s[16:19], s40 offen offset:0 sc1 lds
  s_waitcnt lgkmcnt(5)
  v_mfma_f32_16x16x32_bf16 v[96:99], v[48:51], a[216:219], v[96:99]
  ds_read_b128 a[224:227], v128 offset:49152
  s_waitcnt lgkmcnt(3)
  v_mfma_f32_16x16x32_bf16 v[100:103], v[48:51], a[220:223], v[100:103]
  buffer_load_dwordx4 v131, s[16:19], s40 offen offset:1024 sc1 lds
  v_mfma_f32_16x16x32_bf16 v[108:111], v[52:55], a[220:223], v[108:111]
  ds_read_b64_tr_b16 v[60:61], v2 offset:28672
  v_mfma_f32_16x16x32_bf16 v[104:107], v[52:55], a[216:219], v[104:107]
  ds_read_b64_tr_b16 v[62:63], v2 offset:28928
  v_mfma_f32_16x16x32_bf16 v[76:79], v[52:55], a[212:215], v[76:79]
  ds_read_b128 a[228:231], v128 offset:51200
  v_mfma_f32_16x16x32_bf16 v[72:75], v[52:55], a[208:211], v[72:75]
  s_waitcnt lgkmcnt(4)
  buffer_load_dwordx4 v132, s[16:19], s40 offen offset:2048 sc1 lds
  v_mfma_f32_16x16x32_bf16 v[80:83], v[56:59], a[208:211], v[80:83]
  ds_read_b64_tr_b16 v[48:49], v1 offset:32768
  v_mfma_f32_16x16x32_bf16 v[84:87], v[56:59], a[212:215], v[84:87]
  ds_read_b64_tr_b16 v[50:51], v1 offset:33024
  v_mfma_f32_16x16x32_bf16 v[112:115], v[56:59], a[216:219], v[112:115]
  ds_read_b128 a[232:235], v128 offset:53248
  v_mfma_f32_16x16x32_bf16 v[116:119], v[56:59], a[220:223], v[116:119]
  s_waitcnt lgkmcnt(4)
  buffer_load_dwordx4 v133, s[16:19], s40 offen offset:3072 sc1 lds
  v_mfma_f32_16x16x32_bf16 v[124:127], v[60:63], a[220:223], v[124:127]
  ds_read_b64_tr_b16 v[52:53], v2 offset:32768
  s_add_u32 s40, s40, 128
  v_mfma_f32_16x16x32_bf16 v[120:123], v[60:63], a[216:219], v[120:123]
L_pad1:
  s_cbranch_execz L_pad3
  ds_read_b64_tr_b16 v[54:55], v2 offset:33024
  v_mul_u32_u24 v5, 3840, v18
  v_mfma_f32_16x16x32_bf16 v[92:95], v[60:63], a[212:215], v[92:95]
  ds_read_b128 a[236:239], v128 offset:55296
  s_movk_i32 s58, 29696
  v_mfma_f32_16x16x32_bf16 v[88:91], v[60:63], a[208:211], v[88:91]
  s_waitcnt lgkmcnt(4)
  v_add_u32 v5, v5, v19
  v_xor_b32 v6, 32, v5
  v_mfma_f32_16x16x32_bf16 v[64:67], v[48:51], a[224:227], v[64:67]
  ds_read_b64_tr_b16 v[56:57], v1 offset:40960
  v_add_u32 v6, s58, v6
  v_mfma_f32_16x16x32_bf16 v[68:71], v[48:51], a[228:231], v[68:71]
  ds_read_b64_tr_b16 v[58:59], v1 offset:41216
  s_lshl_b32 s58, s58, 1
  s_waitcnt lgkmcnt(5)
  v_mfma_f32_16x16x32_bf16 v[96:99], v[48:51], a[232:235], v[96:99]
  ds_read_b128 a[240:243], v129 offset:49152
  v_add_u32 v7, s58, v5
  s_waitcnt lgkmcnt(3)
  v_mfma_f32_16x16x32_bf16 v[100:103], v[48:51], a[236:239], v[100:103]
  v_add_u32 v8, s58, v6
  s_add_u32 m0, s47, 65536
  v_mfma_f32_16x16x32_bf16 v[108:111], v[52:55], a[236:239], v[108:111]
  ds_read_b64_tr_b16 v[60:61], v2 offset:40960
  v_mfma_f32_16x16x32_bf16 v[104:107], v[52:55], a[232:235], v[104:107]
  ds_read_b64_tr_b16 v[62:63], v2 offset:41216
  v_mfma_f32_16x16x32_bf16 v[76:79], v[52:55], a[228:231], v[76:79]
  ds_read_b128 a[244:247], v129 offset:51200
  v_mfma_f32_16x16x32_bf16 v[72:75], v[52:55], a[224:227], v[72:75]
  s_waitcnt lgkmcnt(4)
  buffer_load_dwordx4 v5, s[24:27], s42 offen offset:0 sc1 lds
  v_mfma_f32_16x16x32_bf16 v[80:83], v[56:59], a[224:227], v[80:83]
  ds_read_b64_tr_b16 v[48:49], v1 offset:36864
  v_mfma_f32_16x16x32_bf16 v[84:87], v[56:59], a[228:231], v[84:87]
  ds_read_b64_tr_b16 v[50:51], v1 offset:37120
  v_mfma_f32_16x16x32_bf16 v[112:115], v[56:59], a[232:235], v[112:115]
  ds_read_b128 a[248:251], v129 offset:53248
  v_mfma_f32_16x16x32_bf16 v[116:119], v[56:59], a[236:239], v[116:119]
  s_waitcnt lgkmcnt(4)
  buffer_load_dwordx4 v6, s[24:27], s42 offen offset:1024 sc1 lds
  v_mfma_f32_16x16x32_bf16 v[124:127], v[60:63], a[236:239], v[124:127]
  ds_read_b64_tr_b16 v[52:53], v2 offset:36864
  v_mfma_f32_16x16x32_bf16 v[120:123], v[60:63], a[232:235], v[120:123]
  ds_read_b64_tr_b16 v[54:55], v2 offset:37120
  v_mfma_f32_16x16x32_bf16 v[92:95], v[60:63], a[228:231], v[92:95]
  ds_read_b128 a[252:255], v129 offset:55296
  v_mfma_f32_16x16x32_bf16 v[88:91], v[60:63], a[224:227], v[88:91]
  s_waitcnt lgkmcnt(4)
  s_waitcnt vmcnt(10)
  s_barrier
  v_mfma_f32_16x16x32_bf16 v[64:67], v[48:51], a[240:243], v[64:67]
  ds_read_b64_tr_b16 v[56:57], v1 offset:45056
  v_mfma_f32_16x16x32_bf16 v[68:71], v[48:51], a[244:247], v[68:71]
  ds_read_b64_tr_b16 v[58:59], v1 offset:45312
  s_waitcnt lgkmcnt(5)
  v_mfma_f32_16x16x32_bf16 v[96:99], v[48:51], a[248:251], v[96:99]
  ds_read_b128 v[192:195], v128 offset:0
  s_waitcnt lgkmcnt(3)
  v_mfma_f32_16x16x32_bf16 v[100:103], v[48:51], a[252:255], v[100:103]
  buffer_load_dword v188, v186, s[28:31], 0 offen
  v_mfma_f32_16x16x32_bf16 v[108:111], v[52:55], a[252:255], v[108:111]
  ds_read_b64_tr_b16 v[60:61], v2 offset:45056
  v_mfma_f32_16x16x32_bf16 v[104:107], v[52:55], a[248:251], v[104:107]
  ds_read_b64_tr_b16 v[62:63], v2 offset:45312
  v_mfma_f32_16x16x32_bf16 v[76:79], v[52:55], a[244:247], v[76:79]
  ds_read_b128 v[196:199], v128 offset:2048
  v_mfma_f32_16x16x32_bf16 v[72:75], v[52:55], a[240:243], v[72:75]
  s_waitcnt lgkmcnt(4)
  buffer_load_dwordx4 v7, s[24:27], s42 offen offset:2048 sc1 lds
  v_mfma_f32_16x16x32_bf16 v[80:83], v[56:59], a[240:243], v[80:83]
  ds_read_b64_tr_b16 v[48:49], v1 offset:49152
  v_mfma_f32_16x16x32_bf16 v[84:87], v[56:59], a[244:247], v[84:87]
  ds_read_b64_tr_b16 v[50:51], v1 offset:49408
  v_mfma_f32_16x16x32_bf16 v[112:115], v[56:59], a[248:251], v[112:115]
  ds_read_b128 v[200:203], v128 offset:4096
  v_mfma_f32_16x16x32_bf16 v[116:119], v[56:59], a[252:255], v[116:119]
  s_waitcnt lgkmcnt(4)
  buffer_load_dwordx4 v8, s[24:27], s42 offen offset:3072 sc1 lds
  v_mfma_f32_16x16x32_bf16 v[124:127], v[60:63], a[252:255], v[124:127]
  ds_read_b64_tr_b16 v[52:53], v2 offset:49152
  s_add_u32 s42, s42, s45
  v_mfma_f32_16x16x32_bf16 v[120:123], v[60:63], a[248:251], v[120:123]
  ds_read_b64_tr_b16 v[54:55], v2 offset:49408
  s_add_u32 m0, s47, 81920
  v_mfma_f32_16x16x32_bf16 v[92:95], v[60:63], a[244:247], v[92:95]
  ds_read_b128 v[204:207], v128 offset:6144
  v_mfma_f32_16x16x32_bf16 v[88:91], v[60:63], a[240:243], v[88:91]
  s_waitcnt lgkmcnt(4)
  buffer_load_dwordx4 v5, s[24:27], s42 offen offset:0 sc1 lds
  v_mfma_f32_16x16x32_bf16 v[64:67], v[48:51], v[192:195], v[64:67]
  ds_read_b64_tr_b16 v[56:57], v1 offset:57344
  v_mfma_f32_16x16x32_bf16 v[68:71], v[48:51], v[196:199], v[68:71]
  ds_read_b64_tr_b16 v[58:59], v1 offset:57600
  s_waitcnt lgkmcnt(5)
  v_mfma_f32_16x16x32_bf16 v[96:99], v[48:51], v[200:203], v[96:99]
  ds_read_b128 v[208:211], v129 offset:0
  s_waitcnt lgkmcnt(3)
  v_mfma_f32_16x16x32_bf16 v[100:103], v[48:51], v[204:207], v[100:103]
  buffer_load_dwordx4 v6, s[24:27], s42 offen offset:1024 sc1 lds
  v_mfma_f32_16x16x32_bf16 v[108:111], v[52:55], v[204:207], v[108:111]
  ds_read_b64_tr_b16 v[60:61], v2 offset:57344
  v_mfma_f32_16x16x32_bf16 v[104:107], v[52:55], v[200:203], v[104:107]
  ds_read_b64_tr_b16 v[62:63], v2 offset:57600
  v_mfma_f32_16x16x32_bf16 v[76:79], v[52:55], v[196:199], v[76:79]
  ds_read_b128 v[212:215], v129 offset:2048
  v_mfma_f32_16x16x32_bf16 v[72:75], v[52:55], v[192:195], v[72:75]
  s_waitcnt lgkmcnt(4)
  buffer_load_dwordx4 v7, s[24:27], s42 offen offset:2048 sc1 lds
  v_mfma_f32_16x16x32_bf16 v[80:83], v[56:59], v[192:195], v[80:83]
  ds_read_b64_tr_b16 v[48:49], v1 offset:53248
  v_mfma_f32_16x16x32_bf16 v[84:87], v[56:59], v[196:199], v[84:87]
  ds_read_b64_tr_b16 v[50:51], v1 offset:53504
  v_mfma_f32_16x16x32_bf16 v[112:115], v[56:59], v[200:203], v[112:115]
  ds_read_b128 v[216:219], v129 offset:4096
  v_mfma_f32_16x16x32_bf16 v[116:119], v[56:59], v[204:207], v[116:119]
  s_waitcnt lgkmcnt(4)
  buffer_load_dwordx4 v8, s[24:27], s42 offen offset:3072 sc1 lds
  v_mfma_f32_16x16x32_bf16 v[124:127], v[60:63], v[204:207], v[124:127]
  ds_read_b64_tr_b16 v[52:53], v2 offset:53248
  s_add_u32 s42, s42, s45
  v_mfma_f32_16x16x32_bf16 v[120:123], v[60:63], v[200:203], v[120:123]
  ds_read_b64_tr_b16 v[54:55], v2 offset:53504
  v_mfma_f32_16x16x32_bf16 v[92:95], v[60:63], v[196:199], v[92:95]
  ds_read_b128 v[220:223], v129 offset:6144
  v_mfma_f32_16x16x32_bf16 v[88:91], v[60:63], v[192:195], v[88:91]
  s_waitcnt lgkmcnt(4)
  s_waitcnt vmcnt(9)
  s_barrier
  s_add_u32 m0, s47, 98304
  v_mfma_f32_16x16x32_bf16 v[64:67], v[48:51], v[208:211], v[64:67]
  ds_read_b64_tr_b16 v[56:57], v1 offset:61440
  v_mfma_f32_16x16x32_bf16 v[68:71], v[48:51], v[212:215], v[68:71]
  ds_read_b64_tr_b16 v[58:59], v1 offset:61696
  buffer_load_dwordx4 v5, s[24:27], s42 offen offset:0 sc1 lds
  s_waitcnt lgkmcnt(5)
  v_mfma_f32_16x16x32_bf16 v[96:99], v[48:51], v[216:219], v[96:99]
  ds_read_b128 v[224:227], v128 offset:16384
  s_waitcnt lgkmcnt(3)
  v_mfma_f32_16x16x32_bf16 v[100:103], v[48:51], v[220:223], v[100:103]
  buffer_load_dwordx4 v6, s[24:27], s42 offen offset:1024 sc1 lds
  v_mfma_f32_16x16x32_bf16 v[108:111], v[52:55], v[220:223], v[108:111]
  ds_read_b64_tr_b16 v[60:61], v2 offset:61440
  v_mfma_f32_16x16x32_bf16 v[104:107], v[52:55], v[216:219], v[104:107]
  ds_read_b64_tr_b16 v[62:63], v2 offset:61696
  v_mfma_f32_16x16x32_bf16 v[76:79], v[52:55], v[212:215], v[76:79]
  ds_read_b128 v[228:231], v128 offset:18432
  v_mfma_f32_16x16x32_bf16 v[72:75], v[52:55], v[208:211], v[72:75]
  s_waitcnt lgkmcnt(4)
  buffer_load_dwordx4 v7, s[24:27], s42 offen offset:2048 sc1 lds
  v_mfma_f32_16x16x32_bf16 v[80:83], v[56:59], v[208:211], v[80:83]
  ds_read_b64_tr_b16 v[48:49], v3 offset:0
  v_mfma_f32_16x16x32_bf16 v[84:87], v[56:59], v[212:215], v[84:87]
  ds_read_b64_tr_b16 v[50:51], v3 offset:256
  v_mfma_f32_16x16x32_bf16 v[112:115], v[56:59], v[216:219], v[112:115]
  ds_read_b128 v[232:235], v128 offset:20480
  v_mfma_f32_16x16x32_bf16 v[116:119], v[56:59], v[220:223], v[116:119]
  s_waitcnt lgkmcnt(4)
  buffer_load_dwordx4 v8, s[24:27], s42 offen offset:3072 sc1 lds
  v_mfma_f32_16x16x32_bf16 v[124:127], v[60:63], v[220:223], v[124:127]
  ds_read_b64_tr_b16 v[52:53], v4 offset:0
  s_add_u32 s42, s42, s45
  v_mfma_f32_16x16x32_bf16 v[120:123], v[60:63], v[216:219], v[120:123]
  ds_read_b64_tr_b16 v[54:55], v4 offset:256
  s_add_u32 s60, s85, 2
  v_mfma_f32_16x16x32_bf16 v[92:95], v[60:63], v[212:215], v[92:95]
  ds_read_b128 v[236:239], v128 offset:22528
  v_mov_b32 v44, s60
  v_mfma_f32_16x16x32_bf16 v[88:91], v[60:63], v[208:211], v[88:91]
  s_waitcnt lgkmcnt(4)
  v_lshrrev_b32 v45, 7, v13
  v_lshlrev_b32 v45, 2, v45
  v_mfma_f32_16x16x32_bf16 v[64:67], v[48:51], v[224:227], v[64:67]
  ds_read_b64_tr_b16 v[56:57], v3 offset:8192
  v_add_u32 v45, 0x8000, v45
  v_mfma_f32_16x16x32_bf16 v[68:71], v[48:51], v[228:231], v[68:71]
  ds_read_b64_tr_b16 v[58:59], v3 offset:8448
  s_waitcnt lgkmcnt(5)
  v_mfma_f32_16x16x32_bf16 v[96:99], v[48:51], v[232:235], v[96:99]
  ds_read_b128 v[240:243], v129 offset:16384
  s_waitcnt lgkmcnt(3)
  v_mfma_f32_16x16x32_bf16 v[100:103], v[48:51], v[236:239], v[100:103]
  buffer_store_dword v44, v45, s[12:15], 0 offen sc1
  v_mfma_f32_16x16x32_bf16 v[108:111], v[52:55], v[236:239], v[108:111]
  ds_read_b64_tr_b16 v[60:61], v4 offset:8192
  v_mfma_f32_16x16x32_bf16 v[104:107], v[52:55], v[232:235], v[104:107]
  ds_read_b64_tr_b16 v[62:63], v4 offset:8448
  v_mfma_f32_16x16x32_bf16 v[76:79], v[52:55], v[228:231], v[76:79]
  ds_read_b128 v[244:247], v129 offset:18432
  v_mfma_f32_16x16x32_bf16 v[72:75], v[52:55], v[224:227], v[72:75]
  s_waitcnt lgkmcnt(4)
  v_mfma_f32_16x16x32_bf16 v[80:83], v[56:59], v[224:227], v[80:83]
  ds_read_b64_tr_b16 v[48:49], v3 offset:4096
  v_mfma_f32_16x16x32_bf16 v[84:87], v[56:59], v[228:231], v[84:87]
  ds_read_b64_tr_b16 v[50:51], v3 offset:4352
  v_mfma_f32_16x16x32_bf16 v[112:115], v[56:59], v[232:235], v[112:115]
  ds_read_b128 v[248:251], v129 offset:20480
  v_mfma_f32_16x16x32_bf16 v[116:119], v[56:59], v[236:239], v[116:119]
  s_waitcnt lgkmcnt(4)
  v_mfma_f32_16x16x32_bf16 v[124:127], v[60:63], v[236:239], v[124:127]
  ds_read_b64_tr_b16 v[52:53], v4 offset:4096
  v_mfma_f32_16x16x32_bf16 v[120:123], v[60:63], v[232:235], v[120:123]
  ds_read_b64_tr_b16 v[54:55], v4 offset:4352
  v_mfma_f32_16x16x32_bf16 v[92:95], v[60:63], v[228:231], v[92:95]
  ds_read_b128 v[252:255], v129 offset:22528
  v_mfma_f32_16x16x32_bf16 v[88:91], v[60:63], v[224:227], v[88:91]
  s_waitcnt lgkmcnt(4)
  v_mfma_f32_16x16x32_bf16 v[64:67], v[48:51], v[240:243], v[64:67]
  ds_read_b64_tr_b16 v[56:57], v3 offset:12288
  v_mfma_f32_16x16x32_bf16 v[68:71], v[48:51], v[244:247], v[68:71]
  ds_read_b64_tr_b16 v[58:59], v3 offset:12544
  s_waitcnt lgkmcnt(5)
  v_mfma_f32_16x16x32_bf16 v[96:99], v[48:51], v[248:251], v[96:99]
  s_waitcnt lgkmcnt(2)
  v_mfma_f32_16x16x32_bf16 v[100:103], v[48:51], v[252:255], v[100:103]
  v_mfma_f32_16x16x32_bf16 v[108:111], v[52:55], v[252:255], v[108:111]
  ds_read_b64_tr_b16 v[60:61], v4 offset:12288
  v_mfma_f32_16x16x32_bf16 v[104:107], v[52:55], v[248:251], v[104:107]
  ds_read_b64_tr_b16 v[62:63], v4 offset:12544
  v_mfma_f32_16x16x32_bf16 v[76:79], v[52:55], v[244:247], v[76:79]
  v_mfma_f32_16x16x32_bf16 v[72:75], v[52:55], v[240:243], v[72:75]
  s_waitcnt lgkmcnt(2)
  s_waitcnt vmcnt(9)
  s_barrier
  s_add_u32 m0, s47, 114688
  v_mfma_f32_16x16x32_bf16 v[80:83], v[56:59], v[240:243], v[80:83]
  ds_read_b64_tr_b16 v[48:49], v1 offset:0
  v_mfma_f32_16x16x32_bf16 v[84:87], v[56:59], v[244:247], v[84:87]
  ds_read_b64_tr_b16 v[50:51], v1 offset:256
  v_mfma_f32_16x16x32_bf16 v[112:115], v[56:59], v[248:251], v[112:115]
  buffer_load_dwordx4 v5, s[24:27], s42 offen offset:0 sc1 lds
  v_mfma_f32_16x16x32_bf16 v[116:119], v[56:59], v[252:255], v[116:119]
  s_waitcnt lgkmcnt(2)
  v_mfma_f32_16x16x32_bf16 v[124:127], v[60:63], v[252:255], v[124:127]
  ds_read_b64_tr_b16 v[52:53], v2 offset:0
  v_mfma_f32_16x16x32_bf16 v[120:123], v[60:63], v[248:251], v[120:123]
  ds_read_b64_tr_b16 v[54:55], v2 offset:256
  v_mfma_f32_16x16x32_bf16 v[92:95], v[60:63], v[244:247], v[92:95]
  buffer_load_dwordx4 v6, s[24:27], s42 offen offset:1024 sc1 lds
  v_mfma_f32_16x16x32_bf16 v[88:91], v[60:63], v[240:243], v[88:91]
  s_waitcnt lgkmcnt(2)
  s_cmp_eq_u32 s57, 0
  s_cbranch_scc0 L_typeB
  v_mfma_f32_16x16x32_bf16 v[128:131], v[48:51], a[0:3], 0
  ds_read_b64_tr_b16 v[56:57], v1 offset:4096
  v_mfma_f32_16x16x32_bf16 v[132:135], v[48:51], a[4:7], 0
  ds_read_b64_tr_b16 v[58:59], v1 offset:4352
  v_mfma_f32_16x16x32_bf16 v[144:147], v[48:51], a[8:11], 0
  buffer_load_dwordx4 v7, s[24:27], s42 offen offset:2048 sc1 lds
  v_mfma_f32_16x16x32_bf16 v[148:151], v[48:51], a[12:15], 0
  s_waitcnt lgkmcnt(2)
  v_mfma_f32_16x16x32_bf16 v[156:159], v[52:55], a[12:15], 0
  ds_read_b64_tr_b16 v[60:61], v2 offset:4096
  v_fma_f32 v36, -v64, v64, v11
  v_mfma_f32_16x16x32_bf16 v[152:155], v[52:55], a[8:11], 0
  ds_read_b64_tr_b16 v[62:63], v2 offset:4352
  v_fma_f32 v37, -v65, v65, v11
  v_mfma_f32_16x16x32_bf16 v[140:143], v[52:55], a[4:7], 0
  buffer_load_dwordx4 v8, s[24:27], s42 offen offset:3072 sc1 lds
  v_mfma_f32_16x16x32_bf16 v[136:139], v[52:55], a[0:3], 0
  s_waitcnt lgkmcnt(2)
  s_add_u32 s42, s42, s45
  v_fma_f32 v38, -v66, v66, v11
  v_mfma_f32_16x16x32_bf16 v[128:131], v[56:59], a[16:19], v[128:131]
  ds_read_b64_tr_b16 v[48:49], v1 offset:8192
  v_fma_f32 v39, -v67, v67, v11
  v_mfma_f32_16x16x32_bf16 v[132:135], v[56:59], a[20:23], v[132:135]
  ds_read_b64_tr_b16 v[50:51], v1 offset:8448
  v_mul_f32 v36, v36, v64
  v_mfma_f32_16x16x32_bf16 v[144:147], v[56:59], a[24:27], v[144:147]
  v_exp_f32 v36, v36
  v_mfma_f32_16x16x32_bf16 v[148:151], v[56:59], a[28:31], v[148:151]
  s_waitcnt lgkmcnt(2)
  v_mul_f32 v37, v37, v65
  v_mul_f32 v38, v38, v66
  v_mfma_f32_16x16x32_bf16 v[156:159], v[60:63], a[28:31], v[156:159]
  ds_read_b64_tr_b16 v[52:53], v2 offset:8192
  v_mul_f32 v39, v39, v67
  v_mfma_f32_16x16x32_bf16 v[152:155], v[60:63], a[24:27], v[152:155]
  ds_read_b64_tr_b16 v[54:55], v2 offset:8448
  v_mul_f32 v80, v64, v80
  v_mfma_f32_16x16x32_bf16 v[140:143], v[60:63], a[20:23], v[140:143]
  v_exp_f32 v37, v37
  v_mfma_f32_16x16x32_bf16 v[136:139], v[60:63], a[16:19], v[136:139]
  s_waitcnt lgkmcnt(2)
  v_exp_f32 v38, v38
  v_mfma_f32_16x16x32_bf16 v[128:131], v[48:51], a[32:35], v[128:131]
  ds_read_b64_tr_b16 v[56:57], v1 offset:12288
  v_mul_f32 v81, v65, v81
  v_mfma_f32_16x16x32_bf16 v[132:135], v[48:51], a[36:39], v[132:135]
  ds_read_b64_tr_b16 v[58:59], v1 offset:12544
  v_mul_f32 v82, v66, v82
  v_mfma_f32_16x16x32_bf16 v[144:147], v[48:51], a[40:43], v[144:147]
  v_exp_f32 v39, v39
  v_mfma_f32_16x16x32_bf16 v[148:151], v[48:51], a[44:47], v[148:151]
  s_waitcnt lgkmcnt(2)
  v_mul_f32 v83, v67, v83
  v_fma_f32 v36, v36, v12, v12
  v_mfma_f32_16x16x32_bf16 v[156:159], v[52:55], a[44:47], v[156:159]
  ds_read_b64_tr_b16 v[60:61], v2 offset:12288
  v_fma_f32 v37, v37, v12, v12
  v_mfma_f32_16x16x32_bf16 v[152:155], v[52:55], a[40:43], v[152:155]
  ds_read_b64_tr_b16 v[62:63], v2 offset:12544
  v_fma_f32 v38, v38, v12, v12
  v_mfma_f32_16x16x32_bf16 v[140:143], v[52:55], a[36:39], v[140:143]
  v_rcp_f32 v36, v36
  v_mfma_f32_16x16x32_bf16 v[136:139], v[52:55], a[32:35], v[136:139]
  s_waitcnt lgkmcnt(2)
  s_waitcnt vmcnt(9)
  s_barrier
  s_add_u32 m0, s47, 131072
  v_mfma_f32_16x16x32_bf16 v[128:131], v[56:59], a[48:51], v[128:131]
  ds_read_b64_tr_b16 v[48:49], v1 offset:16384
  v_fma_f32 v39, v39, v12, v12
  v_mfma_f32_16x16x32_bf16 v[132:135], v[56:59], a[52:55], v[132:135]
  ds_read_b64_tr_b16 v[50:51], v1 offset:16640
  v_mul_f32 v80, v80, v36
  v_mfma_f32_16x16x32_bf16 v[144:147], v[56:59], a[56:59], v[144:147]
  buffer_load_dwordx4 v5, s[24:27], s42 offen offset:0 sc1 lds
  v_mfma_f32_16x16x32_bf16 v[148:151], v[56:59], a[60:63], v[148:151]
  s_waitcnt lgkmcnt(2)
  v_rcp_f32 v37, v37
  v_mfma_f32_16x16x32_bf16 v[156:159], v[60:63], a[60:63], v[156:159]
  ds_read_b64_tr_b16 v[52:53], v2 offset:16384
  v_mul_f32 v81, v81, v37
  v_mfma_f32_16x16x32_bf16 v[152:155], v[60:63], a[56:59], v[152:155]
  ds_read_b64_tr_b16 v[54:55], v2 offset:16640
  v_cvt_pk_bf16_f32 v20, v80, v81
  v_mfma_f32_16x16x32_bf16 v[140:143], v[60:63], a[52:55], v[140:143]
  buffer_load_dwordx4 v6, s[24:27], s42 offen offset:1024 sc1 lds
  v_mfma_f32_16x16x32_bf16 v[136:139], v[60:63], a[48:51], v[136:139]
  s_waitcnt lgkmcnt(2)
  v_rcp_f32 v38, v38
  v_mfma_f32_16x16x32_bf16 v[128:131], v[48:51], a[64:67], v[128:131]
  ds_read_b64_tr_b16 v[56:57], v1 offset:20480
  v_mul_f32 v82, v82, v38
  v_mfma_f32_16x16x32_bf16 v[132:135], v[48:51], a[68:71], v[132:135]
  ds_read_b64_tr_b16 v[58:59], v1 offset:20736
  v_fma_f32 v40, -v72, v72, v11
  v_mfma_f32_16x16x32_bf16 v[144:147], v[48:51], a[72:75], v[144:147]
  buffer_load_dwordx4 v7, s[24:27], s42 offen offset:2048 sc1 lds
  v_mfma_f32_16x16x32_bf16 v[148:151], v[48:51], a[76:79], v[148:151]
  s_waitcnt lgkmcnt(2)
  v_rcp_f32 v39, v39
  v_mfma_f32_16x16x32_bf16 v[156:159], v[52:55], a[76:79], v[156:159]
  ds_read_b64_tr_b16 v[60:61], v2 offset:20480
  v_mul_f32 v83, v83, v39
  v_mfma_f32_16x16x32_bf16 v[152:155], v[52:55], a[72:75], v[152:155]
  ds_read_b64_tr_b16 v[62:63], v2 offset:20736
  v_cvt_pk_bf16_f32 v21, v82, v83
  v_mfma_f32_16x16x32_bf16 v[140:143], v[52:55], a[68:71], v[140:143]
  buffer_load_dwordx4 v8, s[24:27], s42 offen offset:3072 sc1 lds
  v_mfma_f32_16x16x32_bf16 v[136:139], v[52:55], a[64:67], v[136:139]
  s_waitcnt lgkmcnt(2)
  s_add_u32 s42, s42, s45
  v_mul_u32_u24 v5, 3072, v18
  v_mfma_f32_16x16x32_bf16 v[128:131], v[56:59], a[80:83], v[128:131]
  ds_read_b64_tr_b16 v[48:49], v1 offset:24576
  s_movk_i32 s58, 23552
  v_mfma_f32_16x16x32_bf16 v[132:135], v[56:59], a[84:87], v[132:135]
  ds_read_b64_tr_b16 v[50:51], v1 offset:24832
  v_add_u32 v5, v5, v19
  v_mfma_f32_16x16x32_bf16 v[144:147], v[56:59], a[88:91], v[144:147]
  v_xor_b32 v6, 32, v5
  v_add_u32 v6, s58, v6
  v_mfma_f32_16x16x32_bf16 v[148:151], v[56:59], a[92:95], v[148:151]
  s_waitcnt lgkmcnt(2)
  s_lshl_b32 s58, s58, 1
  v_add_u32 v7, s58, v5
  v_mfma_f32_16x16x32_bf16 v[156:159], v[60:63], a[92:95], v[156:159]
  ds_read_b64_tr_b16 v[52:53], v2 offset:24576
  v_add_u32 v8, s58, v6
  v_mfma_f32_16x16x32_bf16 v[152:155], v[60:63], a[88:91], v[152:155]
  ds_read_b64_tr_b16 v[54:55], v2 offset:24832
  s_add_u32 m0, s47, 0
  v_mfma_f32_16x16x32_bf16 v[140:143], v[60:63], a[84:87], v[140:143]
  buffer_load_dwordx4 v5, s[28:31], s43 offen offset:0 sc1 lds
  v_mfma_f32_16x16x32_bf16 v[136:139], v[60:63], a[80:83], v[136:139]
  s_waitcnt lgkmcnt(2)
  v_fma_f32 v41, -v73, v73, v11
  v_fma_f32 v42, -v74, v74, v11
  v_mfma_f32_16x16x32_bf16 v[128:131], v[48:51], a[96:99], v[128:131]
  ds_read_b64_tr_b16 v[56:57], v1 offset:28672
  v_fma_f32 v43, -v75, v75, v11
  v_mfma_f32_16x16x32_bf16 v[132:135], v[48:51], a[100:103], v[132:135]
  ds_read_b64_tr_b16 v[58:59], v1 offset:28928
  v_mul_f32 v40, v40, v72
  v_mfma_f32_16x16x32_bf16 v[144:147], v[48:51], a[104:107], v[144:147]
  buffer_load_dwordx4 v6, s[28:31], s43 offen offset:1024 sc1 lds
  v_mfma_f32_16x16x32_bf16 v[148:151], v[48:51], a[108:111], v[148:151]
  s_waitcnt lgkmcnt(2)
  v_exp_f32 v40, v40
  v_mfma_f32_16x16x32_bf16 v[156:159], v[52:55], a[108:111], v[156:159]
  ds_read_b64_tr_b16 v[60:61], v2 offset:28672
  v_mul_f32 v41, v41, v73
  v_mfma_f32_16x16x32_bf16 v[152:155], v[52:55], a[104:107], v[152:155]
  ds_read_b64_tr_b16 v[62:63], v2 offset:28928
  v_mul_f32 v42, v42, v74
  v_mfma_f32_16x16x32_bf16 v[140:143], v[52:55], a[100:103], v[140:143]
  buffer_load_dwordx4 v7, s[28:31], s43 offen offset:2048 sc1 lds
  v_mfma_f32_16x16x32_bf16 v[136:139], v[52:55], a[96:99], v[136:139]
  s_waitcnt lgkmcnt(2)
  s_waitcnt vmcnt(12)
  s_barrier
  v_mfma_f32_16x16x32_bf16 v[128:131], v[56:59], a[112:115], v[128:131]
  ds_read_b64_tr_b16 v[48:49], v1 offset:32768
  v_mul_f32 v43, v43, v75
  v_mfma_f32_16x16x32_bf16 v[132:135], v[56:59], a[116:119], v[132:135]
  ds_read_b64_tr_b16 v[50:51], v1 offset:33024
  v_mul_f32 v88, v72, v88
  v_mfma_f32_16x16x32_bf16 v[144:147], v[56:59], a[120:123], v[144:147]
  buffer_load_dwordx4 v8, s[28:31], s43 offen offset:3072 sc1 lds
  v_mfma_f32_16x16x32_bf16 v[148:151], v[56:59], a[124:127], v[148:151]
  s_waitcnt lgkmcnt(2)
  s_add_u32 s43, s43, s46
  s_add_u32 m0, s47, 16384
  v_mfma_f32_16x16x32_bf16 v[156:159], v[60:63], a[124:127], v[156:159]
  ds_read_b64_tr_b16 v[52:53], v2 offset:32768
  v_mul_f32 v89, v73, v89
  v_mfma_f32_16x16x32_bf16 v[152:155], v[60:63], a[120:123], v[152:155]
  ds_read_b64_tr_b16 v[54:55], v2 offset:33024
  v_mul_f32 v90, v74, v90
  v_mfma_f32_16x16x32_bf16 v[140:143], v[60:63], a[116:119], v[140:143]
  buffer_load_dwordx4 v5, s[28:31], s43 offen offset:0 sc1 lds
  v_mfma_f32_16x16x32_bf16 v[136:139], v[60:63], a[112:115], v[136:139]
  s_waitcnt lgkmcnt(2)
  v_exp_f32 v41, v41
  v_mfma_f32_16x16x32_bf16 v[128:131], v[48:51], a[128:131], v[128:131]
  ds_read_b64_tr_b16 v[56:57], v1 offset:36864
  v_mul_f32 v91, v75, v91
  v_mfma_f32_16x16x32_bf16 v[132:135], v[48:51], a[132:135], v[132:135]
  ds_read_b64_tr_b16 v[58:59], v1 offset:37120
  v_fma_f32 v40, v40, v12, v12
  v_mfma_f32_16x16x32_bf16 v[144:147], v[48:51], a[136:139], v[144:147]
  v_exp_f32 v42, v42
  v_mfma_f32_16x16x32_bf16 v[148:151], v[48:51], a[140:143], v[148:151]
  s_waitcnt lgkmcnt(2)
  buffer_load_dwordx4 v6, s[28:31], s43 offen offset:1024 sc1 lds
  v_mfma_f32_16x16x32_bf16 v[156:159], v[52:55], a[140:143], v[156:159]
  ds_read_b64_tr_b16 v[60:61], v2 offset:36864
  v_fma_f32 v41, v41, v12, v12
  v_mfma_f32_16x16x32_bf16 v[152:155], v[52:55], a[136:139], v[152:155]
  ds_read_b64_tr_b16 v[62:63], v2 offset:37120
  v_fma_f32 v42, v42, v12, v12
  v_mfma_f32_16x16x32_bf16 v[140:143], v[52:55], a[132:135], v[140:143]
  v_exp_f32 v43, v43
  v_mfma_f32_16x16x32_bf16 v[136:139], v[52:55], a[128:131], v[136:139]
  s_waitcnt lgkmcnt(2)
  buffer_load_dwordx4 v7, s[28:31], s43 offen offset:2048 sc1 lds
  v_mfma_f32_16x16x32_bf16 v[128:131], v[56:59], a[144:147], v[128:131]
  ds_read_b64_tr_b16 v[48:49], v1 offset:40960
  v_fma_f32 v43, v43, v12, v12
  v_mfma_f32_16x16x32_bf16 v[132:135], v[56:59], a[148:151], v[132:135]
  ds_read_b64_tr_b16 v[50:51], v1 offset:41216
  v_fma_f32 v36, -v68, v68, v11
  v_mfma_f32_16x16x32_bf16 v[144:147], v[56:59], a[152:155], v[144:147]
  v_rcp_f32 v40, v40
  v_mfma_f32_16x16x32_bf16 v[148:151], v[56:59], a[156:159], v[148:151]
  s_waitcnt lgkmcnt(2)
  buffer_load_dwordx4 v8, s[28:31], s43 offen offset:3072 sc1 lds
  v_mfma_f32_16x16x32_bf16 v[156:159], v[60:63], a[156:159], v[156:159]
  ds_read_b64_tr_b16 v[52:53], v2 offset:40960
  s_add_u32 s43, s43, s46
  v_mfma_f32_16x16x32_bf16 v[152:155], v[60:63], a[152:155], v[152:155]
  ds_read_b64_tr_b16 v[54:55], v2 offset:41216
  s_add_u32 m0, s47, 32768
  v_mfma_f32_16x16x32_bf16 v[140:143], v[60:63], a[148:151], v[140:143]
  v_rcp_f32 v41, v41
  v_mfma_f32_16x16x32_bf16 v[136:139], v[60:63], a[144:147], v[136:139]
  s_waitcnt lgkmcnt(2)
  v_rcp_f32 v42, v42
  v_mfma_f32_16x16x32_bf16 v[128:131], v[48:51], a[160:163], v[128:131]
  ds_read_b64_tr_b16 v[56:57], v1 offset:45056
  v_mul_f32 v88, v88, v40
  v_mfma_f32_16x16x32_bf16 v[132:135], v[48:51], a[164:167], v[132:135]
  ds_read_b64_tr_b16 v[58:59], v1 offset:45312
  v_mul_f32 v89, v89, v41
  v_mfma_f32_16x16x32_bf16 v[144:147], v[48:51], a[168:171], v[144:147]
  buffer_load_dwordx4 v5, s[28:31], s43 offen offset:0 sc1 lds
  v_mfma_f32_16x16x32_bf16 v[148:151], v[48:51], a[172:175], v[148:151]
  s_waitcnt lgkmcnt(2)
  v_rcp_f32 v43, v43
  v_mfma_f32_16x16x32_bf16 v[156:159], v[52:55], a[172:175], v[156:159]
  ds_read_b64_tr_b16 v[60:61], v2 offset:45056
  v_mul_f32 v90, v90, v42
  v_mfma_f32_16x16x32_bf16 v[152:155], v[52:55], a[168:171], v[152:155]
  ds_read_b64_tr_b16 v[62:63], v2 offset:45312
  v_mul_f32 v91, v91, v43
  v_mfma_f32_16x16x32_bf16 v[140:143], v[52:55], a[164:167], v[140:143]
  buffer_load_dwordx4 v6, s[28:31], s43 offen offset:1024 sc1 lds
  v_mfma_f32_16x16x32_bf16 v[136:139], v[52:55], a[160:163], v[136:139]
  s_waitcnt lgkmcnt(2)
  s_waitcnt vmcnt(14)
  s_barrier
  v_mfma_f32_16x16x32_bf16 v[128:131], v[56:59], a[176:179], v[128:131]
  ds_read_b64_tr_b16 v[48:49], v1 offset:49152
  v_lshlrev_b32 v16, 2, v0
  v_mfma_f32_16x16x32_bf16 v[132:135], v[56:59], a[180:183], v[132:135]
  ds_read_b64_tr_b16 v[50:51], v1 offset:49408
  v_add_u32 v16, 0x8000, v16
  v_mfma_f32_16x16x32_bf16 v[144:147], v[56:59], a[184:187], v[144:147]
  s_mov_b32 s0, 0
  buffer_load_dword v15, v16, s[12:15], s0 offen sc1
  v_mfma_f32_16x16x32_bf16 v[148:151], v[56:59], a[188:191], v[148:151]
  s_waitcnt lgkmcnt(2)
  v_cvt_pk_bf16_f32 v22, v88, v89
  v_cvt_pk_bf16_f32 v23, v90, v91
  v_mfma_f32_16x16x32_bf16 v[156:159], v[60:63], a[188:191], v[156:159]
  ds_read_b64_tr_b16 v[52:53], v2 offset:49152
  v_fma_f32 v37, -v69, v69, v11
  v_mfma_f32_16x16x32_bf16 v[152:155], v[60:63], a[184:187], v[152:155]
  ds_read_b64_tr_b16 v[54:55], v2 offset:49408
  v_fma_f32 v38, -v70, v70, v11
  v_mfma_f32_16x16x32_bf16 v[140:143], v[60:63], a[180:183], v[140:143]
  buffer_load_dwordx4 v7, s[28:31], s43 offen offset:2048 sc1 lds
  v_mfma_f32_16x16x32_bf16 v[136:139], v[60:63], a[176:179], v[136:139]
  s_waitcnt lgkmcnt(2)
  buffer_store_dwordx4 v[20:23], v10, s[36:39], s55 offen offset:0 sc1
  v_mfma_f32_16x16x32_bf16 v[128:131], v[48:51], a[192:195], v[128:131]
  ds_read_b64_tr_b16 v[56:57], v1 offset:53248
  v_fma_f32 v39, -v71, v71, v11
  v_mfma_f32_16x16x32_bf16 v[132:135], v[48:51], a[196:199], v[132:135]
  ds_read_b64_tr_b16 v[58:59], v1 offset:53504
  v_mul_f32 v36, v36, v68
  v_mfma_f32_16x16x32_bf16 v[144:147], v[48:51], a[200:203], v[144:147]
  v_exp_f32 v36, v36
  v_mfma_f32_16x16x32_bf16 v[148:151], v[48:51], a[204:207], v[148:151]
  s_waitcnt lgkmcnt(2)
  v_mul_f32 v37, v37, v69
  v_mul_f32 v38, v38, v70
  v_mfma_f32_16x16x32_bf16 v[156:159], v[52:55], a[204:207], v[156:159]
  ds_read_b64_tr_b16 v[60:61], v2 offset:53248
  v_mul_f32 v39, v39, v71
  v_mfma_f32_16x16x32_bf16 v[152:155], v[52:55], a[200:203], v[152:155]
  ds_read_b64_tr_b16 v[62:63], v2 offset:53504
  v_mul_f32 v84, v68, v84
  v_mfma_f32_16x16x32_bf16 v[140:143], v[52:55], a[196:199], v[140:143]
  v_exp_f32 v37, v37
  v_mfma_f32_16x16x32_bf16 v[136:139], v[52:55], a[192:195], v[136:139]
  s_waitcnt lgkmcnt(2)
  buffer_load_dwordx4 v8, s[28:31], s43 offen offset:3072 sc1 lds
  v_mfma_f32_16x16x32_bf16 v[128:131], v[56:59], a[208:211], v[128:131]
  ds_read_b64_tr_b16 v[48:49], v1 offset:57344
  s_add_u32 s43, s43, s46
  v_mfma_f32_16x16x32_bf16 v[132:135], v[56:59], a[212:215], v[132:135]
  ds_read_b64_tr_b16 v[50:51], v1 offset:57600
  s_add_u32 m0, s47, 49152
  v_mfma_f32_16x16x32_bf16 v[144:147], v[56:59], a[216:219], v[144:147]
  v_exp_f32 v38, v38
  v_mfma_f32_16x16x32_bf16 v[148:151], v[56:59], a[220:223], v[148:151]
  s_waitcnt lgkmcnt(2)
  buffer_load_dwordx4 v5, s[28:31], s43 offen offset:0 sc1 lds
  v_mfma_f32_16x16x32_bf16 v[156:159], v[60:63], a[220:223], v[156:159]
  ds_read_b64_tr_b16 v[52:53], v2 offset:57344
  v_mul_f32 v85, v69, v85
  v_mfma_f32_16x16x32_bf16 v[152:155], v[60:63], a[216:219], v[152:155]
  ds_read_b64_tr_b16 v[54:55], v2 offset:57600
  v_mul_f32 v86, v70, v86
  v_mfma_f32_16x16x32_bf16 v[140:143], v[60:63], a[212:215], v[140:143]
  v_exp_f32 v39, v39
  v_mfma_f32_16x16x32_bf16 v[136:139], v[60:63], a[208:211], v[136:139]
  s_waitcnt lgkmcnt(2)
  buffer_load_dwordx4 v6, s[28:31], s43 offen offset:1024 sc1 lds
  v_mfma_f32_16x16x32_bf16 v[128:131], v[48:51], a[224:227], v[128:131]
  ds_read_b64_tr_b16 v[56:57], v1 offset:61440
  v_mul_f32 v87, v71, v87
  v_mfma_f32_16x16x32_bf16 v[132:135], v[48:51], a[228:231], v[132:135]
  ds_read_b64_tr_b16 v[58:59], v1 offset:61696
  v_fma_f32 v36, v36, v12, v12
  v_mfma_f32_16x16x32_bf16 v[144:147], v[48:51], a[232:235], v[144:147]
  v_rcp_f32 v36, v36
  v_mfma_f32_16x16x32_bf16 v[148:151], v[48:51], a[236:239], v[148:151]
  s_waitcnt lgkmcnt(2)
  v_fma_f32 v37, v37, v12, v12
  v_fma_f32 v38, v38, v12, v12
  v_mfma_f32_16x16x32_bf16 v[156:159], v[52:55], a[236:239], v[156:159]
  ds_read_b64_tr_b16 v[60:61], v2 offset:61440
  v_fma_f32 v39, v39, v12, v12
  v_mfma_f32_16x16x32_bf16 v[152:155], v[52:55], a[232:235], v[152:155]
  ds_read_b64_tr_b16 v[62:63], v2 offset:61696
  v_mul_f32 v84, v84, v36
  v_mfma_f32_16x16x32_bf16 v[140:143], v[52:55], a[228:231], v[140:143]
  buffer_load_dwordx4 v7, s[28:31], s43 offen offset:2048 sc1 lds
  v_mfma_f32_16x16x32_bf16 v[136:139], v[52:55], a[224:227], v[136:139]
  s_waitcnt lgkmcnt(2)
  s_waitcnt vmcnt(17)
  s_barrier
  v_mfma_f32_16x16x32_bf16 v[128:131], v[56:59], a[240:243], v[128:131]
  ds_read_b64_tr_b16 v[48:49], v3 offset:0
  v_fma_f32 v40, -v76, v76, v11
  v_mfma_f32_16x16x32_bf16 v[132:135], v[56:59], a[244:247], v[132:135]
L_pad2:
  s_cbranch_execz L_pad4
  ds_read_b64_tr_b16 v[50:51], v3 offset:256
  v_fma_f32 v41, -v77, v77, v11
  v_mfma_f32_16x16x32_bf16 v[144:147], v[56:59], a[248:251], v[144:147]
  buffer_load_dwordx4 v8, s[28:31], s43 offen offset:3072 sc1 lds
  v_mfma_f32_16x16x32_bf16 v[148:151], v[56:59], a[252:255], v[148:151]
  s_waitcnt lgkmcnt(2)
  s_add_u32 s43, s43, s46
  s_add_u32 m0, s47, 65536
  v_mfma_f32_16x16x32_bf16 v[156:159], v[60:63], a[252:255], v[156:159]
  ds_read_b64_tr_b16 v[52:53], v4 offset:0
  v_fma_f32 v42, -v78, v78, v11
  v_mfma_f32_16x16x32_bf16 v[152:155], v[60:63], a[248:251], v[152:155]
  ds_read_b64_tr_b16 v[54:55], v4 offset:256
  v_fma_f32 v43, -v79, v79, v11
  v_mfma_f32_16x16x32_bf16 v[140:143], v[60:63], a[244:247], v[140:143]
  buffer_load_dwordx4 v5, s[28:31], s43 offen offset:0 sc1 lds
  v_mfma_f32_16x16x32_bf16 v[136:139], v[60:63], a[240:243], v[136:139]
  s_waitcnt lgkmcnt(2)
  v_rcp_f32 v37, v37
  v_mfma_f32_16x16x32_bf16 v[128:131], v[48:51], v[192:195], v[128:131]
  ds_read_b64_tr_b16 v[56:57], v3 offset:4096
  v_mul_f32 v85, v85, v37
  v_mfma_f32_16x16x32_bf16 v[132:135], v[48:51], v[196:199], v[132:135]
  ds_read_b64_tr_b16 v[58:59], v3 offset:4352
  v_cvt_pk_bf16_f32 v24, v84, v85
  v_mfma_f32_16x16x32_bf16 v[144:147], v[48:51], v[200:203], v[144:147]
  buffer_load_dwordx4 v6, s[28:31], s43 offen offset:1024 sc1 lds
  v_mfma_f32_16x16x32_bf16 v[148:151], v[48:51], v[204:207], v[148:151]
  s_waitcnt lgkmcnt(2)
  v_rcp_f32 v38, v38
  v_mfma_f32_16x16x32_bf16 v[156:159], v[52:55], v[204:207], v[156:159]
  ds_read_b64_tr_b16 v[60:61], v4 offset:4096
  v_mul_f32 v86, v86, v38
  v_mfma_f32_16x16x32_bf16 v[152:155], v[52:55], v[200:203], v[152:155]
  ds_read_b64_tr_b16 v[62:63], v4 offset:4352
  v_mul_f32 v40, v40, v76
  v_mfma_f32_16x16x32_bf16 v[140:143], v[52:55], v[196:199], v[140:143]
  buffer_load_dwordx4 v7, s[28:31], s43 offen offset:2048 sc1 lds
  v_mfma_f32_16x16x32_bf16 v[136:139], v[52:55], v[192:195], v[136:139]
  s_waitcnt lgkmcnt(2)
  v_rcp_f32 v39, v39
  v_mfma_f32_16x16x32_bf16 v[128:131], v[56:59], v[208:211], v[128:131]
  ds_read_b64_tr_b16 v[48:49], v3 offset:8192
  v_mul_f32 v87, v87, v39
  v_mfma_f32_16x16x32_bf16 v[132:135], v[56:59], v[212:215], v[132:135]
  ds_read_b64_tr_b16 v[50:51], v3 offset:8448
  v_cvt_pk_bf16_f32 v25, v86, v87
  v_mfma_f32_16x16x32_bf16 v[144:147], v[56:59], v[216:219], v[144:147]
  v_exp_f32 v40, v40
  v_mfma_f32_16x16x32_bf16 v[148:151], v[56:59], v[220:223], v[148:151]
  s_waitcnt lgkmcnt(2)
  buffer_load_dwordx4 v8, s[28:31], s43 offen offset:3072 sc1 lds
  v_mfma_f32_16x16x32_bf16 v[156:159], v[60:63], v[220:223], v[156:159]
  ds_read_b64_tr_b16 v[52:53], v4 offset:8192
  s_add_u32 s43, s43, s46
  v_mfma_f32_16x16x32_bf16 v[152:155], v[60:63], v[216:219], v[152:155]
  ds_read_b64_tr_b16 v[54:55], v4 offset:8448
  s_add_u32 m0, s47, 81920
  v_mfma_f32_16x16x32_bf16 v[140:143], v[60:63], v[212:215], v[140:143]
  v_mul_f32 v41, v41, v77
  v_mul_f32 v42, v42, v78
  v_mfma_f32_16x16x32_bf16 v[136:139], v[60:63], v[208:211], v[136:139]
  s_waitcnt lgkmcnt(2)
  buffer_load_dwordx4 v5, s[28:31], s43 offen offset:0 sc1 lds
  v_mfma_f32_16x16x32_bf16 v[128:131], v[48:51], v[224:227], v[128:131]
  ds_read_b64_tr_b16 v[56:57], v3 offset:12288
  v_mul_f32 v43, v43, v79
  v_mfma_f32_16x16x32_bf16 v[132:135], v[48:51], v[228:231], v[132:135]
  ds_read_b64_tr_b16 v[58:59], v3 offset:12544
  v_mul_f32 v92, v76, v92
  v_mfma_f32_16x16x32_bf16 v[144:147], v[48:51], v[232:235], v[144:147]
  v_exp_f32 v41, v41
  v_mfma_f32_16x16x32_bf16 v[148:151], v[48:51], v[236:239], v[148:151]
  s_waitcnt lgkmcnt(2)
  buffer_load_dwordx4 v6, s[28:31], s43 offen offset:1024 sc1 lds
  v_mfma_f32_16x16x32_bf16 v[156:159], v[52:55], v[236:239], v[156:159]
  ds_read_b64_tr_b16 v[60:61], v4 offset:12288
  v_mul_f32 v93, v77, v93
  v_mfma_f32_16x16x32_bf16 v[152:155], v[52:55], v[232:235], v[152:155]
  ds_read_b64_tr_b16 v[62:63], v4 offset:12544
  v_mul_f32 v94, v78, v94
  v_mfma_f32_16x16x32_bf16 v[140:143], v[52:55], v[228:231], v[140:143]
  v_exp_f32 v42, v42
  v_mfma_f32_16x16x32_bf16 v[136:139], v[52:55], v[224:227], v[136:139]
  s_waitcnt lgkmcnt(2)
  s_waitcnt vmcnt(13)
  v_subrev_u32 v15, s85, v15
  v_subrev_u32 v15, 2, v15
  v_cmp_gt_u32 vcc, 6, v15
  s_nop 0
  s_cmp_eq_u64 vcc, -1
  s_cbranch_scc0 L_slow2
L_back2:
  s_barrier
  v_xor_b32 v3, 0x20000, v3
  v_xor_b32 v4, 0x20000, v4
  v_mfma_f32_16x16x32_bf16 v[128:131], v[56:59], v[240:243], v[128:131]
  ds_read_b64_tr_b16 v[48:49], v3 offset:0
  v_mul_f32 v95, v79, v95
  v_mfma_f32_16x16x32_bf16 v[132:135], v[56:59], v[244:247], v[132:135]
  ds_read_b64_tr_b16 v[50:51], v3 offset:256
  v_fma_f32 v40, v40, v12, v12
  v_mfma_f32_16x16x32_bf16 v[144:147], v[56:59], v[248:251], v[144:147]
  buffer_load_dwordx4 v7, s[28:31], s43 offen offset:2048 sc1 lds
  v_mfma_f32_16x16x32_bf16 v[148:151], v[56:59], v[252:255], v[148:151]
  s_waitcnt lgkmcnt(2)
  v_exp_f32 v43, v43
  v_mfma_f32_16x16x32_bf16 v[156:159], v[60:63], v[252:255], v[156:159]
  ds_read_b64_tr_b16 v[52:53], v4 offset:0
  v_fma_f32 v41, v41, v12, v12
  v_mfma_f32_16x16x32_bf16 v[152:155], v[60:63], v[248:251], v[152:155]
  ds_read_b64_tr_b16 v[54:55], v4 offset:256
  v_fma_f32 v42, v42, v12, v12
  v_mfma_f32_16x16x32_bf16 v[140:143], v[60:63], v[244:247], v[140:143]
  buffer_load_dwordx4 v8, s[28:31], s43 offen offset:3072 sc1 lds
  v_mfma_f32_16x16x32_bf16 v[136:139], v[60:63], v[240:243], v[136:139]
  s_waitcnt lgkmcnt(2)
  s_add_u32 s43, s43, s46
  s_add_u32 m0, s47, 98304
  v_fma_f32 v43, v43, v12, v12
  v_rcp_f32 v40, v40
  v_rcp_f32 v41, v41
  v_rcp_f32 v42, v42
  v_rcp_f32 v43, v43
  v_mul_f32 v92, v92, v40
  v_mul_f32 v93, v93, v41
  v_mul_f32 v94, v94, v42
  v_mul_f32 v95, v95, v43
  v_cvt_pk_bf16_f32 v26, v92, v93
  v_cvt_pk_bf16_f32 v27, v94, v95
  buffer_store_dwordx4 v[24:27], v10, s[36:39], s55 offen offset:256 sc1
  v_mfma_f32_16x16x32_bf16 v[160:163], v[48:51], a[0:3], 0
  ds_read_b64_tr_b16 v[56:57], v3 offset:8192
  v_mfma_f32_16x16x32_bf16 v[164:167], v[48:51], a[4:7], 0
  ds_read_b64_tr_b16 v[58:59], v3 offset:8448
  v_mfma_f32_16x16x32_bf16 v[64:67], v[48:51], a[8:11], 0
  buffer_load_dwordx4 v5, s[28:31], s43 offen offset:0 sc1 lds
  v_mfma_f32_16x16x32_bf16 v[68:71], v[48:51], a[12:15], 0
  s_waitcnt lgkmcnt(2)
  v_mfma_f32_16x16x32_bf16 v[76:79], v[52:55], a[12:15], 0
  ds_read_b64_tr_b16 v[60:61], v4 offset:8192
  s_add_u32 s59, s51, 0x10000
  v_mfma_f32_16x16x32_bf16 v[72:75], v[52:55], a[8:11], 0
  ds_read_b64_tr_b16 v[62:63], v4 offset:8448
  v_mul_f32 v128, s54, v128
  v_mfma_f32_16x16x32_bf16 v[172:175], v[52:55], a[4:7], 0
  buffer_load_dwordx4 v6, s[28:31], s43 offen offset:1024 sc1 lds
  v_mfma_f32_16x16x32_bf16 v[168:171], v[52:55], a[0:3], 0
  s_waitcnt lgkmcnt(2)
  v_mul_f32 v129, s54, v129
  v_mul_f32 v130, s54, v130
  v_mfma_f32_16x16x32_bf16 v[176:179], v[56:59], a[0:3], 0
  ds_read_b64_tr_b16 v[48:49], v3 offset:4096
  v_mul_f32 v131, s54, v131
  v_mfma_f32_16x16x32_bf16 v[180:183], v[56:59], a[4:7], 0
  ds_read_b64_tr_b16 v[50:51], v3 offset:4352
  v_cvt_pk_bf16_f32 v20, v128, v129
  v_mfma_f32_16x16x32_bf16 v[80:83], v[56:59], a[8:11], 0
  buffer_load_dwordx4 v7, s[28:31], s43 offen offset:2048 sc1 lds
  v_mfma_f32_16x16x32_bf16 v[84:87], v[56:59], a[12:15], 0
  s_waitcnt lgkmcnt(2)
  v_cvt_pk_bf16_f32 v21, v130, v131
  v_mul_f32 v132, s54, v132
  v_mfma_f32_16x16x32_bf16 v[92:95], v[60:63], a[12:15], 0
  ds_read_b64_tr_b16 v[52:53], v4 offset:4096
  v_mul_f32 v133, s54, v133
  v_mfma_f32_16x16x32_bf16 v[88:91], v[60:63], a[8:11], 0
  ds_read_b64_tr_b16 v[54:55], v4 offset:4352
  v_mul_f32 v134, s54, v134
  v_mfma_f32_16x16x32_bf16 v[188:191], v[60:63], a[4:7], 0
  v_mul_f32 v135, s54, v135
  v_cvt_pk_bf16_f32 v22, v132, v133
  v_mfma_f32_16x16x32_bf16 v[184:187], v[60:63], a[0:3], 0
  s_waitcnt lgkmcnt(2)
  buffer_load_dwordx4 v8, s[28:31], s43 offen offset:3072 sc1 lds
  v_mfma_f32_16x16x32_bf16 v[160:163], v[48:51], a[16:19], v[160:163]
  ds_read_b64_tr_b16 v[56:57], v3 offset:12288
  s_add_u32 s43, s43, s46
  v_mfma_f32_16x16x32_bf16 v[164:167], v[48:51], a[20:23], v[164:167]
  ds_read_b64_tr_b16 v[58:59], v3 offset:12544
  s_add_u32 m0, s47, 114688
  v_mfma_f32_16x16x32_bf16 v[64:67], v[48:51], a[24:27], v[64:67]
  v_cvt_pk_bf16_f32 v23, v134, v135
  v_mul_f32 v136, s54, v136
  v_mfma_f32_16x16x32_bf16 v[68:71], v[48:51], a[28:31], v[68:71]
  s_waitcnt lgkmcnt(2)
  buffer_load_dwordx4 v5, s[28:31], s43 offen offset:0 sc1 lds
  v_mfma_f32_16x16x32_bf16 v[76:79], v[52:55], a[28:31], v[76:79]
  ds_read_b64_tr_b16 v[60:61], v4 offset:12288
  v_mul_f32 v137, s54, v137
  v_mfma_f32_16x16x32_bf16 v[72:75], v[52:55], a[24:27], v[72:75]
  ds_read_b64_tr_b16 v[62:63], v4 offset:12544
  v_mul_f32 v138, s54, v138
  v_mfma_f32_16x16x32_bf16 v[172:175], v[52:55], a[20:23], v[172:175]
  buffer_store_dwordx4 v[20:23], v9, s[32:35], s51 offen offset:0 sc1
  v_mfma_f32_16x16x32_bf16 v[168:171], v[52:55], a[16:19], v[168:171]
  s_waitcnt lgkmcnt(2)
  s_barrier
  v_mfma_f32_16x16x32_bf16 v[176:179], v[56:59], a[16:19], v[176:179]
  ds_read_b64_tr_b16 v[48:49], v3 offset:16384
  v_mul_f32 v139, s54, v139
  v_mfma_f32_16x16x32_bf16 v[180:183], v[56:59], a[20:23], v[180:183]
  ds_read_b64_tr_b16 v[50:51], v3 offset:16640
  v_cvt_pk_bf16_f32 v24, v136, v137
  v_mfma_f32_16x16x32_bf16 v[80:83], v[56:59], a[24:27], v[80:83]
  v_cvt_pk_bf16_f32 v25, v138, v139
  v_mul_f32 v140, s54, v140
  v_mfma_f32_16x16x32_bf16 v[84:87], v[56:59], a[28:31], v[84:87]
  s_waitcnt lgkmcnt(2)
  v_mul_f32 v141, s54, v141
  v_mul_f32 v142, s54, v142
  v_mfma_f32_16x16x32_bf16 v[92:95], v[60:63], a[28:31], v[92:95]
  ds_read_b64_tr_b16 v[52:53], v4 offset:16384
  v_mul_f32 v143, s54, v143
  v_mfma_f32_16x16x32_bf16 v[88:91], v[60:63], a[24:27], v[88:91]
  ds_read_b64_tr_b16 v[54:55], v4 offset:16640
  v_cvt_pk_bf16_f32 v26, v140, v141
  v_mfma_f32_16x16x32_bf16 v[188:191], v[60:63], a[20:23], v[188:191]
  buffer_load_dwordx4 v6, s[28:31], s43 offen offset:1024 sc1 lds
  v_mfma_f32_16x16x32_bf16 v[184:187], v[60:63], a[16:19], v[184:187]
  s_waitcnt lgkmcnt(2)
  v_cvt_pk_bf16_f32 v27, v142, v143
  v_mul_f32 v144, s54, v144
  v_mfma_f32_16x16x32_bf16 v[160:163], v[48:51], a[32:35], v[160:163]
  ds_read_b64_tr_b16 v[56:57], v3 offset:24576
  v_mul_f32 v145, s54, v145
  v_mfma_f32_16x16x32_bf16 v[164:167], v[48:51], a[36:39], v[164:167]
  ds_read_b64_tr_b16 v[58:59], v3 offset:24832
  v_mul_f32 v146, s54, v146
  v_mfma_f32_16x16x32_bf16 v[64:67], v[48:51], a[40:43], v[64:67]
  buffer_load_dwordx4 v7, s[28:31], s43 offen offset:2048 sc1 lds
  v_mfma_f32_16x16x32_bf16 v[68:71], v[48:51], a[44:47], v[68:71]
  s_waitcnt lgkmcnt(2)
  buffer_store_dwordx4 v[24:27], v9, s[32:35], s59 offen offset:0 sc1
  v_mfma_f32_16x16x32_bf16 v[76:79], v[52:55], a[44:47], v[76:79]
  ds_read_b64_tr_b16 v[60:61], v4 offset:24576
  v_mul_f32 v147, s54, v147
  v_mfma_f32_16x16x32_bf16 v[72:75], v[52:55], a[40:43], v[72:75]
  ds_read_b64_tr_b16 v[62:63], v4 offset:24832
  v_cvt_pk_bf16_f32 v28, v144, v145
  v_mfma_f32_16x16x32_bf16 v[172:175], v[52:55], a[36:39], v[172:175]
  v_cvt_pk_bf16_f32 v29, v146, v147
  v_mul_f32 v148, s54, v148
  v_mfma_f32_16x16x32_bf16 v[168:171], v[52:55], a[32:35], v[168:171]
  s_waitcnt lgkmcnt(2)
  v_mul_f32 v149, s54, v149
  v_mul_f32 v150, s54, v150
  v_mfma_f32_16x16x32_bf16 v[176:179], v[56:59], a[32:35], v[176:179]
  ds_read_b64_tr_b16 v[48:49], v3 offset:20480
  v_mul_f32 v151, s54, v151
  v_mfma_f32_16x16x32_bf16 v[180:183], v[56:59], a[36:39], v[180:183]
  ds_read_b64_tr_b16 v[50:51], v3 offset:20736
  v_cvt_pk_bf16_f32 v30, v148, v149
  v_mfma_f32_16x16x32_bf16 v[80:83], v[56:59], a[40:43], v[80:83]
  buffer_load_dwordx4 v8, s[28:31], s43 offen offset:3072 sc1 lds
  v_mfma_f32_16x16x32_bf16 v[84:87], v[56:59], a[44:47], v[84:87]
  s_waitcnt lgkmcnt(2)
  s_add_u32 s43, s43, s46
  s_add_u32 m0, s47, 131072
  v_mfma_f32_16x16x32_bf16 v[92:95], v[60:63], a[44:47], v[92:95]
  ds_read_b64_tr_b16 v[52:53], v4 offset:20480
  v_cvt_pk_bf16_f32 v31, v150, v151
  v_mfma_f32_16x16x32_bf16 v[88:91], v[60:63], a[40:43], v[88:91]
  ds_read_b64_tr_b16 v[54:55], v4 offset:20736
  v_mul_f32 v152, s54, v152
  v_mfma_f32_16x16x32_bf16 v[188:191], v[60:63], a[36:39], v[188:191]
  buffer_load_dwordx4 v5, s[28:31], s43 offen offset:0 sc1 lds
  v_mfma_f32_16x16x32_bf16 v[184:187], v[60:63], a[32:35], v[184:187]
  s_waitcnt lgkmcnt(2)
  buffer_store_dwordx4 v[28:31], v9, s[32:35], s51 offen offset:256 sc1
  v_mfma_f32_16x16x32_bf16 v[160:163], v[48:51], a[48:51], v[160:163]
  ds_read_b64_tr_b16 v[56:57], v3 offset:28672
  v_mul_f32 v153, s54, v153
  v_mfma_f32_16x16x32_bf16 v[164:167], v[48:51], a[52:55], v[164:167]
  ds_read_b64_tr_b16 v[58:59], v3 offset:28928
  v_mul_f32 v154, s54, v154
  v_mfma_f32_16x16x32_bf16 v[64:67], v[48:51], a[56:59], v[64:67]
  v_mul_f32 v155, s54, v155
  v_cvt_pk_bf16_f32 v32, v152, v153
  v_mfma_f32_16x16x32_bf16 v[68:71], v[48:51], a[60:63], v[68:71]
  s_waitcnt lgkmcnt(2)
  v_cvt_pk_bf16_f32 v33, v154, v155
  v_mul_f32 v156, s54, v156
  v_mfma_f32_16x16x32_bf16 v[76:79], v[52:55], a[60:63], v[76:79]
  ds_read_b64_tr_b16 v[60:61], v4 offset:28672
  v_mul_f32 v157, s54, v157
  v_mfma_f32_16x16x32_bf16 v[72:75], v[52:55], a[56:59], v[72:75]
  ds_read_b64_tr_b16 v[62:63], v4 offset:28928
  v_mul_f32 v158, s54, v158
  v_mfma_f32_16x16x32_bf16 v[172:175], v[52:55], a[52:55], v[172:175]
  v_mul_f32 v159, s54, v159
  v_cvt_pk_bf16_f32 v34, v156, v157
  v_mfma_f32_16x16x32_bf16 v[168:171], v[52:55], a[48:51], v[168:171]
  s_waitcnt lgkmcnt(2)
  s_waitcnt vmcnt(25)
  s_barrier
  v_mfma_f32_16x16x32_bf16 v[176:179], v[56:59], a[48:51], v[176:179]
  ds_read_b64_tr_b16 v[48:49], v3 offset:32768
  v_cvt_pk_bf16_f32 v35, v158, v159
  v_mfma_f32_16x16x32_bf16 v[180:183], v[56:59], a[52:55], v[180:183]
  ds_read_b64_tr_b16 v[50:51], v3 offset:33024
  v_fma_f32 v36, -v96, v96, v11
  v_mfma_f32_16x16x32_bf16 v[80:83], v[56:59], a[56:59], v[80:83]
  buffer_load_dwordx4 v6, s[28:31], s43 offen offset:1024 sc1 lds
  v_mfma_f32_16x16x32_bf16 v[84:87], v[56:59], a[60:63], v[84:87]
  s_waitcnt lgkmcnt(2)
  buffer_store_dwordx4 v[32:35], v9, s[32:35], s59 offen offset:256 sc1
  v_mfma_f32_16x16x32_bf16 v[92:95], v[60:63], a[60:63], v[92:95]
  ds_read_b64_tr_b16 v[52:53], v4 offset:32768
  v_fma_f32 v37, -v97, v97, v11
  v_mfma_f32_16x16x32_bf16 v[88:91], v[60:63], a[56:59], v[88:91]
  ds_read_b64_tr_b16 v[54:55], v4 offset:33024
  v_fma_f32 v38, -v98, v98, v11
  v_mfma_f32_16x16x32_bf16 v[188:191], v[60:63], a[52:55], v[188:191]
  v_fma_f32 v39, -v99, v99, v11
  v_mul_f32 v36, v36, v96
  v_mfma_f32_16x16x32_bf16 v[184:187], v[60:63], a[48:51], v[184:187]
  s_waitcnt lgkmcnt(2)
  v_exp_f32 v36, v36
  v_mfma_f32_16x16x32_bf16 v[160:163], v[48:51], a[64:67], v[160:163]
  ds_read_b64_tr_b16 v[56:57], v3 offset:40960
  v_mul_f32 v37, v37, v97
  v_mfma_f32_16x16x32_bf16 v[164:167], v[48:51], a[68:71], v[164:167]
  ds_read_b64_tr_b16 v[58:59], v3 offset:41216
  v_mul_f32 v38, v38, v98
  v_mfma_f32_16x16x32_bf16 v[64:67], v[48:51], a[72:75], v[64:67]
  buffer_load_dwordx4 v7, s[28:31], s43 offen offset:2048 sc1 lds
  v_mfma_f32_16x16x32_bf16 v[68:71], v[48:51], a[76:79], v[68:71]
  s_waitcnt lgkmcnt(2)
  v_exp_f32 v37, v37
  v_mfma_f32_16x16x32_bf16 v[76:79], v[52:55], a[76:79], v[76:79]
  ds_read_b64_tr_b16 v[60:61], v4 offset:40960
  v_mul_f32 v39, v39, v99
  v_mfma_f32_16x16x32_bf16 v[72:75], v[52:55], a[72:75], v[72:75]
  ds_read_b64_tr_b16 v[62:63], v4 offset:41216
  v_mul_f32 v112, v96, v112
  v_mfma_f32_16x16x32_bf16 v[172:175], v[52:55], a[68:71], v[172:175]
  buffer_load_dwordx4 v8, s[28:31], s43 offen offset:3072 sc1 lds
  v_mfma_f32_16x16x32_bf16 v[168:171], v[52:55], a[64:67], v[168:171]
  s_waitcnt lgkmcnt(2)
  s_add_u32 s43, s43, s46
  v_mul_f32 v113, v97, v113
  v_mfma_f32_16x16x32_bf16 v[176:179], v[56:59], a[64:67], v[176:179]
  ds_read_b64_tr_b16 v[48:49], v3 offset:36864
  s_add_u32 s71, s69, 0
  v_mfma_f32_16x16x32_bf16 v[180:183], v[56:59], a[68:71], v[180:183]
  ds_read_b64_tr_b16 v[50:51], v3 offset:37120
  v_mul_f32 v114, v98, v114
  v_mfma_f32_16x16x32_bf16 v[80:83], v[56:59], a[72:75], v[80:83]
  buffer_load_dwordx4 a[0:3], v17, s[8:11], s71 offen offset:0 sc1
  v_mfma_f32_16x16x32_bf16 v[84:87], v[56:59], a[76:79], v[84:87]
  s_waitcnt lgkmcnt(2)
  v_exp_f32 v38, v38
  v_mfma_f32_16x16x32_bf16 v[92:95], v[60:63], a[76:79], v[92:95]
  ds_read_b64_tr_b16 v[52:53], v4 offset:36864
  v_mul_f32 v115, v99, v115
  v_mfma_f32_16x16x32_bf16 v[88:91], v[60:63], a[72:75], v[88:91]
  ds_read_b64_tr_b16 v[54:55], v4 offset:37120
  v_fma_f32 v36, v36, v12, v12
  v_mfma_f32_16x16x32_bf16 v[188:191], v[60:63], a[68:71], v[188:191]
  v_exp_f32 v39, v39
  v_mfma_f32_16x16x32_bf16 v[184:187], v[60:63], a[64:67], v[184:187]
  s_waitcnt lgkmcnt(2)
  buffer_load_dwordx4 a[4:7], v17, s[8:11], s71 offen offset:1024 sc1
  v_mfma_f32_16x16x32_bf16 v[160:163], v[48:51], a[80:83], v[160:163]
  ds_read_b64_tr_b16 v[56:57], v3 offset:45056
  v_fma_f32 v37, v37, v12, v12
  v_mfma_f32_16x16x32_bf16 v[164:167], v[48:51], a[84:87], v[164:167]
  ds_read_b64_tr_b16 v[58:59], v3 offset:45312
  v_fma_f32 v38, v38, v12, v12
  v_mfma_f32_16x16x32_bf16 v[64:67], v[48:51], a[88:91], v[64:67]
  v_rcp_f32 v36, v36
  v_mfma_f32_16x16x32_bf16 v[68:71], v[48:51], a[92:95], v[68:71]
  s_waitcnt lgkmcnt(2)
  buffer_load_dwordx4 a[8:11], v17, s[8:11], s71 offen offset:2048 sc1
  v_mfma_f32_16x16x32_bf16 v[76:79], v[52:55], a[92:95], v[76:79]
  ds_read_b64_tr_b16 v[60:61], v4 offset:45056
  v_fma_f32 v39, v39, v12, v12
  v_mfma_f32_16x16x32_bf16 v[72:75], v[52:55], a[88:91], v[72:75]
  ds_read_b64_tr_b16 v[62:63], v4 offset:45312
  v_mul_f32 v112, v112, v36
  v_mfma_f32_16x16x32_bf16 v[172:175], v[52:55], a[84:87], v[172:175]
  v_rcp_f32 v37, v37
  v_mfma_f32_16x16x32_bf16 v[168:171], v[52:55], a[80:83], v[168:171]
  s_waitcnt lgkmcnt(2)
  s_waitcnt vmcnt(28)
  s_barrier
  v_mfma_f32_16x16x32_bf16 v[176:179], v[56:59], a[80:83], v[176:179]
  ds_read_b64_tr_b16 v[48:49], v3 offset:49152
  v_mul_f32 v113, v113, v37
  v_mfma_f32_16x16x32_bf16 v[180:183], v[56:59], a[84:87], v[180:183]
  ds_read_b64_tr_b16 v[50:51], v3 offset:49408
  v_cvt_pk_bf16_f32 v28, v112, v113
  v_mfma_f32_16x16x32_bf16 v[80:83], v[56:59], a[88:91], v[80:83]
  buffer_load_dwordx4 a[12:15], v17, s[8:11], s71 offen offset:3072 sc1
  v_mfma_f32_16x16x32_bf16 v[84:87], v[56:59], a[92:95], v[84:87]
  s_waitcnt lgkmcnt(2)
  s_add_u32 s71, s69, 4096
  v_fma_f32 v40, -v104, v104, v11
  v_mfma_f32_16x16x32_bf16 v[92:95], v[60:63], a[92:95], v[92:95]
  ds_read_b64_tr_b16 v[52:53], v4 offset:49152
  v_fma_f32 v41, -v105, v105, v11
  v_mfma_f32_16x16x32_bf16 v[88:91], v[60:63], a[88:91], v[88:91]
  ds_read_b64_tr_b16 v[54:55], v4 offset:49408
  v_fma_f32 v42, -v106, v106, v11
  v_mfma_f32_16x16x32_bf16 v[188:191], v[60:63], a[84:87], v[188:191]
  buffer_load_dwordx4 a[16:19], v17, s[8:11], s71 offen offset:0 sc1
  v_mfma_f32_16x16x32_bf16 v[184:187], v[60:63], a[80:83], v[184:187]
  s_waitcnt lgkmcnt(2)
  v_rcp_f32 v38, v38
  v_mfma_f32_16x16x32_bf16 v[160:163], v[48:51], a[96:99], v[160:163]
  ds_read_b64_tr_b16 v[56:57], v3 offset:57344
  v_mul_f32 v114, v114, v38
  v_mfma_f32_16x16x32_bf16 v[164:167], v[48:51], a[100:103], v[164:167]
  ds_read_b64_tr_b16 v[58:59], v3 offset:57600
  v_fma_f32 v43, -v107, v107, v11
  v_mfma_f32_16x16x32_bf16 v[64:67], v[48:51], a[104:107], v[64:67]
  buffer_load_dwordx4 a[20:23], v17, s[8:11], s71 offen offset:1024 sc1
  v_mfma_f32_16x16x32_bf16 v[68:71], v[48:51], a[108:111], v[68:71]
  s_waitcnt lgkmcnt(2)
  v_rcp_f32 v39, v39
  v_mfma_f32_16x16x32_bf16 v[76:79], v[52:55], a[108:111], v[76:79]
  ds_read_b64_tr_b16 v[60:61], v4 offset:57344
  v_mul_f32 v115, v115, v39
  v_mfma_f32_16x16x32_bf16 v[72:75], v[52:55], a[104:107], v[72:75]
  ds_read_b64_tr_b16 v[62:63], v4 offset:57600
  v_cvt_pk_bf16_f32 v29, v114, v115
  v_mfma_f32_16x16x32_bf16 v[172:175], v[52:55], a[100:103], v[172:175]
  buffer_load_dwordx4 a[24:27], v17, s[8:11], s71 offen offset:2048 sc1
  v_mfma_f32_16x16x32_bf16 v[168:171], v[52:55], a[96:99], v[168:171]
  s_waitcnt lgkmcnt(2)
  v_mul_f32 v40, v40, v104
  v_mul_f32 v41, v41, v105
  v_mfma_f32_16x16x32_bf16 v[176:179], v[56:59], a[96:99], v[176:179]
  ds_read_b64_tr_b16 v[48:49], v3 offset:53248
  v_mul_f32 v42, v42, v106
  v_mfma_f32_16x16x32_bf16 v[180:183], v[56:59], a[100:103], v[180:183]
  ds_read_b64_tr_b16 v[50:51], v3 offset:53504
  v_mul_f32 v43, v43, v107
  v_mfma_f32_16x16x32_bf16 v[80:83], v[56:59], a[104:107], v[80:83]
  buffer_load_dwordx4 a[28:31], v17, s[8:11], s71 offen offset:3072 sc1
  v_mfma_f32_16x16x32_bf16 v[84:87], v[56:59], a[108:111], v[84:87]
  s_waitcnt lgkmcnt(2)
  v_exp_f32 v40, v40
  v_mfma_f32_16x16x32_bf16 v[92:95], v[60:63], a[108:111], v[92:95]
  ds_read_b64_tr_b16 v[52:53], v4 offset:53248
  s_add_u32 s71, s69, 8192
  v_mfma_f32_16x16x32_bf16 v[88:91], v[60:63], a[104:107], v[88:91]
  ds_read_b64_tr_b16 v[54:55], v4 offset:53504
  v_mul_f32 v120, v104, v120
  v_mfma_f32_16x16x32_bf16 v[188:191], v[60:63], a[100:103], v[188:191]
  v_exp_f32 v41, v41
  v_mfma_f32_16x16x32_bf16 v[184:187], v[60:63], a[96:99], v[184:187]
  s_waitcnt lgkmcnt(2)
  buffer_load_dwordx4 a[32:35], v17, s[8:11], s71 offen offset:0 sc1
  v_mfma_f32_16x16x32_bf16 v[160:163], v[48:51], a[112:115], v[160:163]
  ds_read_b64_tr_b16 v[56:57], v3 offset:61440
  v_mul_f32 v121, v105, v121
  v_mfma_f32_16x16x32_bf16 v[164:167], v[48:51], a[116:119], v[164:167]
  ds_read_b64_tr_b16 v[58:59], v3 offset:61696
  v_mul_f32 v122, v106, v122
  v_mfma_f32_16x16x32_bf16 v[64:67], v[48:51], a[120:123], v[64:67]
  v_exp_f32 v42, v42
  v_mfma_f32_16x16x32_bf16 v[68:71], v[48:51], a[124:127], v[68:71]
  s_waitcnt lgkmcnt(2)
  buffer_load_dwordx4 a[36:39], v17, s[8:11], s71 offen offset:1024 sc1
  v_mfma_f32_16x16x32_bf16 v[76:79], v[52:55], a[124:127], v[76:79]
  ds_read_b64_tr_b16 v[60:61], v4 offset:61440
  v_mul_f32 v123, v107, v123
  v_mfma_f32_16x16x32_bf16 v[72:75], v[52:55], a[120:123], v[72:75]
  ds_read_b64_tr_b16 v[62:63], v4 offset:61696
  v_fma_f32 v40, v40, v12, v12
  v_mfma_f32_16x16x32_bf16 v[172:175], v[52:55], a[116:119], v[172:175]
  v_exp_f32 v43, v43
  v_mfma_f32_16x16x32_bf16 v[168:171], v[52:55], a[112:115], v[168:171]
  s_waitcnt lgkmcnt(2)
  s_waitcnt vmcnt(12)
  s_barrier
  v_mfma_f32_16x16x32_bf16 v[176:179], v[56:59], a[112:115], v[176:179]
  ds_read_b64_tr_b16 v[48:49], v1 offset:0
  s_add_u32 s60, s85, 4
  v_mfma_f32_16x16x32_bf16 v[180:183], v[56:59], a[116:119], v[180:183]
  ds_read_b64_tr_b16 v[50:51], v1 offset:256
  s_mov_b32 s1, 131072
  v_mfma_f32_16x16x32_bf16 v[80:83], v[56:59], a[120:123], v[80:83]
  v_mov_b32 v44, s60
  v_fma_f32 v41, v41, v12, v12
  v_mfma_f32_16x16x32_bf16 v[84:87], v[56:59], a[124:127], v[84:87]
  s_waitcnt lgkmcnt(2)
  buffer_store_dword v44, v13, s[12:15], s1 offen sc1
  v_mfma_f32_16x16x32_bf16 v[92:95], v[60:63], a[124:127], v[92:95]
  ds_read_b64_tr_b16 v[52:53], v2 offset:0
  s_add_u32 s71, s69, 20480
  v_mfma_f32_16x16x32_bf16 v[88:91], v[60:63], a[120:123], v[88:91]
  ds_read_b64_tr_b16 v[54:55], v2 offset:256
  v_fma_f32 v42, v42, v12, v12
  v_mfma_f32_16x16x32_bf16 v[188:191], v[60:63], a[116:119], v[188:191]
  buffer_load_dwordx4 a[40:43], v17, s[8:11], s71 offen offset:0 sc1
  v_mfma_f32_16x16x32_bf16 v[184:187], v[60:63], a[112:115], v[184:187]
  s_waitcnt lgkmcnt(2)
  v_rcp_f32 v40, v40
  v_mfma_f32_16x16x32_bf16 v[160:163], v[48:51], a[128:131], v[160:163]
  ds_read_b64_tr_b16 v[56:57], v1 offset:8192
  v_fma_f32 v43, v43, v12, v12
  v_mfma_f32_16x16x32_bf16 v[164:167], v[48:51], a[132:135], v[164:167]
  ds_read_b64_tr_b16 v[58:59], v1 offset:8448
  v_mul_f32 v120, v120, v40
  v_mfma_f32_16x16x32_bf16 v[64:67], v[48:51], a[136:139], v[64:67]
  buffer_load_dwordx4 a[44:47], v17, s[8:11], s71 offen offset:1024 sc1
  v_mfma_f32_16x16x32_bf16 v[68:71], v[48:51], a[140:143], v[68:71]
  s_waitcnt lgkmcnt(2)
  v_rcp_f32 v41, v41
  v_mfma_f32_16x16x32_bf16 v[76:79], v[52:55], a[140:143], v[76:79]
  ds_read_b64_tr_b16 v[60:61], v2 offset:8192
  v_mul_f32 v121, v121, v41
  v_mfma_f32_16x16x32_bf16 v[72:75], v[52:55], a[136:139], v[72:75]
  ds_read_b64_tr_b16 v[62:63], v2 offset:8448
  v_cvt_pk_bf16_f32 v30, v120, v121
  v_mfma_f32_16x16x32_bf16 v[172:175], v[52:55], a[132:135], v[172:175]
  v_rcp_f32 v42, v42
  v_mfma_f32_16x16x32_bf16 v[168:171], v[52:55], a[128:131], v[168:171]
  s_waitcnt lgkmcnt(2)
  buffer_load_dwordx4 a[48:51], v17, s[8:11], s71 offen offset:2048 sc1
  v_mfma_f32_16x16x32_bf16 v[176:179], v[56:59], a[128:131], v[176:179]
  ds_read_b64_tr_b16 v[48:49], v1 offset:4096
  v_mul_f32 v122, v122, v42
  v_mfma_f32_16x16x32_bf16 v[180:183], v[56:59], a[132:135], v[180:183]
  ds_read_b64_tr_b16 v[50:51], v1 offset:4352
  v_fma_f32 v36, -v100, v100, v11
  v_mfma_f32_16x16x32_bf16 v[80:83], v[56:59], a[136:139], v[80:83]
  v_rcp_f32 v43, v43
  v_mfma_f32_16x16x32_bf16 v[84:87], v[56:59], a[140:143], v[84:87]
  s_waitcnt lgkmcnt(2)
  buffer_load_dwordx4 a[52:55], v17, s[8:11], s71 offen offset:3072 sc1
  v_mfma_f32_16x16x32_bf16 v[92:95], v[60:63], a[140:143], v[92:95]
  ds_read_b64_tr_b16 v[52:53], v2 offset:4096
  s_add_u32 s71, s69, 24576
  v_mfma_f32_16x16x32_bf16 v[88:91], v[60:63], a[136:139], v[88:91]
  ds_read_b64_tr_b16 v[54:55], v2 offset:4352
  v_mul_f32 v123, v123, v43
  v_mfma_f32_16x16x32_bf16 v[188:191], v[60:63], a[132:135], v[188:191]
  v_cvt_pk_bf16_f32 v31, v122, v123
  v_fma_f32 v37, -v101, v101, v11
  v_mfma_f32_16x16x32_bf16 v[184:187], v[60:63], a[128:131], v[184:187]
  s_waitcnt lgkmcnt(2)
  buffer_store_dwordx4 v[28:31], v10, s[36:39], s55 offen offset:512 sc1
  v_mfma_f32_16x16x32_bf16 v[160:163], v[48:51], a[144:147], v[160:163]
  ds_read_b64_tr_b16 v[56:57], v1 offset:12288
  v_fma_f32 v38, -v102, v102, v11
  v_mfma_f32_16x16x32_bf16 v[164:167], v[48:51], a[148:151], v[164:167]
  ds_read_b64_tr_b16 v[58:59], v1 offset:12544
  v_fma_f32 v39, -v103, v103, v11
  v_mfma_f32_16x16x32_bf16 v[64:67], v[48:51], a[152:155], v[64:67]
  v_mul_f32 v36, v36, v100
  v_mul_f32 v37, v37, v101
  v_mfma_f32_16x16x32_bf16 v[68:71], v[48:51], a[156:159], v[68:71]
  s_waitcnt lgkmcnt(2)
  v_exp_f32 v36, v36
  v_mfma_f32_16x16x32_bf16 v[76:79], v[52:55], a[156:159], v[76:79]
  ds_read_b64_tr_b16 v[60:61], v2 offset:12288
  v_mul_f32 v38, v38, v102
  v_mfma_f32_16x16x32_bf16 v[72:75], v[52:55], a[152:155], v[72:75]
  ds_read_b64_tr_b16 v[62:63], v2 offset:12544
  v_mul_f32 v39, v39, v103
  v_mfma_f32_16x16x32_bf16 v[172:175], v[52:55], a[148:151], v[172:175]
  buffer_load_dwordx4 a[56:59], v17, s[8:11], s71 offen offset:0 sc1
  v_mfma_f32_16x16x32_bf16 v[168:171], v[52:55], a[144:147], v[168:171]
  s_waitcnt lgkmcnt(2)
  s_barrier
  v_xor_b32 v3, 0x20000, v3
  v_xor_b32 v4, 0x20000, v4
  v_mfma_f32_16x16x32_bf16 v[176:179], v[56:59], a[144:147], v[176:179]
  ds_read_b64_tr_b16 v[48:49], v1 offset:16384
  v_mul_f32 v116, v100, v116
  v_mfma_f32_16x16x32_bf16 v[180:183], v[56:59], a[148:151], v[180:183]
  ds_read_b64_tr_b16 v[50:51], v1 offset:16640
  v_mul_f32 v117, v101, v117
  v_mfma_f32_16x16x32_bf16 v[80:83], v[56:59], a[152:155], v[80:83]
  buffer_load_dwordx4 a[60:63], v17, s[8:11], s71 offen offset:1024 sc1
  v_mfma_f32_16x16x32_bf16 v[84:87], v[56:59], a[156:159], v[84:87]
  s_waitcnt lgkmcnt(2)
  v_exp_f32 v37, v37
  v_mfma_f32_16x16x32_bf16 v[92:95], v[60:63], a[156:159], v[92:95]
  ds_read_b64_tr_b16 v[52:53], v2 offset:16384
  v_mul_f32 v118, v102, v118
  v_mfma_f32_16x16x32_bf16 v[88:91], v[60:63], a[152:155], v[88:91]
  ds_read_b64_tr_b16 v[54:55], v2 offset:16640
  v_mul_f32 v119, v103, v119
  v_mfma_f32_16x16x32_bf16 v[188:191], v[60:63], a[148:151], v[188:191]
  buffer_load_dwordx4 a[64:67], v17, s[8:11], s71 offen offset:2048 sc1
  v_mfma_f32_16x16x32_bf16 v[184:187], v[60:63], a[144:147], v[184:187]
  s_waitcnt lgkmcnt(2)
  v_exp_f32 v38, v38
  v_mfma_f32_16x16x32_bf16 v[160:163], v[48:51], a[160:163], v[160:163]
  ds_read_b64_tr_b16 v[56:57], v1 offset:24576
  v_fma_f32 v36, v36, v12, v12
  v_mfma_f32_16x16x32_bf16 v[164:167], v[48:51], a[164:167], v[164:167]
  ds_read_b64_tr_b16 v[58:59], v1 offset:24832
  v_fma_f32 v37, v37, v12, v12
  v_mfma_f32_16x16x32_bf16 v[64:67], v[48:51], a[168:171], v[64:67]
  buffer_load_dwordx4 a[68:71], v17, s[8:11], s71 offen offset:3072 sc1
  v_mfma_f32_16x16x32_bf16 v[68:71], v[48:51], a[172:175], v[68:71]
  s_waitcnt lgkmcnt(2)
  s_add_u32 s71, s69, 28672
  v_fma_f32 v38, v38, v12, v12
  v_mfma_f32_16x16x32_bf16 v[76:79], v[52:55], a[172:175], v[76:79]
L_pad3:
  s_cbranch_execz L_pad5
  ds_read_b64_tr_b16 v[60:61], v2 offset:24576
  v_fma_f32 v40, -v108, v108, v11
  v_mfma_f32_16x16x32_bf16 v[72:75], v[52:55], a[168:171], v[72:75]
  ds_read_b64_tr_b16 v[62:63], v2 offset:24832
  v_fma_f32 v41, -v109, v109, v11
  v_mfma_f32_16x16x32_bf16 v[172:175], v[52:55], a[164:167], v[172:175]
  buffer_load_dwordx4 a[72:75], v17, s[8:11], s71 offen offset:0 sc1
  v_mfma_f32_16x16x32_bf16 v[168:171], v[52:55], a[160:163], v[168:171]
  s_waitcnt lgkmcnt(2)
  v_exp_f32 v39, v39
  v_mfma_f32_16x16x32_bf16 v[176:179], v[56:59], a[160:163], v[176:179]
  ds_read_b64_tr_b16 v[48:49], v1 offset:20480
  v_fma_f32 v39, v39, v12, v12
  v_mfma_f32_16x16x32_bf16 v[180:183], v[56:59], a[164:167], v[180:183]
  ds_read_b64_tr_b16 v[50:51], v1 offset:20736
  v_fma_f32 v42, -v110, v110, v11
  v_mfma_f32_16x16x32_bf16 v[80:83], v[56:59], a[168:171], v[80:83]
  v_rcp_f32 v36, v36
  v_mfma_f32_16x16x32_bf16 v[84:87], v[56:59], a[172:175], v[84:87]
  s_waitcnt lgkmcnt(2)
  buffer_load_dwordx4 a[76:79], v17, s[8:11], s71 offen offset:1024 sc1
  v_mfma_f32_16x16x32_bf16 v[92:95], v[60:63], a[172:175], v[92:95]
  ds_read_b64_tr_b16 v[52:53], v2 offset:20480
  s_add_u32 s71, s69, 8192
  v_mfma_f32_16x16x32_bf16 v[88:91], v[60:63], a[168:171], v[88:91]
  ds_read_b64_tr_b16 v[54:55], v2 offset:20736
  v_mul_f32 v116, v116, v36
  v_mfma_f32_16x16x32_bf16 v[188:191], v[60:63], a[164:167], v[188:191]
  v_rcp_f32 v37, v37
  v_mfma_f32_16x16x32_bf16 v[184:187], v[60:63], a[160:163], v[184:187]
  s_waitcnt lgkmcnt(2)
  buffer_load_dwordx4 a[80:83], v17, s[8:11], s71 offen offset:2048 sc1
  v_mfma_f32_16x16x32_bf16 v[160:163], v[48:51], a[176:179], v[160:163]
  ds_read_b64_tr_b16 v[56:57], v1 offset:28672
  v_mul_f32 v117, v117, v37
  v_mfma_f32_16x16x32_bf16 v[164:167], v[48:51], a[180:183], v[164:167]
  ds_read_b64_tr_b16 v[58:59], v1 offset:28928
  v_cvt_pk_bf16_f32 v32, v116, v117
  v_mfma_f32_16x16x32_bf16 v[64:67], v[48:51], a[184:187], v[64:67]
  v_rcp_f32 v38, v38
  v_mfma_f32_16x16x32_bf16 v[68:71], v[48:51], a[188:191], v[68:71]
  s_waitcnt lgkmcnt(2)
  buffer_load_dwordx4 a[84:87], v17, s[8:11], s71 offen offset:3072 sc1
  v_mfma_f32_16x16x32_bf16 v[76:79], v[52:55], a[188:191], v[76:79]
  ds_read_b64_tr_b16 v[60:61], v2 offset:28672
  v_mul_f32 v118, v118, v38
  v_mfma_f32_16x16x32_bf16 v[72:75], v[52:55], a[184:187], v[72:75]
  ds_read_b64_tr_b16 v[62:63], v2 offset:28928
  v_fma_f32 v43, -v111, v111, v11
  v_mfma_f32_16x16x32_bf16 v[172:175], v[52:55], a[180:183], v[172:175]
  v_rcp_f32 v39, v39
  v_mfma_f32_16x16x32_bf16 v[168:171], v[52:55], a[176:179], v[168:171]
  s_waitcnt lgkmcnt(2)
  s_barrier
  s_add_u32 m0, s47, 65536
  v_mfma_f32_16x16x32_bf16 v[176:179], v[56:59], a[176:179], v[176:179]
  ds_read_b64_tr_b16 v[48:49], v1 offset:32768
  v_mul_f32 v119, v119, v39
  v_mfma_f32_16x16x32_bf16 v[180:183], v[56:59], a[180:183], v[180:183]
  ds_read_b64_tr_b16 v[50:51], v1 offset:33024
  v_cvt_pk_bf16_f32 v33, v118, v119
  v_mfma_f32_16x16x32_bf16 v[80:83], v[56:59], a[184:187], v[80:83]
  buffer_load_dwordx4 v5, s[28:31], s43 offen offset:0 sc1 lds
  v_mfma_f32_16x16x32_bf16 v[84:87], v[56:59], a[188:191], v[84:87]
  s_waitcnt lgkmcnt(2)
  v_mul_f32 v40, v40, v108
  v_mul_f32 v41, v41, v109
  v_mfma_f32_16x16x32_bf16 v[92:95], v[60:63], a[188:191], v[92:95]
  ds_read_b64_tr_b16 v[52:53], v2 offset:32768
  v_mul_f32 v42, v42, v110
  v_mfma_f32_16x16x32_bf16 v[88:91], v[60:63], a[184:187], v[88:91]
  ds_read_b64_tr_b16 v[54:55], v2 offset:33024
  v_mul_f32 v43, v43, v111
  v_mfma_f32_16x16x32_bf16 v[188:191], v[60:63], a[180:183], v[188:191]
  buffer_load_dwordx4 v6, s[28:31], s43 offen offset:1024 sc1 lds
  v_mfma_f32_16x16x32_bf16 v[184:187], v[60:63], a[176:179], v[184:187]
  s_waitcnt lgkmcnt(2)
  v_exp_f32 v40, v40
  v_mfma_f32_16x16x32_bf16 v[160:163], v[48:51], a[192:195], v[160:163]
  ds_read_b64_tr_b16 v[56:57], v1 offset:40960
  v_mul_f32 v124, v108, v124
  v_mfma_f32_16x16x32_bf16 v[164:167], v[48:51], a[196:199], v[164:167]
  ds_read_b64_tr_b16 v[58:59], v1 offset:41216
  v_mul_f32 v125, v109, v125
  v_mfma_f32_16x16x32_bf16 v[64:67], v[48:51], a[200:203], v[64:67]
  buffer_load_dwordx4 v7, s[28:31], s43 offen offset:2048 sc1 lds
  v_mfma_f32_16x16x32_bf16 v[68:71], v[48:51], a[204:207], v[68:71]
  s_waitcnt lgkmcnt(2)
  v_exp_f32 v41, v41
  v_mfma_f32_16x16x32_bf16 v[76:79], v[52:55], a[204:207], v[76:79]
  ds_read_b64_tr_b16 v[60:61], v2 offset:40960
  v_mul_f32 v126, v110, v126
  v_mfma_f32_16x16x32_bf16 v[72:75], v[52:55], a[200:203], v[72:75]
  ds_read_b64_tr_b16 v[62:63], v2 offset:41216
  v_mul_f32 v127, v111, v127
  v_mfma_f32_16x16x32_bf16 v[172:175], v[52:55], a[196:199], v[172:175]
  buffer_load_dwordx4 v8, s[28:31], s43 offen offset:3072 sc1 lds
  v_mfma_f32_16x16x32_bf16 v[168:171], v[52:55], a[192:195], v[168:171]
  s_waitcnt lgkmcnt(2)
  s_add_u32 s43, s43, s46
  v_fma_f32 v40, v40, v12, v12
  v_mfma_f32_16x16x32_bf16 v[176:179], v[56:59], a[192:195], v[176:179]
  ds_read_b64_tr_b16 v[48:49], v1 offset:36864
  s_add_u32 s71, s69, 12288
  v_mfma_f32_16x16x32_bf16 v[180:183], v[56:59], a[196:199], v[180:183]
  ds_read_b64_tr_b16 v[50:51], v1 offset:37120
  v_fma_f32 v41, v41, v12, v12
  v_mfma_f32_16x16x32_bf16 v[80:83], v[56:59], a[200:203], v[80:83]
  buffer_load_dwordx4 a[88:91], v17, s[8:11], s71 offen offset:0 sc1
  v_mfma_f32_16x16x32_bf16 v[84:87], v[56:59], a[204:207], v[84:87]
  s_waitcnt lgkmcnt(2)
  v_exp_f32 v42, v42
  v_mfma_f32_16x16x32_bf16 v[92:95], v[60:63], a[204:207], v[92:95]
  ds_read_b64_tr_b16 v[52:53], v2 offset:36864
  v_fma_f32 v42, v42, v12, v12
  v_mfma_f32_16x16x32_bf16 v[88:91], v[60:63], a[200:203], v[88:91]
  ds_read_b64_tr_b16 v[54:55], v2 offset:37120
  v_mfma_f32_16x16x32_bf16 v[188:191], v[60:63], a[196:199], v[188:191]
  v_exp_f32 v43, v43
  v_mfma_f32_16x16x32_bf16 v[184:187], v[60:63], a[192:195], v[184:187]
  s_waitcnt lgkmcnt(2)
  buffer_load_dwordx4 a[92:95], v17, s[8:11], s71 offen offset:1024 sc1
  v_mfma_f32_16x16x32_bf16 v[160:163], v[48:51], a[208:211], v[160:163]
  ds_read_b64_tr_b16 v[56:57], v1 offset:45056
  v_fma_f32 v43, v43, v12, v12
  v_mfma_f32_16x16x32_bf16 v[164:167], v[48:51], a[212:215], v[164:167]
  ds_read_b64_tr_b16 v[58:59], v1 offset:45312
  v_mfma_f32_16x16x32_bf16 v[64:67], v[48:51], a[216:219], v[64:67]
  v_rcp_f32 v40, v40
  v_mfma_f32_16x16x32_bf16 v[68:71], v[48:51], a[220:223], v[68:71]
  s_waitcnt lgkmcnt(2)
  buffer_load_dwordx4 a[96:99], v17, s[8:11], s71 offen offset:2048 sc1
  v_mfma_f32_16x16x32_bf16 v[76:79], v[52:55], a[220:223], v[76:79]
  ds_read_b64_tr_b16 v[60:61], v2 offset:45056
  v_mul_f32 v124, v124, v40
  v_mfma_f32_16x16x32_bf16 v[72:75], v[52:55], a[216:219], v[72:75]
  ds_read_b64_tr_b16 v[62:63], v2 offset:45312
  v_mfma_f32_16x16x32_bf16 v[172:175], v[52:55], a[212:215], v[172:175]
  v_rcp_f32 v41, v41
  v_mfma_f32_16x16x32_bf16 v[168:171], v[52:55], a[208:211], v[168:171]
  s_waitcnt lgkmcnt(2)
  s_barrier
  v_rcp_f32 v42, v42
  v_rcp_f32 v43, v43
  v_mul_f32 v125, v125, v41
  v_mul_f32 v126, v126, v42
  v_mul_f32 v127, v127, v43
  v_cvt_pk_bf16_f32 v34, v124, v125
  v_cvt_pk_bf16_f32 v35, v126, v127
  buffer_store_dwordx4 v[32:35], v10, s[36:39], s55 offen offset:768 sc1
  buffer_load_dwordx4 a[100:103], v17, s[8:11], s71 offen offset:3072 sc1
  s_add_u32 s71, s69, 16384
  buffer_load_dwordx4 a[104:107], v17, s[8:11], s71 offen offset:0 sc1
  buffer_load_dwordx4 a[108:111], v17, s[8:11], s71 offen offset:1024 sc1
  s_branch L_join
L_typeB:
L_pad4:
  s_cbranch_execz L_pad6
  v_mfma_f32_16x16x32_bf16 v[128:131], v[48:51], a[0:3], 0
  ds_read_b64_tr_b16 v[56:57], v1 offset:4096
  v_mfma_f32_16x16x32_bf16 v[132:135], v[48:51], a[4:7], 0
  ds_read_b64_tr_b16 v[58:59], v1 offset:4352
  v_mfma_f32_16x16x32_bf16 v[144:147], v[48:51], a[8:11], 0
  buffer_load_dwordx4 v7, s[24:27], s42 offen offset:2048 sc1 lds
  v_mfma_f32_16x16x32_bf16 v[148:151], v[48:51], a[12:15], 0
  s_waitcnt lgkmcnt(2)
  v_mfma_f32_16x16x32_bf16 v[156:159], v[52:55], a[12:15], 0
  ds_read_b64_tr_b16 v[60:61], v2 offset:4096
  s_add_u32 s59, s49, 0x10000
  v_mfma_f32_16x16x32_bf16 v[152:155], v[52:55], a[8:11], 0
  ds_read_b64_tr_b16 v[62:63], v2 offset:4352
  v_mul_f32 v64, s52, v64
  v_mfma_f32_16x16x32_bf16 v[140:143], v[52:55], a[4:7], 0
  buffer_load_dwordx4 v8, s[24:27], s42 offen offset:3072 sc1 lds
  v_mfma_f32_16x16x32_bf16 v[136:139], v[52:55], a[0:3], 0
  s_waitcnt lgkmcnt(2)
  s_add_u32 s42, s42, s45
  v_mul_f32 v65, s52, v65
  v_mfma_f32_16x16x32_bf16 v[128:131], v[56:59], a[16:19], v[128:131]
  ds_read_b64_tr_b16 v[48:49], v1 offset:8192
  v_mul_f32 v66, s52, v66
  v_mfma_f32_16x16x32_bf16 v[132:135], v[56:59], a[20:23], v[132:135]
  ds_read_b64_tr_b16 v[50:51], v1 offset:8448
  v_mul_f32 v67, s52, v67
  v_mfma_f32_16x16x32_bf16 v[144:147], v[56:59], a[24:27], v[144:147]
  v_cvt_pk_bf16_f32 v20, v64, v65
  v_cvt_pk_bf16_f32 v21, v66, v67
  v_mfma_f32_16x16x32_bf16 v[148:151], v[56:59], a[28:31], v[148:151]
  s_waitcnt lgkmcnt(2)
  v_mul_f32 v68, s52, v68
  v_mul_f32 v69, s52, v69
  v_mfma_f32_16x16x32_bf16 v[156:159], v[60:63], a[28:31], v[156:159]
  ds_read_b64_tr_b16 v[52:53], v2 offset:8192
  v_mul_f32 v70, s52, v70
  v_mfma_f32_16x16x32_bf16 v[152:155], v[60:63], a[24:27], v[152:155]
  ds_read_b64_tr_b16 v[54:55], v2 offset:8448
  v_mul_f32 v71, s52, v71
  v_mfma_f32_16x16x32_bf16 v[140:143], v[60:63], a[20:23], v[140:143]
  v_cvt_pk_bf16_f32 v22, v68, v69
  v_cvt_pk_bf16_f32 v23, v70, v71
  v_mfma_f32_16x16x32_bf16 v[136:139], v[60:63], a[16:19], v[136:139]
  s_waitcnt lgkmcnt(2)
  buffer_store_dwordx4 v[20:23], v9, s[32:35], s49 offen offset:0 sc1
  v_mfma_f32_16x16x32_bf16 v[128:131], v[48:51], a[32:35], v[128:131]
  ds_read_b64_tr_b16 v[56:57], v1 offset:12288
  v_mul_f32 v72, s52, v72
  v_mfma_f32_16x16x32_bf16 v[132:135], v[48:51], a[36:39], v[132:135]
  ds_read_b64_tr_b16 v[58:59], v1 offset:12544
  v_mul_f32 v73, s52, v73
  v_mfma_f32_16x16x32_bf16 v[144:147], v[48:51], a[40:43], v[144:147]
  v_mul_f32 v74, s52, v74
  v_mul_f32 v75, s52, v75
  v_mfma_f32_16x16x32_bf16 v[148:151], v[48:51], a[44:47], v[148:151]
  s_waitcnt lgkmcnt(2)
  v_cvt_pk_bf16_f32 v24, v72, v73
  v_cvt_pk_bf16_f32 v25, v74, v75
  v_mfma_f32_16x16x32_bf16 v[156:159], v[52:55], a[44:47], v[156:159]
  ds_read_b64_tr_b16 v[60:61], v2 offset:12288
  v_mul_f32 v76, s52, v76
  v_mfma_f32_16x16x32_bf16 v[152:155], v[52:55], a[40:43], v[152:155]
  ds_read_b64_tr_b16 v[62:63], v2 offset:12544
  v_mul_f32 v77, s52, v77
  v_mfma_f32_16x16x32_bf16 v[140:143], v[52:55], a[36:39], v[140:143]
  v_mul_f32 v78, s52, v78
  v_mul_f32 v79, s52, v79
  v_mfma_f32_16x16x32_bf16 v[136:139], v[52:55], a[32:35], v[136:139]
  s_waitcnt lgkmcnt(2)
  s_waitcnt vmcnt(10)
  s_barrier
  s_add_u32 m0, s47, 131072
  v_mfma_f32_16x16x32_bf16 v[128:131], v[56:59], a[48:51], v[128:131]
  ds_read_b64_tr_b16 v[48:49], v1 offset:16384
  v_cvt_pk_bf16_f32 v26, v76, v77
  v_mfma_f32_16x16x32_bf16 v[132:135], v[56:59], a[52:55], v[132:135]
  ds_read_b64_tr_b16 v[50:51], v1 offset:16640
  v_cvt_pk_bf16_f32 v27, v78, v79
  v_mfma_f32_16x16x32_bf16 v[144:147], v[56:59], a[56:59], v[144:147]
  buffer_load_dwordx4 v5, s[24:27], s42 offen offset:0 sc1 lds
  v_mfma_f32_16x16x32_bf16 v[148:151], v[56:59], a[60:63], v[148:151]
  s_waitcnt lgkmcnt(2)
  buffer_store_dwordx4 v[24:27], v9, s[32:35], s59 offen offset:0 sc1
  v_mfma_f32_16x16x32_bf16 v[156:159], v[60:63], a[60:63], v[156:159]
  ds_read_b64_tr_b16 v[52:53], v2 offset:16384
  s_add_u32 s59, s50, 0x10000
  v_mfma_f32_16x16x32_bf16 v[152:155], v[60:63], a[56:59], v[152:155]
  ds_read_b64_tr_b16 v[54:55], v2 offset:16640
  v_mul_f32 v80, s53, v80
  v_mfma_f32_16x16x32_bf16 v[140:143], v[60:63], a[52:55], v[140:143]
  v_mul_f32 v81, s53, v81
  v_mul_f32 v82, s53, v82
  v_mfma_f32_16x16x32_bf16 v[136:139], v[60:63], a[48:51], v[136:139]
  s_waitcnt lgkmcnt(2)
  v_mul_f32 v83, s53, v83
  v_cvt_pk_bf16_f32 v28, v80, v81
  v_mfma_f32_16x16x32_bf16 v[128:131], v[48:51], a[64:67], v[128:131]
  ds_read_b64_tr_b16 v[56:57], v1 offset:20480
  v_cvt_pk_bf16_f32 v29, v82, v83
  v_mfma_f32_16x16x32_bf16 v[132:135], v[48:51], a[68:71], v[132:135]
  ds_read_b64_tr_b16 v[58:59], v1 offset:20736
  v_mul_f32 v84, s53, v84
  v_mfma_f32_16x16x32_bf16 v[144:147], v[48:51], a[72:75], v[144:147]
  buffer_load_dwordx4 v6, s[24:27], s42 offen offset:1024 sc1 lds
  v_mfma_f32_16x16x32_bf16 v[148:151], v[48:51], a[76:79], v[148:151]
  s_waitcnt lgkmcnt(2)
  v_mul_f32 v85, s53, v85
  v_mul_f32 v86, s53, v86
  v_mfma_f32_16x16x32_bf16 v[156:159], v[52:55], a[76:79], v[156:159]
  ds_read_b64_tr_b16 v[60:61], v2 offset:20480
  v_mul_f32 v87, s53, v87
  v_mfma_f32_16x16x32_bf16 v[152:155], v[52:55], a[72:75], v[152:155]
  ds_read_b64_tr_b16 v[62:63], v2 offset:20736
  v_cvt_pk_bf16_f32 v30, v84, v85
  v_mfma_f32_16x16x32_bf16 v[140:143], v[52:55], a[68:71], v[140:143]
  buffer_load_dwordx4 v7, s[24:27], s42 offen offset:2048 sc1 lds
  v_mfma_f32_16x16x32_bf16 v[136:139], v[52:55], a[64:67], v[136:139]
  s_waitcnt lgkmcnt(2)
  v_cvt_pk_bf16_f32 v31, v86, v87
  v_mul_f32 v88, s53, v88
  v_mfma_f32_16x16x32_bf16 v[128:131], v[56:59], a[80:83], v[128:131]
  ds_read_b64_tr_b16 v[48:49], v1 offset:24576
  v_mul_f32 v89, s53, v89
  v_mfma_f32_16x16x32_bf16 v[132:135], v[56:59], a[84:87], v[132:135]
  ds_read_b64_tr_b16 v[50:51], v1 offset:24832
  v_mul_f32 v90, s53, v90
  v_mfma_f32_16x16x32_bf16 v[144:147], v[56:59], a[88:91], v[144:147]
  buffer_load_dwordx4 v8, s[24:27], s42 offen offset:3072 sc1 lds
  v_mfma_f32_16x16x32_bf16 v[148:151], v[56:59], a[92:95], v[148:151]
  s_waitcnt lgkmcnt(2)
  s_add_u32 s42, s42, s45
  v_mul_u32_u24 v5, 3072, v18
  v_mfma_f32_16x16x32_bf16 v[156:159], v[60:63], a[92:95], v[156:159]
  ds_read_b64_tr_b16 v[52:53], v2 offset:24576
  s_movk_i32 s58, 23552
  v_mfma_f32_16x16x32_bf16 v[152:155], v[60:63], a[88:91], v[152:155]
  ds_read_b64_tr_b16 v[54:55], v2 offset:24832
  v_add_u32 v5, v5, v19
  v_mfma_f32_16x16x32_bf16 v[140:143], v[60:63], a[84:87], v[140:143]
  v_xor_b32 v6, 32, v5
  v_add_u32 v6, s58, v6
  v_mfma_f32_16x16x32_bf16 v[136:139], v[60:63], a[80:83], v[136:139]
  s_waitcnt lgkmcnt(2)
  s_lshl_b32 s58, s58, 1
  v_add_u32 v7, s58, v5
  v_mfma_f32_16x16x32_bf16 v[128:131], v[48:51], a[96:99], v[128:131]
  ds_read_b64_tr_b16 v[56:57], v1 offset:28672
  v_add_u32 v8, s58, v6
  v_mfma_f32_16x16x32_bf16 v[132:135], v[48:51], a[100:103], v[132:135]
  ds_read_b64_tr_b16 v[58:59], v1 offset:28928
  s_add_u32 m0, s47, 0
  v_mfma_f32_16x16x32_bf16 v[144:147], v[48:51], a[104:107], v[144:147]
  buffer_load_dwordx4 v5, s[28:31], s43 offen offset:0 sc1 lds
  v_mfma_f32_16x16x32_bf16 v[148:151], v[48:51], a[108:111], v[148:151]
  s_waitcnt lgkmcnt(2)
  buffer_store_dwordx4 v[28:31], v9, s[32:35], s50 offen offset:0 sc1
  v_mfma_f32_16x16x32_bf16 v[156:159], v[52:55], a[108:111], v[156:159]
  ds_read_b64_tr_b16 v[60:61], v2 offset:28672
  v_mul_f32 v91, s53, v91
  v_mfma_f32_16x16x32_bf16 v[152:155], v[52:55], a[104:107], v[152:155]
  ds_read_b64_tr_b16 v[62:63], v2 offset:28928
  v_cvt_pk_bf16_f32 v32, v88, v89
  v_mfma_f32_16x16x32_bf16 v[140:143], v[52:55], a[100:103], v[140:143]
  v_cvt_pk_bf16_f32 v33, v90, v91
  v_mul_f32 v92, s53, v92
  v_mfma_f32_16x16x32_bf16 v[136:139], v[52:55], a[96:99], v[136:139]
  s_waitcnt lgkmcnt(2)
  s_waitcnt vmcnt(13)
  s_barrier
  v_mfma_f32_16x16x32_bf16 v[128:131], v[56:59], a[112:115], v[128:131]
  ds_read_b64_tr_b16 v[48:49], v1 offset:32768
  v_mul_f32 v93, s53, v93
  v_mfma_f32_16x16x32_bf16 v[132:135], v[56:59], a[116:119], v[132:135]
  ds_read_b64_tr_b16 v[50:51], v1 offset:33024
  v_mul_f32 v94, s53, v94
  v_mfma_f32_16x16x32_bf16 v[144:147], v[56:59], a[120:123], v[144:147]
  buffer_load_dwordx4 v6, s[28:31], s43 offen offset:1024 sc1 lds
  v_mfma_f32_16x16x32_bf16 v[148:151], v[56:59], a[124:127], v[148:151]
  s_waitcnt lgkmcnt(2)
  v_mul_f32 v95, s53, v95
  v_cvt_pk_bf16_f32 v34, v92, v93
  v_mfma_f32_16x16x32_bf16 v[156:159], v[60:63], a[124:127], v[156:159]
  ds_read_b64_tr_b16 v[52:53], v2 offset:32768
  v_cvt_pk_bf16_f32 v35, v94, v95
  v_mfma_f32_16x16x32_bf16 v[152:155], v[60:63], a[120:123], v[152:155]
  ds_read_b64_tr_b16 v[54:55], v2 offset:33024
  v_mul_f32 v96, s52, v96
  v_mfma_f32_16x16x32_bf16 v[140:143], v[60:63], a[116:119], v[140:143]
  buffer_load_dwordx4 v7, s[28:31], s43 offen offset:2048 sc1 lds
  v_mfma_f32_16x16x32_bf16 v[136:139], v[60:63], a[112:115], v[136:139]
  s_waitcnt lgkmcnt(2)
  buffer_store_dwordx4 v[32:35], v9, s[32:35], s59 offen offset:0 sc1
  v_mfma_f32_16x16x32_bf16 v[128:131], v[48:51], a[128:131], v[128:131]
  ds_read_b64_tr_b16 v[56:57], v1 offset:36864
  s_add_u32 s59, s49, 0x10000
  v_mfma_f32_16x16x32_bf16 v[132:135], v[48:51], a[132:135], v[132:135]
  ds_read_b64_tr_b16 v[58:59], v1 offset:37120
  v_mul_f32 v97, s52, v97
  v_mfma_f32_16x16x32_bf16 v[144:147], v[48:51], a[136:139], v[144:147]
  v_mul_f32 v98, s52, v98
  v_mul_f32 v99, s52, v99
  v_mfma_f32_16x16x32_bf16 v[148:151], v[48:51], a[140:143], v[148:151]
  s_waitcnt lgkmcnt(2)
  v_cvt_pk_bf16_f32 v20, v96, v97
  v_cvt_pk_bf16_f32 v21, v98, v99
  v_mfma_f32_16x16x32_bf16 v[156:159], v[52:55], a[140:143], v[156:159]
  ds_read_b64_tr_b16 v[60:61], v2 offset:36864
  v_mul_f32 v100, s52, v100
  v_mfma_f32_16x16x32_bf16 v[152:155], v[52:55], a[136:139], v[152:155]
  ds_read_b64_tr_b16 v[62:63], v2 offset:37120
  v_mul_f32 v101, s52, v101
  v_mfma_f32_16x16x32_bf16 v[140:143], v[52:55], a[132:135], v[140:143]
  v_mul_f32 v102, s52, v102
  v_mul_f32 v103, s52, v103
  v_mfma_f32_16x16x32_bf16 v[136:139], v[52:55], a[128:131], v[136:139]
  s_waitcnt lgkmcnt(2)
  buffer_load_dwordx4 v8, s[28:31], s43 offen offset:3072 sc1 lds
  v_mfma_f32_16x16x32_bf16 v[128:131], v[56:59], a[144:147], v[128:131]
  ds_read_b64_tr_b16 v[48:49], v1 offset:40960
  s_add_u32 s43, s43, s46
  v_mfma_f32_16x16x32_bf16 v[132:135], v[56:59], a[148:151], v[132:135]
  ds_read_b64_tr_b16 v[50:51], v1 offset:41216
  s_add_u32 m0, s47, 16384
  v_mfma_f32_16x16x32_bf16 v[144:147], v[56:59], a[152:155], v[144:147]
  v_cvt_pk_bf16_f32 v22, v100, v101
  v_cvt_pk_bf16_f32 v23, v102, v103
  v_mfma_f32_16x16x32_bf16 v[148:151], v[56:59], a[156:159], v[148:151]
  s_waitcnt lgkmcnt(2)
  buffer_load_dwordx4 v5, s[28:31], s43 offen offset:0 sc1 lds
  v_mfma_f32_16x16x32_bf16 v[156:159], v[60:63], a[156:159], v[156:159]
  ds_read_b64_tr_b16 v[52:53], v2 offset:40960
  v_mul_f32 v104, s52, v104
  v_mfma_f32_16x16x32_bf16 v[152:155], v[60:63], a[152:155], v[152:155]
  ds_read_b64_tr_b16 v[54:55], v2 offset:41216
  v_mul_f32 v105, s52, v105
  v_mfma_f32_16x16x32_bf16 v[140:143], v[60:63], a[148:151], v[140:143]
  buffer_store_dwordx4 v[20:23], v9, s[32:35], s49 offen offset:256 sc1
  v_mfma_f32_16x16x32_bf16 v[136:139], v[60:63], a[144:147], v[136:139]
  s_waitcnt lgkmcnt(2)
  v_mul_f32 v106, s52, v106
  v_mul_f32 v107, s52, v107
  v_mfma_f32_16x16x32_bf16 v[128:131], v[48:51], a[160:163], v[128:131]
  ds_read_b64_tr_b16 v[56:57], v1 offset:45056
  v_cvt_pk_bf16_f32 v24, v104, v105
  v_mfma_f32_16x16x32_bf16 v[132:135], v[48:51], a[164:167], v[132:135]
  ds_read_b64_tr_b16 v[58:59], v1 offset:45312
  v_cvt_pk_bf16_f32 v25, v106, v107
  v_mfma_f32_16x16x32_bf16 v[144:147], v[48:51], a[168:171], v[144:147]
  v_mul_f32 v108, s52, v108
  v_mul_f32 v109, s52, v109
  v_mfma_f32_16x16x32_bf16 v[148:151], v[48:51], a[172:175], v[148:151]
  s_waitcnt lgkmcnt(2)
  v_mul_f32 v110, s52, v110
  v_mul_f32 v111, s52, v111
  v_mfma_f32_16x16x32_bf16 v[156:159], v[52:55], a[172:175], v[156:159]
  ds_read_b64_tr_b16 v[60:61], v2 offset:45056
  v_cvt_pk_bf16_f32 v26, v108, v109
  v_mfma_f32_16x16x32_bf16 v[152:155], v[52:55], a[168:171], v[152:155]
  ds_read_b64_tr_b16 v[62:63], v2 offset:45312
  v_cvt_pk_bf16_f32 v27, v110, v111
  v_mfma_f32_16x16x32_bf16 v[140:143], v[52:55], a[164:167], v[140:143]
  buffer_load_dwordx4 v6, s[28:31], s43 offen offset:1024 sc1 lds
  v_mfma_f32_16x16x32_bf16 v[136:139], v[52:55], a[160:163], v[136:139]
  s_waitcnt lgkmcnt(2)
  s_waitcnt vmcnt(15)
  s_barrier
  v_mfma_f32_16x16x32_bf16 v[128:131], v[56:59], a[176:179], v[128:131]
  ds_read_b64_tr_b16 v[48:49], v1 offset:49152
  v_lshlrev_b32 v16, 2, v0
  v_mfma_f32_16x16x32_bf16 v[132:135], v[56:59], a[180:183], v[132:135]
  ds_read_b64_tr_b16 v[50:51], v1 offset:49408
  v_add_u32 v16, 0x8000, v16
  v_mfma_f32_16x16x32_bf16 v[144:147], v[56:59], a[184:187], v[144:147]
  s_mov_b32 s0, 0
  buffer_load_dword v15, v16, s[12:15], s0 offen sc1
  v_mfma_f32_16x16x32_bf16 v[148:151], v[56:59], a[188:191], v[148:151]
  s_waitcnt lgkmcnt(2)
  buffer_store_dwordx4 v[24:27], v9, s[32:35], s59 offen offset:256 sc1
  v_mfma_f32_16x16x32_bf16 v[156:159], v[60:63], a[188:191], v[156:159]
  ds_read_b64_tr_b16 v[52:53], v2 offset:49152
  s_add_u32 s59, s50, 0x10000
  v_mfma_f32_16x16x32_bf16 v[152:155], v[60:63], a[184:187], v[152:155]
  ds_read_b64_tr_b16 v[54:55], v2 offset:49408
  v_mul_f32 v112, s53, v112
  v_mfma_f32_16x16x32_bf16 v[140:143], v[60:63], a[180:183], v[140:143]
  v_mul_f32 v113, s53, v113
  v_mul_f32 v114, s53, v114
  v_mfma_f32_16x16x32_bf16 v[136:139], v[60:63], a[176:179], v[136:139]
  s_waitcnt lgkmcnt(2)
  v_mul_f32 v115, s53, v115
  v_cvt_pk_bf16_f32 v28, v112, v113
  v_mfma_f32_16x16x32_bf16 v[128:131], v[48:51], a[192:195], v[128:131]
  ds_read_b64_tr_b16 v[56:57], v1 offset:53248
  v_cvt_pk_bf16_f32 v29, v114, v115
  v_mfma_f32_16x16x32_bf16 v[132:135], v[48:51], a[196:199], v[132:135]
  ds_read_b64_tr_b16 v[58:59], v1 offset:53504
  v_mul_f32 v116, s53, v116
  v_mfma_f32_16x16x32_bf16 v[144:147], v[48:51], a[200:203], v[144:147]
  buffer_load_dwordx4 v7, s[28:31], s43 offen offset:2048 sc1 lds
  v_mfma_f32_16x16x32_bf16 v[148:151], v[48:51], a[204:207], v[148:151]
  s_waitcnt lgkmcnt(2)
  v_mul_f32 v117, s53, v117
  v_mul_f32 v118, s53, v118
  v_mfma_f32_16x16x32_bf16 v[156:159], v[52:55], a[204:207], v[156:159]
  ds_read_b64_tr_b16 v[60:61], v2 offset:53248
  v_mul_f32 v119, s53, v119
  v_mfma_f32_16x16x32_bf16 v[152:155], v[52:55], a[200:203], v[152:155]
  ds_read_b64_tr_b16 v[62:63], v2 offset:53504
  v_cvt_pk_bf16_f32 v30, v116, v117
  v_mfma_f32_16x16x32_bf16 v[140:143], v[52:55], a[196:199], v[140:143]
  buffer_load_dwordx4 v8, s[28:31], s43 offen offset:3072 sc1 lds
  v_mfma_f32_16x16x32_bf16 v[136:139], v[52:55], a[192:195], v[136:139]
  s_waitcnt lgkmcnt(2)
  s_add_u32 s43, s43, s46
  s_add_u32 m0, s47, 32768
  v_mfma_f32_16x16x32_bf16 v[128:131], v[56:59], a[208:211], v[128:131]
  ds_read_b64_tr_b16 v[48:49], v1 offset:57344
  v_cvt_pk_bf16_f32 v31, v118, v119
  v_mfma_f32_16x16x32_bf16 v[132:135], v[56:59], a[212:215], v[132:135]
  ds_read_b64_tr_b16 v[50:51], v1 offset:57600
  v_mul_f32 v120, s53, v120
  v_mfma_f32_16x16x32_bf16 v[144:147], v[56:59], a[216:219], v[144:147]
  buffer_store_dwordx4 v[28:31], v9, s[32:35], s50 offen offset:256 sc1
  v_mfma_f32_16x16x32_bf16 v[148:151], v[56:59], a[220:223], v[148:151]
  s_waitcnt lgkmcnt(2)
  v_mul_f32 v121, s53, v121
  v_mul_f32 v122, s53, v122
  v_mfma_f32_16x16x32_bf16 v[156:159], v[60:63], a[220:223], v[156:159]
  ds_read_b64_tr_b16 v[52:53], v2 offset:57344
  v_mul_f32 v123, s53, v123
  v_mfma_f32_16x16x32_bf16 v[152:155], v[60:63], a[216:219], v[152:155]
  ds_read_b64_tr_b16 v[54:55], v2 offset:57600
  v_cvt_pk_bf16_f32 v32, v120, v121
  v_mfma_f32_16x16x32_bf16 v[140:143], v[60:63], a[212:215], v[140:143]
  v_cvt_pk_bf16_f32 v33, v122, v123
  v_mul_f32 v124, s53, v124
  v_mfma_f32_16x16x32_bf16 v[136:139], v[60:63], a[208:211], v[136:139]
  s_waitcnt lgkmcnt(2)
  buffer_load_dwordx4 v5, s[28:31], s43 offen offset:0 sc1 lds
  v_mfma_f32_16x16x32_bf16 v[128:131], v[48:51], a[224:227], v[128:131]
  ds_read_b64_tr_b16 v[56:57], v1 offset:61440
  v_mul_f32 v125, s53, v125
  v_mfma_f32_16x16x32_bf16 v[132:135], v[48:51], a[228:231], v[132:135]
  ds_read_b64_tr_b16 v[58:59], v1 offset:61696
  v_mul_f32 v126, s53, v126
  v_mfma_f32_16x16x32_bf16 v[144:147], v[48:51], a[232:235], v[144:147]
  v_mul_f32 v127, s53, v127
  v_cvt_pk_bf16_f32 v34, v124, v125
  v_mfma_f32_16x16x32_bf16 v[148:151], v[48:51], a[236:239], v[148:151]
  s_waitcnt lgkmcnt(2)
  buffer_load_dwordx4 v6, s[28:31], s43 offen offset:1024 sc1 lds
  v_mfma_f32_16x16x32_bf16 v[156:159], v[52:55], a[236:239], v[156:159]
  ds_read_b64_tr_b16 v[60:61], v2 offset:61440
  v_cvt_pk_bf16_f32 v35, v126, v127
  v_mfma_f32_16x16x32_bf16 v[152:155], v[52:55], a[232:235], v[152:155]
  ds_read_b64_tr_b16 v[62:63], v2 offset:61696
  v_mfma_f32_16x16x32_bf16 v[140:143], v[52:55], a[228:231], v[140:143]
  buffer_store_dwordx4 v[32:35], v9, s[32:35], s59 offen offset:256 sc1
  v_mfma_f32_16x16x32_bf16 v[136:139], v[52:55], a[224:227], v[136:139]
  s_waitcnt lgkmcnt(2)
  s_waitcnt vmcnt(17)
  s_barrier
  v_mfma_f32_16x16x32_bf16 v[128:131], v[56:59], a[240:243], v[128:131]
  ds_read_b64_tr_b16 v[48:49], v3 offset:0
  v_mfma_f32_16x16x32_bf16 v[132:135], v[56:59], a[244:247], v[132:135]
  ds_read_b64_tr_b16 v[50:51], v3 offset:256
  v_mfma_f32_16x16x32_bf16 v[144:147], v[56:59], a[248:251], v[144:147]
  v_mfma_f32_16x16x32_bf16 v[148:151], v[56:59], a[252:255], v[148:151]
  s_waitcnt lgkmcnt(2)
  v_mfma_f32_16x16x32_bf16 v[156:159], v[60:63], a[252:255], v[156:159]
  ds_read_b64_tr_b16 v[52:53], v4 offset:0
  v_mfma_f32_16x16x32_bf16 v[152:155], v[60:63], a[248:251], v[152:155]
  ds_read_b64_tr_b16 v[54:55], v4 offset:256
  v_mfma_f32_16x16x32_bf16 v[140:143], v[60:63], a[244:247], v[140:143]
  buffer_load_dwordx4 v7, s[28:31], s43 offen offset:2048 sc1 lds
  v_mfma_f32_16x16x32_bf16 v[136:139], v[60:63], a[240:243], v[136:139]
  s_waitcnt lgkmcnt(2)
  v_mfma_f32_16x16x32_bf16 v[128:131], v[48:51], v[192:195], v[128:131]
  ds_read_b64_tr_b16 v[56:57], v3 offset:4096
  v_mfma_f32_16x16x32_bf16 v[132:135], v[48:51], v[196:199], v[132:135]
  ds_read_b64_tr_b16 v[58:59], v3 offset:4352
  v_mfma_f32_16x16x32_bf16 v[144:147], v[48:51], v[200:203], v[144:147]
  buffer_load_dwordx4 v8, s[28:31], s43 offen offset:3072 sc1 lds
  v_mfma_f32_16x16x32_bf16 v[148:151], v[48:51], v[204:207], v[148:151]
  s_waitcnt lgkmcnt(2)
  s_add_u32 s43, s43, s46
  s_add_u32 m0, s47, 49152
  v_mfma_f32_16x16x32_bf16 v[156:159], v[52:55], v[204:207], v[156:159]
  ds_read_b64_tr_b16 v[60:61], v4 offset:4096
  v_mfma_f32_16x16x32_bf16 v[152:155], v[52:55], v[200:203], v[152:155]
  ds_read_b64_tr_b16 v[62:63], v4 offset:4352
  v_mfma_f32_16x16x32_bf16 v[140:143], v[52:55], v[196:199], v[140:143]
  buffer_load_dwordx4 v5, s[28:31], s43 offen offset:0 sc1 lds
  v_mfma_f32_16x16x32_bf16 v[136:139], v[52:55], v[192:195], v[136:139]
  s_waitcnt lgkmcnt(2)
  v_mfma_f32_16x16x32_bf16 v[128:131], v[56:59], v[208:211], v[128:131]
  ds_read_b64_tr_b16 v[48:49], v3 offset:8192
  v_mfma_f32_16x16x32_bf16 v[132:135], v[56:59], v[212:215], v[132:135]
  ds_read_b64_tr_b16 v[50:51], v3 offset:8448
  v_mfma_f32_16x16x32_bf16 v[144:147], v[56:59], v[216:219], v[144:147]
  buffer_load_dwordx4 v6, s[28:31], s43 offen offset:1024 sc1 lds
  v_mfma_f32_16x16x32_bf16 v[148:151], v[56:59], v[220:223], v[148:151]
  s_waitcnt lgkmcnt(2)
  v_mfma_f32_16x16x32_bf16 v[156:159], v[60:63], v[220:223], v[156:159]
  ds_read_b64_tr_b16 v[52:53], v4 offset:8192
  v_mfma_f32_16x16x32_bf16 v[152:155], v[60:63], v[216:219], v[152:155]
  ds_read_b64_tr_b16 v[54:55], v4 offset:8448
  v_mfma_f32_16x16x32_bf16 v[140:143], v[60:63], v[212:215], v[140:143]
  buffer_load_dwordx4 v7, s[28:31], s43 offen offset:2048 sc1 lds
  v_mfma_f32_16x16x32_bf16 v[136:139], v[60:63], v[208:211], v[136:139]
  s_waitcnt lgkmcnt(2)
  v_mfma_f32_16x16x32_bf16 v[128:131], v[48:51], v[224:227], v[128:131]
  ds_read_b64_tr_b16 v[56:57], v3 offset:12288
  v_mfma_f32_16x16x32_bf16 v[132:135], v[48:51], v[228:231], v[132:135]
  ds_read_b64_tr_b16 v[58:59], v3 offset:12544
  v_mfma_f32_16x16x32_bf16 v[144:147], v[48:51], v[232:235], v[144:147]
  v_mfma_f32_16x16x32_bf16 v[148:151], v[48:51], v[236:239], v[148:151]
  s_waitcnt lgkmcnt(2)
  buffer_load_dwordx4 v8, s[28:31], s43 offen offset:3072 sc1 lds
  v_mfma_f32_16x16x32_bf16 v[156:159], v[52:55], v[236:239], v[156:159]
  ds_read_b64_tr_b16 v[60:61], v4 offset:12288
  s_add_u32 s43, s43, s46
  v_mfma_f32_16x16x32_bf16 v[152:155], v[52:55], v[232:235], v[152:155]
  ds_read_b64_tr_b16 v[62:63], v4 offset:12544
  s_add_u32 m0, s47, 65536
  v_mfma_f32_16x16x32_bf16 v[140:143], v[52:55], v[228:231], v[140:143]
  v_mfma_f32_16x16x32_bf16 v[136:139], v[52:55], v[224:227], v[136:139]
  s_waitcnt lgkmcnt(2)
  s_waitcnt vmcnt(13)
  v_subrev_u32 v15, s85, v15
  v_subrev_u32 v15, 2, v15
  v_cmp_gt_u32 vcc, 6, v15
  s_nop 0
  s_cmp_eq_u64 vcc, -1
  s_cbranch_scc0 L_slow3
L_back3:
  s_barrier
  v_xor_b32 v3, 0x20000, v3
  v_xor_b32 v4, 0x20000, v4
  v_mfma_f32_16x16x32_bf16 v[128:131], v[56:59], v[240:243], v[128:131]
  ds_read_b64_tr_b16 v[48:49], v3 offset:0
  v_mfma_f32_16x16x32_bf16 v[132:135], v[56:59], v[244:247], v[132:135]
  ds_read_b64_tr_b16 v[50:51], v3 offset:256
  v_mfma_f32_16x16x32_bf16 v[144:147], v[56:59], v[248:251], v[144:147]
  buffer_load_dwordx4 v5, s[28:31], s43 offen offset:0 sc1 lds
  v_mfma_f32_16x16x32_bf16 v[148:151], v[56:59], v[252:255], v[148:151]
L_pad5:
  s_cbranch_execz L_pad7
  s_waitcnt lgkmcnt(2)
  v_mfma_f32_16x16x32_bf16 v[156:159], v[60:63], v[252:255], v[156:159]
  ds_read_b64_tr_b16 v[52:53], v4 offset:0
  v_mfma_f32_16x16x32_bf16 v[152:155], v[60:63], v[248:251], v[152:155]
  ds_read_b64_tr_b16 v[54:55], v4 offset:256
  v_mfma_f32_16x16x32_bf16 v[140:143], v[60:63], v[244:247], v[140:143]
  buffer_load_dwordx4 v6, s[28:31], s43 offen offset:1024 sc1 lds
  v_mfma_f32_16x16x32_bf16 v[136:139], v[60:63], v[240:243], v[136:139]
  s_waitcnt lgkmcnt(2)
  v_mfma_f32_16x16x32_bf16 v[160:163], v[48:51], a[0:3], 0
  ds_read_b64_tr_b16 v[56:57], v3 offset:8192
  v_mfma_f32_16x16x32_bf16 v[164:167], v[48:51], a[4:7], 0
  ds_read_b64_tr_b16 v[58:59], v3 offset:8448
  v_mfma_f32_16x16x32_bf16 v[64:67], v[48:51], a[8:11], 0
  buffer_load_dwordx4 v7, s[28:31], s43 offen offset:2048 sc1 lds
  v_mfma_f32_16x16x32_bf16 v[68:71], v[48:51], a[12:15], 0
  s_waitcnt lgkmcnt(2)
  v_mfma_f32_16x16x32_bf16 v[76:79], v[52:55], a[12:15], 0
  ds_read_b64_tr_b16 v[60:61], v4 offset:8192
  s_add_u32 s59, s51, 0x10000
  v_mfma_f32_16x16x32_bf16 v[72:75], v[52:55], a[8:11], 0
  ds_read_b64_tr_b16 v[62:63], v4 offset:8448
  v_mul_f32 v128, s54, v128
  v_mfma_f32_16x16x32_bf16 v[172:175], v[52:55], a[4:7], 0
  buffer_load_dwordx4 v8, s[28:31], s43 offen offset:3072 sc1 lds
  v_mfma_f32_16x16x32_bf16 v[168:171], v[52:55], a[0:3], 0
  s_waitcnt lgkmcnt(2)
  s_add_u32 s43, s43, s46
  s_add_u32 m0, s47, 81920
  v_mfma_f32_16x16x32_bf16 v[176:179], v[56:59], a[0:3], 0
  ds_read_b64_tr_b16 v[48:49], v3 offset:4096
  v_mul_f32 v129, s54, v129
  v_mfma_f32_16x16x32_bf16 v[180:183], v[56:59], a[4:7], 0
  ds_read_b64_tr_b16 v[50:51], v3 offset:4352
  v_mul_f32 v130, s54, v130
  v_mfma_f32_16x16x32_bf16 v[80:83], v[56:59], a[8:11], 0
  buffer_load_dwordx4 v5, s[28:31], s43 offen offset:0 sc1 lds
  v_mfma_f32_16x16x32_bf16 v[84:87], v[56:59], a[12:15], 0
  s_waitcnt lgkmcnt(2)
  v_mul_f32 v131, s54, v131
  v_cvt_pk_bf16_f32 v20, v128, v129
  v_mfma_f32_16x16x32_bf16 v[92:95], v[60:63], a[12:15], 0
  ds_read_b64_tr_b16 v[52:53], v4 offset:4096
  v_cvt_pk_bf16_f32 v21, v130, v131
  v_mfma_f32_16x16x32_bf16 v[88:91], v[60:63], a[8:11], 0
  ds_read_b64_tr_b16 v[54:55], v4 offset:4352
  v_mul_f32 v132, s54, v132
  v_mfma_f32_16x16x32_bf16 v[188:191], v[60:63], a[4:7], 0
  v_mul_f32 v133, s54, v133
  v_mul_f32 v134, s54, v134
  v_mfma_f32_16x16x32_bf16 v[184:187], v[60:63], a[0:3], 0
  s_waitcnt lgkmcnt(2)
  buffer_load_dwordx4 v6, s[28:31], s43 offen offset:1024 sc1 lds
  v_mfma_f32_16x16x32_bf16 v[160:163], v[48:51], a[16:19], v[160:163]
  ds_read_b64_tr_b16 v[56:57], v3 offset:12288
  v_mul_f32 v135, s54, v135
  v_mfma_f32_16x16x32_bf16 v[164:167], v[48:51], a[20:23], v[164:167]
  ds_read_b64_tr_b16 v[58:59], v3 offset:12544
  v_cvt_pk_bf16_f32 v22, v132, v133
  v_mfma_f32_16x16x32_bf16 v[64:67], v[48:51], a[24:27], v[64:67]
  v_cvt_pk_bf16_f32 v23, v134, v135
  v_mul_f32 v136, s54, v136
  v_mfma_f32_16x16x32_bf16 v[68:71], v[48:51], a[28:31], v[68:71]
  s_waitcnt lgkmcnt(2)
  buffer_load_dwordx4 v7, s[28:31], s43 offen offset:2048 sc1 lds
  v_mfma_f32_16x16x32_bf16 v[76:79], v[52:55], a[28:31], v[76:79]
  ds_read_b64_tr_b16 v[60:61], v4 offset:12288
  v_mul_f32 v137, s54, v137
  v_mfma_f32_16x16x32_bf16 v[72:75], v[52:55], a[24:27], v[72:75]
  ds_read_b64_tr_b16 v[62:63], v4 offset:12544
  v_mul_f32 v138, s54, v138
  v_mfma_f32_16x16x32_bf16 v[172:175], v[52:55], a[20:23], v[172:175]
  buffer_store_dwordx4 v[20:23], v9, s[32:35], s51 offen offset:0 sc1
  v_mfma_f32_16x16x32_bf16 v[168:171], v[52:55], a[16:19], v[168:171]
  s_waitcnt lgkmcnt(2)
  s_waitcnt vmcnt(18)
  s_barrier
  v_mfma_f32_16x16x32_bf16 v[176:179], v[56:59], a[16:19], v[176:179]
  ds_read_b64_tr_b16 v[48:49], v3 offset:16384
  v_mul_f32 v139, s54, v139
  v_mfma_f32_16x16x32_bf16 v[180:183], v[56:59], a[20:23], v[180:183]
  ds_read_b64_tr_b16 v[50:51], v3 offset:16640
  v_cvt_pk_bf16_f32 v24, v136, v137
  v_mfma_f32_16x16x32_bf16 v[80:83], v[56:59], a[24:27], v[80:83]
  v_cvt_pk_bf16_f32 v25, v138, v139
  v_mul_f32 v140, s54, v140
  v_mfma_f32_16x16x32_bf16 v[84:87], v[56:59], a[28:31], v[84:87]
  s_waitcnt lgkmcnt(2)
  v_mul_f32 v141, s54, v141
  v_mul_f32 v142, s54, v142
  v_mfma_f32_16x16x32_bf16 v[92:95], v[60:63], a[28:31], v[92:95]
  ds_read_b64_tr_b16 v[52:53], v4 offset:16384
  v_mul_f32 v143, s54, v143
  v_mfma_f32_16x16x32_bf16 v[88:91], v[60:63], a[24:27], v[88:91]
  ds_read_b64_tr_b16 v[54:55], v4 offset:16640
  v_cvt_pk_bf16_f32 v26, v140, v141
  v_mfma_f32_16x16x32_bf16 v[188:191], v[60:63], a[20:23], v[188:191]
  buffer_load_dwordx4 v8, s[28:31], s43 offen offset:3072 sc1 lds
  v_mfma_f32_16x16x32_bf16 v[184:187], v[60:63], a[16:19], v[184:187]
  s_waitcnt lgkmcnt(2)
  s_add_u32 s43, s43, s46
  s_add_u32 m0, s47, 98304
  v_mfma_f32_16x16x32_bf16 v[160:163], v[48:51], a[32:35], v[160:163]
  ds_read_b64_tr_b16 v[56:57], v3 offset:24576
  v_cvt_pk_bf16_f32 v27, v142, v143
  v_mfma_f32_16x16x32_bf16 v[164:167], v[48:51], a[36:39], v[164:167]
  ds_read_b64_tr_b16 v[58:59], v3 offset:24832
  v_mul_f32 v144, s54, v144
  v_mfma_f32_16x16x32_bf16 v[64:67], v[48:51], a[40:43], v[64:67]
  buffer_load_dwordx4 v5, s[28:31], s43 offen offset:0 sc1 lds
  v_mfma_f32_16x16x32_bf16 v[68:71], v[48:51], a[44:47], v[68:71]
  s_waitcnt lgkmcnt(2)
  buffer_store_dwordx4 v[24:27], v9, s[32:35], s59 offen offset:0 sc1
  v_mfma_f32_16x16x32_bf16 v[76:79], v[52:55], a[44:47], v[76:79]
  ds_read_b64_tr_b16 v[60:61], v4 offset:24576
  v_mul_f32 v145, s54, v145
  v_mfma_f32_16x16x32_bf16 v[72:75], v[52:55], a[40:43], v[72:75]
  ds_read_b64_tr_b16 v[62:63], v4 offset:24832
  v_mul_f32 v146, s54, v146
  v_mfma_f32_16x16x32_bf16 v[172:175], v[52:55], a[36:39], v[172:175]
  v_mul_f32 v147, s54, v147
  v_cvt_pk_bf16_f32 v28, v144, v145
  v_mfma_f32_16x16x32_bf16 v[168:171], v[52:55], a[32:35], v[168:171]
  s_waitcnt lgkmcnt(2)
  v_cvt_pk_bf16_f32 v29, v146, v147
  v_mul_f32 v148, s54, v148
  v_mfma_f32_16x16x32_bf16 v[176:179], v[56:59], a[32:35], v[176:179]
  ds_read_b64_tr_b16 v[48:49], v3 offset:20480
  v_mul_f32 v149, s54, v149
  v_mfma_f32_16x16x32_bf16 v[180:183], v[56:59], a[36:39], v[180:183]
  ds_read_b64_tr_b16 v[50:51], v3 offset:20736
  v_mul_f32 v150, s54, v150
  v_mfma_f32_16x16x32_bf16 v[80:83], v[56:59], a[40:43], v[80:83]
  buffer_load_dwordx4 v6, s[28:31], s43 offen offset:1024 sc1 lds
  v_mfma_f32_16x16x32_bf16 v[84:87], v[56:59], a[44:47], v[84:87]
  s_waitcnt lgkmcnt(2)
  v_mul_f32 v151, s54, v151
  v_cvt_pk_bf16_f32 v30, v148, v149
  v_mfma_f32_16x16x32_bf16 v[92:95], v[60:63], a[44:47], v[92:95]
  ds_read_b64_tr_b16 v[52:53], v4 offset:20480
  v_cvt_pk_bf16_f32 v31, v150, v151
  v_mfma_f32_16x16x32_bf16 v[88:91], v[60:63], a[40:43], v[88:91]
  ds_read_b64_tr_b16 v[54:55], v4 offset:20736
  v_mul_f32 v152, s54, v152
  v_mfma_f32_16x16x32_bf16 v[188:191], v[60:63], a[36:39], v[188:191]
  buffer_load_dwordx4 v7, s[28:31], s43 offen offset:2048 sc1 lds
  v_mfma_f32_16x16x32_bf16 v[184:187], v[60:63], a[32:35], v[184:187]
  s_waitcnt lgkmcnt(2)
  buffer_store_dwordx4 v[28:31], v9, s[32:35], s51 offen offset:256 sc1
  v_mfma_f32_16x16x32_bf16 v[160:163], v[48:51], a[48:51], v[160:163]
  ds_read_b64_tr_b16 v[56:57], v3 offset:28672
  v_mul_f32 v153, s54, v153
  v_mfma_f32_16x16x32_bf16 v[164:167], v[48:51], a[52:55], v[164:167]
  ds_read_b64_tr_b16 v[58:59], v3 offset:28928
  v_mul_f32 v154, s54, v154
  v_mfma_f32_16x16x32_bf16 v[64:67], v[48:51], a[56:59], v[64:67]
  v_mul_f32 v155, s54, v155
  v_cvt_pk_bf16_f32 v32, v152, v153
  v_mfma_f32_16x16x32_bf16 v[68:71], v[48:51], a[60:63], v[68:71]
  s_waitcnt lgkmcnt(2)
  v_cvt_pk_bf16_f32 v33, v154, v155
  v_mul_f32 v156, s54, v156
  v_mfma_f32_16x16x32_bf16 v[76:79], v[52:55], a[60:63], v[76:79]
  ds_read_b64_tr_b16 v[60:61], v4 offset:28672
  v_mul_f32 v157, s54, v157
  v_mfma_f32_16x16x32_bf16 v[72:75], v[52:55], a[56:59], v[72:75]
  ds_read_b64_tr_b16 v[62:63], v4 offset:28928
  v_mul_f32 v158, s54, v158
  v_mfma_f32_16x16x32_bf16 v[172:175], v[52:55], a[52:55], v[172:175]
  v_mul_f32 v159, s54, v159
  v_cvt_pk_bf16_f32 v34, v156, v157
  v_mfma_f32_16x16x32_bf16 v[168:171], v[52:55], a[48:51], v[168:171]
  s_waitcnt lgkmcnt(2)
  s_waitcnt vmcnt(18)
  s_barrier
  v_mfma_f32_16x16x32_bf16 v[176:179], v[56:59], a[48:51], v[176:179]
  ds_read_b64_tr_b16 v[48:49], v3 offset:32768
  v_cvt_pk_bf16_f32 v35, v158, v159
  v_mfma_f32_16x16x32_bf16 v[180:183], v[56:59], a[52:55], v[180:183]
  ds_read_b64_tr_b16 v[50:51], v3 offset:33024
  v_mfma_f32_16x16x32_bf16 v[80:83], v[56:59], a[56:59], v[80:83]
  buffer_load_dwordx4 v8, s[28:31], s43 offen offset:3072 sc1 lds
  v_mfma_f32_16x16x32_bf16 v[84:87], v[56:59], a[60:63], v[84:87]
  s_waitcnt lgkmcnt(2)
  s_add_u32 s43, s43, s46
  s_add_u32 m0, s47, 114688
  v_mfma_f32_16x16x32_bf16 v[92:95], v[60:63], a[60:63], v[92:95]
  ds_read_b64_tr_b16 v[52:53], v4 offset:32768
  v_mfma_f32_16x16x32_bf16 v[88:91], v[60:63], a[56:59], v[88:91]
  ds_read_b64_tr_b16 v[54:55], v4 offset:33024
  v_mfma_f32_16x16x32_bf16 v[188:191], v[60:63], a[52:55], v[188:191]
  buffer_load_dwordx4 v5, s[28:31], s43 offen offset:0 sc1 lds
  v_mfma_f32_16x16x32_bf16 v[184:187], v[60:63], a[48:51], v[184:187]
  s_waitcnt lgkmcnt(2)
  buffer_store_dwordx4 v[32:35], v9, s[32:35], s59 offen offset:256 sc1
  v_mfma_f32_16x16x32_bf16 v[160:163], v[48:51], a[64:67], v[160:163]
  ds_read_b64_tr_b16 v[56:57], v3 offset:40960
  v_mfma_f32_16x16x32_bf16 v[164:167], v[48:51], a[68:71], v[164:167]
  ds_read_b64_tr_b16 v[58:59], v3 offset:41216
  v_mfma_f32_16x16x32_bf16 v[64:67], v[48:51], a[72:75], v[64:67]
  v_mfma_f32_16x16x32_bf16 v[68:71], v[48:51], a[76:79], v[68:71]
  s_waitcnt lgkmcnt(2)
  v_mfma_f32_16x16x32_bf16 v[76:79], v[52:55], a[76:79], v[76:79]
  ds_read_b64_tr_b16 v[60:61], v4 offset:40960
  v_mfma_f32_16x16x32_bf16 v[72:75], v[52:55], a[72:75], v[72:75]
  ds_read_b64_tr_b16 v[62:63], v4 offset:41216
  v_mfma_f32_16x16x32_bf16 v[172:175], v[52:55], a[68:71], v[172:175]
  buffer_load_dwordx4 v6, s[28:31], s43 offen offset:1024 sc1 lds
  v_mfma_f32_16x16x32_bf16 v[168:171], v[52:55], a[64:67], v[168:171]
  s_waitcnt lgkmcnt(2)
  v_mfma_f32_16x16x32_bf16 v[176:179], v[56:59], a[64:67], v[176:179]
  ds_read_b64_tr_b16 v[48:49], v3 offset:36864
  v_mfma_f32_16x16x32_bf16 v[180:183], v[56:59], a[68:71], v[180:183]
  ds_read_b64_tr_b16 v[50:51], v3 offset:37120
  v_mfma_f32_16x16x32_bf16 v[80:83], v[56:59], a[72:75], v[80:83]
  buffer_load_dwordx4 v7, s[28:31], s43 offen offset:2048 sc1 lds
  v_mfma_f32_16x16x32_bf16 v[84:87], v[56:59], a[76:79], v[84:87]
  s_waitcnt lgkmcnt(2)
  v_mfma_f32_16x16x32_bf16 v[92:95], v[60:63], a[76:79], v[92:95]
  ds_read_b64_tr_b16 v[52:53], v4 offset:36864
  v_mfma_f32_16x16x32_bf16 v[88:91], v[60:63], a[72:75], v[88:91]
  ds_read_b64_tr_b16 v[54:55], v4 offset:37120
  v_mfma_f32_16x16x32_bf16 v[188:191], v[60:63], a[68:71], v[188:191]
  v_mfma_f32_16x16x32_bf16 v[184:187], v[60:63], a[64:67], v[184:187]
  s_waitcnt lgkmcnt(2)
  buffer_load_dwordx4 v8, s[28:31], s43 offen offset:3072 sc1 lds
  v_mfma_f32_16x16x32_bf16 v[160:163], v[48:51], a[80:83], v[160:163]
  ds_read_b64_tr_b16 v[56:57], v3 offset:45056
  s_add_u32 s43, s43, s46
  v_mfma_f32_16x16x32_bf16 v[164:167], v[48:51], a[84:87], v[164:167]
  ds_read_b64_tr_b16 v[58:59], v3 offset:45312
  s_add_u32 m0, s47, 131072
  v_mfma_f32_16x16x32_bf16 v[64:67], v[48:51], a[88:91], v[64:67]
  v_mfma_f32_16x16x32_bf16 v[68:71], v[48:51], a[92:95], v[68:71]
  s_waitcnt lgkmcnt(2)
  buffer_load_dwordx4 v5, s[28:31], s43 offen offset:0 sc1 lds
  v_mfma_f32_16x16x32_bf16 v[76:79], v[52:55], a[92:95], v[76:79]
  ds_read_b64_tr_b16 v[60:61], v4 offset:45056
  v_mfma_f32_16x16x32_bf16 v[72:75], v[52:55], a[88:91], v[72:75]
  ds_read_b64_tr_b16 v[62:63], v4 offset:45312
  v_mfma_f32_16x16x32_bf16 v[172:175], v[52:55], a[84:87], v[172:175]
  v_mfma_f32_16x16x32_bf16 v[168:171], v[52:55], a[80:83], v[168:171]
  s_waitcnt lgkmcnt(2)
  s_waitcnt vmcnt(21)
  s_barrier
  v_mfma_f32_16x16x32_bf16 v[176:179], v[56:59], a[80:83], v[176:179]
  ds_read_b64_tr_b16 v[48:49], v3 offset:49152
  v_mfma_f32_16x16x32_bf16 v[180:183], v[56:59], a[84:87], v[180:183]
  ds_read_b64_tr_b16 v[50:51], v3 offset:49408
  v_mfma_f32_16x16x32_bf16 v[80:83], v[56:59], a[88:91], v[80:83]
  buffer_load_dwordx4 v6, s[28:31], s43 offen offset:1024 sc1 lds
  v_mfma_f32_16x16x32_bf16 v[84:87], v[56:59], a[92:95], v[84:87]
  s_waitcnt lgkmcnt(2)
  v_mfma_f32_16x16x32_bf16 v[92:95], v[60:63], a[92:95], v[92:95]
  ds_read_b64_tr_b16 v[52:53], v4 offset:49152
  v_mfma_f32_16x16x32_bf16 v[88:91], v[60:63], a[88:91], v[88:91]
  ds_read_b64_tr_b16 v[54:55], v4 offset:49408
  v_mfma_f32_16x16x32_bf16 v[188:191], v[60:63], a[84:87], v[188:191]
  buffer_load_dwordx4 v7, s[28:31], s43 offen offset:2048 sc1 lds
  v_mfma_f32_16x16x32_bf16 v[184:187], v[60:63], a[80:83], v[184:187]
  s_waitcnt lgkmcnt(2)
  v_mfma_f32_16x16x32_bf16 v[160:163], v[48:51], a[96:99], v[160:163]
  ds_read_b64_tr_b16 v[56:57], v3 offset:57344
  v_mfma_f32_16x16x32_bf16 v[164:167], v[48:51], a[100:103], v[164:167]
  ds_read_b64_tr_b16 v[58:59], v3 offset:57600
  v_mfma_f32_16x16x32_bf16 v[64:67], v[48:51], a[104:107], v[64:67]
  buffer_load_dwordx4 v8, s[28:31], s43 offen offset:3072 sc1 lds
  v_mfma_f32_16x16x32_bf16 v[68:71], v[48:51], a[108:111], v[68:71]
  s_waitcnt lgkmcnt(2)
  s_add_u32 s43, s43, s46
  v_mfma_f32_16x16x32_bf16 v[76:79], v[52:55], a[108:111], v[76:79]
  ds_read_b64_tr_b16 v[60:61], v4 offset:57344
  s_add_u32 s71, s69, 0
  v_mfma_f32_16x16x32_bf16 v[72:75], v[52:55], a[104:107], v[72:75]
  ds_read_b64_tr_b16 v[62:63], v4 offset:57600
  v_mfma_f32_16x16x32_bf16 v[172:175], v[52:55], a[100:103], v[172:175]
  buffer_load_dwordx4 a[0:3], v17, s[8:11], s71 offen offset:0 sc1
  v_mfma_f32_16x16x32_bf16 v[168:171], v[52:55], a[96:99], v[168:171]
  s_waitcnt lgkmcnt(2)
  v_mfma_f32_16x16x32_bf16 v[176:179], v[56:59], a[96:99], v[176:179]
  ds_read_b64_tr_b16 v[48:49], v3 offset:53248
  v_mfma_f32_16x16x32_bf16 v[180:183], v[56:59], a[100:103], v[180:183]
  ds_read_b64_tr_b16 v[50:51], v3 offset:53504
  v_mfma_f32_16x16x32_bf16 v[80:83], v[56:59], a[104:107], v[80:83]
  buffer_load_dwordx4 a[4:7], v17, s[8:11], s71 offen offset:1024 sc1
  v_mfma_f32_16x16x32_bf16 v[84:87], v[56:59], a[108:111], v[84:87]
  s_waitcnt lgkmcnt(2)
  v_mfma_f32_16x16x32_bf16 v[92:95], v[60:63], a[108:111], v[92:95]
  ds_read_b64_tr_b16 v[52:53], v4 offset:53248
  v_mfma_f32_16x16x32_bf16 v[88:91], v[60:63], a[104:107], v[88:91]
  ds_read_b64_tr_b16 v[54:55], v4 offset:53504
  v_mfma_f32_16x16x32_bf16 v[188:191], v[60:63], a[100:103], v[188:191]
  v_mfma_f32_16x16x32_bf16 v[184:187], v[60:63], a[96:99], v[184:187]
  s_waitcnt lgkmcnt(2)
  buffer_load_dwordx4 a[8:11], v17, s[8:11], s71 offen offset:2048 sc1
  v_mfma_f32_16x16x32_bf16 v[160:163], v[48:51], a[112:115], v[160:163]
  ds_read_b64_tr_b16 v[56:57], v3 offset:61440
  v_mfma_f32_16x16x32_bf16 v[164:167], v[48:51], a[116:119], v[164:167]
  ds_read_b64_tr_b16 v[58:59], v3 offset:61696
  v_mfma_f32_16x16x32_bf16 v[64:67], v[48:51], a[120:123], v[64:67]
  v_mfma_f32_16x16x32_bf16 v[68:71], v[48:51], a[124:127], v[68:71]
  s_waitcnt lgkmcnt(2)
  buffer_load_dwordx4 a[12:15], v17, s[8:11], s71 offen offset:3072 sc1
  v_mfma_f32_16x16x32_bf16 v[76:79], v[52:55], a[124:127], v[76:79]
  ds_read_b64_tr_b16 v[60:61], v4 offset:61440
  s_add_u32 s71, s69, 4096
  v_mfma_f32_16x16x32_bf16 v[72:75], v[52:55], a[120:123], v[72:75]
  ds_read_b64_tr_b16 v[62:63], v4 offset:61696
  v_mfma_f32_16x16x32_bf16 v[172:175], v[52:55], a[116:119], v[172:175]
  v_mfma_f32_16x16x32_bf16 v[168:171], v[52:55], a[112:115], v[168:171]
  s_waitcnt lgkmcnt(2)
  s_waitcnt vmcnt(11)
  s_barrier
  v_mfma_f32_16x16x32_bf16 v[176:179], v[56:59], a[112:115], v[176:179]
  ds_read_b64_tr_b16 v[48:49], v1 offset:0
  s_add_u32 s60, s85, 4
  v_mfma_f32_16x16x32_bf16 v[180:183], v[56:59], a[116:119], v[180:183]
  ds_read_b64_tr_b16 v[50:51], v1 offset:256
  s_mov_b32 s1, 131072
  v_mfma_f32_16x16x32_bf16 v[80:83], v[56:59], a[120:123], v[80:83]
  v_mov_b32 v44, s60
  v_mfma_f32_16x16x32_bf16 v[84:87], v[56:59], a[124:127], v[84:87]
  s_waitcnt lgkmcnt(2)
  buffer_store_dword v44, v13, s[12:15], s1 offen sc1
  v_mfma_f32_16x16x32_bf16 v[92:95], v[60:63], a[124:127], v[92:95]
  ds_read_b64_tr_b16 v[52:53], v2 offset:0
  v_mfma_f32_16x16x32_bf16 v[88:91], v[60:63], a[120:123], v[88:91]
  ds_read_b64_tr_b16 v[54:55], v2 offset:256
  v_mfma_f32_16x16x32_bf16 v[188:191], v[60:63], a[116:119], v[188:191]
  buffer_load_dwordx4 a[16:19], v17, s[8:11], s71 offen offset:0 sc1
  v_mfma_f32_16x16x32_bf16 v[184:187], v[60:63], a[112:115], v[184:187]
  s_waitcnt lgkmcnt(2)
  v_mfma_f32_16x16x32_bf16 v[160:163], v[48:51], a[128:131], v[160:163]
  ds_read_b64_tr_b16 v[56:57], v1 offset:8192
  v_mfma_f32_16x16x32_bf16 v[164:167], v[48:51], a[132:135], v[164:167]
  ds_read_b64_tr_b16 v[58:59], v1 offset:8448
  v_mfma_f32_16x16x32_bf16 v[64:67], v[48:51], a[136:139], v[64:67]
  buffer_load_dwordx4 a[20:23], v17, s[8:11], s71 offen offset:1024 sc1
  v_mfma_f32_16x16x32_bf16 v[68:71], v[48:51], a[140:143], v[68:71]
  s_waitcnt lgkmcnt(2)
  v_mfma_f32_16x16x32_bf16 v[76:79], v[52:55], a[140:143], v[76:79]
  ds_read_b64_tr_b16 v[60:61], v2 offset:8192
  v_mfma_f32_16x16x32_bf16 v[72:75], v[52:55], a[136:139], v[72:75]
  ds_read_b64_tr_b16 v[62:63], v2 offset:8448
  v_mfma_f32_16x16x32_bf16 v[172:175], v[52:55], a[132:135], v[172:175]
  v_mfma_f32_16x16x32_bf16 v[168:171], v[52:55], a[128:131], v[168:171]
  s_waitcnt lgkmcnt(2)
  buffer_load_dwordx4 a[24:27], v17, s[8:11], s71 offen offset:2048 sc1
  v_mfma_f32_16x16x32_bf16 v[176:179], v[56:59], a[128:131], v[176:179]
  ds_read_b64_tr_b16 v[48:49], v1 offset:4096
  v_mfma_f32_16x16x32_bf16 v[180:183], v[56:59], a[132:135], v[180:183]
  ds_read_b64_tr_b16 v[50:51], v1 offset:4352
  v_mfma_f32_16x16x32_bf16 v[80:83], v[56:59], a[136:139], v[80:83]
  v_mfma_f32_16x16x32_bf16 v[84:87], v[56:59], a[140:143], v[84:87]
  s_waitcnt lgkmcnt(2)
  buffer_load_dwordx4 a[28:31], v17, s[8:11], s71 offen offset:3072 sc1
  v_mfma_f32_16x16x32_bf16 v[92:95], v[60:63], a[140:143], v[92:95]
  ds_read_b64_tr_b16 v[52:53], v2 offset:4096
  s_add_u32 s71, s69, 8192
  v_mfma_f32_16x16x32_bf16 v[88:91], v[60:63], a[136:139], v[88:91]
  ds_read_b64_tr_b16 v[54:55], v2 offset:4352
  v_mfma_f32_16x16x32_bf16 v[188:191], v[60:63], a[132:135], v[188:191]
  v_mfma_f32_16x16x32_bf16 v[184:187], v[60:63], a[128:131], v[184:187]
  s_waitcnt lgkmcnt(2)
  v_mfma_f32_16x16x32_bf16 v[160:163], v[48:51], a[144:147], v[160:163]
  ds_read_b64_tr_b16 v[56:57], v1 offset:12288
  v_mfma_f32_16x16x32_bf16 v[164:167], v[48:51], a[148:151], v[164:167]
  ds_read_b64_tr_b16 v[58:59], v1 offset:12544
  v_mfma_f32_16x16x32_bf16 v[64:67], v[48:51], a[152:155], v[64:67]
  buffer_load_dwordx4 a[32:35], v17, s[8:11], s71 offen offset:0 sc1
  v_mfma_f32_16x16x32_bf16 v[68:71], v[48:51], a[156:159], v[68:71]
  s_waitcnt lgkmcnt(2)
  v_mfma_f32_16x16x32_bf16 v[76:79], v[52:55], a[156:159], v[76:79]
  ds_read_b64_tr_b16 v[60:61], v2 offset:12288
  v_mfma_f32_16x16x32_bf16 v[72:75], v[52:55], a[152:155], v[72:75]
  ds_read_b64_tr_b16 v[62:63], v2 offset:12544
  v_mfma_f32_16x16x32_bf16 v[172:175], v[52:55], a[148:151], v[172:175]
  buffer_load_dwordx4 a[36:39], v17, s[8:11], s71 offen offset:1024 sc1
  v_mfma_f32_16x16x32_bf16 v[168:171], v[52:55], a[144:147], v[168:171]
  s_waitcnt lgkmcnt(2)
  s_barrier
  v_xor_b32 v3, 0x20000, v3
  v_xor_b32 v4, 0x20000, v4
  v_mfma_f32_16x16x32_bf16 v[176:179], v[56:59], a[144:147], v[176:179]
  ds_read_b64_tr_b16 v[48:49], v1 offset:16384
  s_add_u32 s71, s69, 20480
  v_mfma_f32_16x16x32_bf16 v[180:183], v[56:59], a[148:151], v[180:183]
  ds_read_b64_tr_b16 v[50:51], v1 offset:16640
  v_mfma_f32_16x16x32_bf16 v[80:83], v[56:59], a[152:155], v[80:83]
  buffer_load_dwordx4 a[40:43], v17, s[8:11], s71 offen offset:0 sc1
  v_mfma_f32_16x16x32_bf16 v[84:87], v[56:59], a[156:159], v[84:87]
  s_waitcnt lgkmcnt(2)
  v_mfma_f32_16x16x32_bf16 v[92:95], v[60:63], a[156:159], v[92:95]
  ds_read_b64_tr_b16 v[52:53], v2 offset:16384
  v_mfma_f32_16x16x32_bf16 v[88:91], v[60:63], a[152:155], v[88:91]
  ds_read_b64_tr_b16 v[54:55], v2 offset:16640
  v_mfma_f32_16x16x32_bf16 v[188:191], v[60:63], a[148:151], v[188:191]
  buffer_load_dwordx4 a[44:47], v17, s[8:11], s71 offen offset:1024 sc1
  v_mfma_f32_16x16x32_bf16 v[184:187], v[60:63], a[144:147], v[184:187]
  s_waitcnt lgkmcnt(2)
  v_mfma_f32_16x16x32_bf16 v[160:163], v[48:51], a[160:163], v[160:163]
  ds_read_b64_tr_b16 v[56:57], v1 offset:24576
  v_mfma_f32_16x16x32_bf16 v[164:167], v[48:51], a[164:167], v[164:167]
  ds_read_b64_tr_b16 v[58:59], v1 offset:24832
  v_mfma_f32_16x16x32_bf16 v[64:67], v[48:51], a[168:171], v[64:67]
  buffer_load_dwordx4 a[48:51], v17, s[8:11], s71 offen offset:2048 sc1
  v_mfma_f32_16x16x32_bf16 v[68:71], v[48:51], a[172:175], v[68:71]
  s_waitcnt lgkmcnt(2)
  v_mfma_f32_16x16x32_bf16 v[76:79], v[52:55], a[172:175], v[76:79]
  ds_read_b64_tr_b16 v[60:61], v2 offset:24576
  v_mfma_f32_16x16x32_bf16 v[72:75], v[52:55], a[168:171], v[72:75]
  ds_read_b64_tr_b16 v[62:63], v2 offset:24832
  v_mfma_f32_16x16x32_bf16 v[172:175], v[52:55], a[164:167], v[172:175]
  v_mfma_f32_16x16x32_bf16 v[168:171], v[52:55], a[160:163], v[168:171]
  s_waitcnt lgkmcnt(2)
  buffer_load_dwordx4 a[52:55], v17, s[8:11], s71 offen offset:3072 sc1
  v_mfma_f32_16x16x32_bf16 v[176:179], v[56:59], a[160:163], v[176:179]
  ds_read_b64_tr_b16 v[48:49], v1 offset:20480
  s_add_u32 s71, s69, 24576
  v_mfma_f32_16x16x32_bf16 v[180:183], v[56:59], a[164:167], v[180:183]
  ds_read_b64_tr_b16 v[50:51], v1 offset:20736
  v_mfma_f32_16x16x32_bf16 v[80:83], v[56:59], a[168:171], v[80:83]
  v_mfma_f32_16x16x32_bf16 v[84:87], v[56:59], a[172:175], v[84:87]
  s_waitcnt lgkmcnt(2)
  buffer_load_dwordx4 a[56:59], v17, s[8:11], s71 offen offset:0 sc1
  v_mfma_f32_16x16x32_bf16 v[92:95], v[60:63], a[172:175], v[92:95]
  ds_read_b64_tr_b16 v[52:53], v2 offset:20480
  v_mfma_f32_16x16x32_bf16 v[88:91], v[60:63], a[168:171], v[88:91]
  ds_read_b64_tr_b16 v[54:55], v2 offset:20736
  v_mfma_f32_16x16x32_bf16 v[188:191], v[60:63], a[164:167], v[188:191]
  v_mfma_f32_16x16x32_bf16 v[184:187], v[60:63], a[160:163], v[184:187]
  s_waitcnt lgkmcnt(2)
  buffer_load_dwordx4 a[60:63], v17, s[8:11], s71 offen offset:1024 sc1
  v_mfma_f32_16x16x32_bf16 v[160:163], v[48:51], a[176:179], v[160:163]
  ds_read_b64_tr_b16 v[56:57], v1 offset:28672
  v_mfma_f32_16x16x32_bf16 v[164:167], v[48:51], a[180:183], v[164:167]
  ds_read_b64_tr_b16 v[58:59], v1 offset:28928
  v_mfma_f32_16x16x32_bf16 v[64:67], v[48:51], a[184:187], v[64:67]
  v_mfma_f32_16x16x32_bf16 v[68:71], v[48:51], a[188:191], v[68:71]
  s_waitcnt lgkmcnt(2)
  v_mfma_f32_16x16x32_bf16 v[76:79], v[52:55], a[188:191], v[76:79]
  ds_read_b64_tr_b16 v[60:61], v2 offset:28672
  v_mfma_f32_16x16x32_bf16 v[72:75], v[52:55], a[184:187], v[72:75]
  ds_read_b64_tr_b16 v[62:63], v2 offset:28928
  v_mfma_f32_16x16x32_bf16 v[172:175], v[52:55], a[180:183], v[172:175]
  buffer_load_dwordx4 a[64:67], v17, s[8:11], s71 offen offset:2048 sc1
  v_mfma_f32_16x16x32_bf16 v[168:171], v[52:55], a[176:179], v[168:171]
  s_waitcnt lgkmcnt(2)
  s_barrier
  s_add_u32 m0, s47, 65536
  v_mfma_f32_16x16x32_bf16 v[176:179], v[56:59], a[176:179], v[176:179]
  ds_read_b64_tr_b16 v[48:49], v1 offset:32768
  v_mfma_f32_16x16x32_bf16 v[180:183], v[56:59], a[180:183], v[180:183]
  ds_read_b64_tr_b16 v[50:51], v1 offset:33024
  v_mfma_f32_16x16x32_bf16 v[80:83], v[56:59], a[184:187], v[80:83]
  buffer_load_dwordx4 v5, s[28:31], s43 offen offset:0 sc1 lds
  v_mfma_f32_16x16x32_bf16 v[84:87], v[56:59], a[188:191], v[84:87]
  s_waitcnt lgkmcnt(2)
  v_mfma_f32_16x16x32_bf16 v[92:95], v[60:63], a[188:191], v[92:95]
  ds_read_b64_tr_b16 v[52:53], v2 offset:32768
  v_mfma_f32_16x16x32_bf16 v[88:91], v[60:63], a[184:187], v[88:91]
  ds_read_b64_tr_b16 v[54:55], v2 offset:33024
  v_mfma_f32_16x16x32_bf16 v[188:191], v[60:63], a[180:183], v[188:191]
  buffer_load_dwordx4 v6, s[28:31], s43 offen offset:1024 sc1 lds
  v_mfma_f32_16x16x32_bf16 v[184:187], v[60:63], a[176:179], v[184:187]
  s_waitcnt lgkmcnt(2)
  v_mfma_f32_16x16x32_bf16 v[160:163], v[48:51], a[192:195], v[160:163]
  ds_read_b64_tr_b16 v[56:57], v1 offset:40960
  v_mfma_f32_16x16x32_bf16 v[164:167], v[48:51], a[196:199], v[164:167]
  ds_read_b64_tr_b16 v[58:59], v1 offset:41216
  v_mfma_f32_16x16x32_bf16 v[64:67], v[48:51], a[200:203], v[64:67]
  buffer_load_dwordx4 v7, s[28:31], s43 offen offset:2048 sc1 lds
  v_mfma_f32_16x16x32_bf16 v[68:71], v[48:51], a[204:207], v[68:71]
  s_waitcnt lgkmcnt(2)
  v_mfma_f32_16x16x32_bf16 v[76:79], v[52:55], a[204:207], v[76:79]
  ds_read_b64_tr_b16 v[60:61], v2 offset:40960
  v_mfma_f32_16x16x32_bf16 v[72:75], v[52:55], a[200:203], v[72:75]
  ds_read_b64_tr_b16 v[62:63], v2 offset:41216
  v_mfma_f32_16x16x32_bf16 v[172:175], v[52:55], a[196:199], v[172:175]
  buffer_load_dwordx4 v8, s[28:31], s43 offen offset:3072 sc1 lds
  v_mfma_f32_16x16x32_bf16 v[168:171], v[52:55], a[192:195], v[168:171]
  s_waitcnt lgkmcnt(2)
  s_add_u32 s43, s43, s46
  v_mfma_f32_16x16x32_bf16 v[176:179], v[56:59], a[192:195], v[176:179]
  ds_read_b64_tr_b16 v[48:49], v1 offset:36864
  v_mfma_f32_16x16x32_bf16 v[180:183], v[56:59], a[196:199], v[180:183]
  ds_read_b64_tr_b16 v[50:51], v1 offset:37120
  v_mfma_f32_16x16x32_bf16 v[80:83], v[56:59], a[200:203], v[80:83]
  v_mfma_f32_16x16x32_bf16 v[84:87], v[56:59], a[204:207], v[84:87]
  s_waitcnt lgkmcnt(2)
  buffer_load_dwordx4 a[68:71], v17, s[8:11], s71 offen offset:3072 sc1
  v_mfma_f32_16x16x32_bf16 v[92:95], v[60:63], a[204:207], v[92:95]
  ds_read_b64_tr_b16 v[52:53], v2 offset:36864
  s_add_u32 s71, s69, 28672
  v_mfma_f32_16x16x32_bf16 v[88:91], v[60:63], a[200:203], v[88:91]
  ds_read_b64_tr_b16 v[54:55], v2 offset:37120
  v_mfma_f32_16x16x32_bf16 v[188:191], v[60:63], a[196:199], v[188:191]
  v_mfma_f32_16x16x32_bf16 v[184:187], v[60:63], a[192:195], v[184:187]
  s_waitcnt lgkmcnt(2)
  buffer_load_dwordx4 a[72:75], v17, s[8:11], s71 offen offset:0 sc1
  v_mfma_f32_16x16x32_bf16 v[160:163], v[48:51], a[208:211], v[160:163]
  ds_read_b64_tr_b16 v[56:57], v1 offset:45056
  v_mfma_f32_16x16x32_bf16 v[164:167], v[48:51], a[212:215], v[164:167]
  ds_read_b64_tr_b16 v[58:59], v1 offset:45312
  v_mfma_f32_16x16x32_bf16 v[64:67], v[48:51], a[216:219], v[64:67]
  v_mfma_f32_16x16x32_bf16 v[68:71], v[48:51], a[220:223], v[68:71]
  s_waitcnt lgkmcnt(2)
  buffer_load_dwordx4 a[76:79], v17, s[8:11], s71 offen offset:1024 sc1
  v_mfma_f32_16x16x32_bf16 v[76:79], v[52:55], a[220:223], v[76:79]
  ds_read_b64_tr_b16 v[60:61], v2 offset:45056
  s_add_u32 s71, s69, 8192
  v_mfma_f32_16x16x32_bf16 v[72:75], v[52:55], a[216:219], v[72:75]
  ds_read_b64_tr_b16 v[62:63], v2 offset:45312
  v_mfma_f32_16x16x32_bf16 v[172:175], v[52:55], a[212:215], v[172:175]
  v_mfma_f32_16x16x32_bf16 v[168:171], v[52:55], a[208:211], v[168:171]
  s_waitcnt lgkmcnt(2)
  s_waitcnt vmcnt(29)
  s_barrier
  buffer_load_dwordx4 a[80:83], v17, s[8:11], s71 offen offset:2048 sc1
  buffer_load_dwordx4 a[84:87], v17, s[8:11], s71 offen offset:3072 sc1
  s_add_u32 s71, s69, 12288
  buffer_load_dwordx4 a[88:91], v17, s[8:11], s71 offen offset:0 sc1
  buffer_load_dwordx4 a[92:95], v17, s[8:11], s71 offen offset:1024 sc1
  buffer_load_dwordx4 a[96:99], v17, s[8:11], s71 offen offset:2048 sc1
  buffer_load_dwordx4 a[100:103], v17, s[8:11], s71 offen offset:3072 sc1
  s_add_u32 s71, s69, 16384
  buffer_load_dwordx4 a[104:107], v17, s[8:11], s71 offen offset:0 sc1
  buffer_load_dwordx4 a[108:111], v17, s[8:11], s71 offen offset:1024 sc1
L_join:
L_pad6:
  s_cbranch_execz L_pad8
  v_mfma_f32_16x16x32_bf16 v[176:179], v[56:59], a[208:211], v[176:179]
  ds_read_b64_tr_b16 v[48:49], v1 offset:49152
  v_bfe_u32 v40, v14, 2, 2
  v_mfma_f32_16x16x32_bf16 v[180:183], v[56:59], a[212:215], v[180:183]
  ds_read_b64_tr_b16 v[50:51], v1 offset:49408
  v_lshrrev_b32 v41, 4, v14
  v_mfma_f32_16x16x32_bf16 v[80:83], v[56:59], a[216:219], v[80:83]
  buffer_load_dwordx4 a[112:115], v17, s[8:11], s71 offen offset:2048 sc1
  v_mfma_f32_16x16x32_bf16 v[84:87], v[56:59], a[220:223], v[84:87]
  s_waitcnt lgkmcnt(2)
  v_lshl_add_u32 v40, v40, 3, v41
  v_add_u32 v41, s84, v40
  v_mfma_f32_16x16x32_bf16 v[92:95], v[60:63], a[220:223], v[92:95]
  ds_read_b64_tr_b16 v[52:53], v2 offset:49152
  v_lshlrev_b32 v16, 7, v41
  v_mfma_f32_16x16x32_bf16 v[88:91], v[60:63], a[216:219], v[88:91]
  ds_read_b64_tr_b16 v[54:55], v2 offset:49408
  s_mov_b32 s0, 131072
  v_mfma_f32_16x16x32_bf16 v[188:191], v[60:63], a[212:215], v[188:191]
  buffer_load_dwordx4 a[116:119], v17, s[8:11], s71 offen offset:3072 sc1
  v_mfma_f32_16x16x32_bf16 v[184:187], v[60:63], a[208:211], v[184:187]
  s_waitcnt lgkmcnt(2)
  buffer_load_dword v15, v16, s[12:15], s0 offen sc1
  v_mfma_f32_16x16x32_bf16 v[160:163], v[48:51], a[224:227], v[160:163]
  ds_read_b64_tr_b16 v[56:57], v1 offset:57344
  s_add_u32 s71, s69, 28672
  v_mfma_f32_16x16x32_bf16 v[164:167], v[48:51], a[228:231], v[164:167]
  ds_read_b64_tr_b16 v[58:59], v1 offset:57600
  v_lshrrev_b32 v125, 5, v14
  v_mfma_f32_16x16x32_bf16 v[64:67], v[48:51], a[232:235], v[64:67]
  s_lshl_b32 s59, s3, 9
  v_and_b32 v126, 31, v14
  v_lshlrev_b32 v127, 3, v126
  v_mfma_f32_16x16x32_bf16 v[68:71], v[48:51], a[236:239], v[68:71]
  s_waitcnt lgkmcnt(2)
  s_add_u32 s59, s59, 0
  v_and_b32 v109, 15, v14
  v_mfma_f32_16x16x32_bf16 v[76:79], v[52:55], a[236:239], v[76:79]
  ds_read_b64_tr_b16 v[60:61], v2 offset:57344
  v_bfe_u32 v110, v14, 4, 1
  v_mfma_f32_16x16x32_bf16 v[72:75], v[52:55], a[232:235], v[72:75]
  ds_read_b64_tr_b16 v[62:63], v2 offset:57600
  v_lshl_add_u32 v109, v109, 1, v110
  v_mfma_f32_16x16x32_bf16 v[172:175], v[52:55], a[228:231], v[172:175]
L_pad7:
  s_cbranch_execz L_pad9
  buffer_load_dwordx4 a[120:123], v17, s[8:11], s71 offen offset:2048 sc1
  v_mfma_f32_16x16x32_bf16 v[168:171], v[52:55], a[224:227], v[168:171]
  s_waitcnt lgkmcnt(2)
  v_lshlrev_b32 v109, 3, v109
  v_lshl_add_u32 v108, v125, 15, v109
  v_mfma_f32_16x16x32_bf16 v[176:179], v[56:59], a[224:227], v[176:179]
  ds_read_b64_tr_b16 v[48:49], v1 offset:53248
  v_mul_u32_u24 v37, 8256, v125
  v_mfma_f32_16x16x32_bf16 v[180:183], v[56:59], a[228:231], v[180:183]
  ds_read_b64_tr_b16 v[50:51], v1 offset:53504
  v_add3_u32 v120, v37, v127, s59
  v_mfma_f32_16x16x32_bf16 v[80:83], v[56:59], a[232:235], v[80:83]
  buffer_load_dwordx4 a[124:127], v17, s[8:11], s71 offen offset:3072 sc1
  v_mfma_f32_16x16x32_bf16 v[84:87], v[56:59], a[236:239], v[84:87]
  s_waitcnt lgkmcnt(2)
  v_mul_u32_u24 v37, 4128, v125
  v_add_u32 v37, 16512, v37
  v_mfma_f32_16x16x32_bf16 v[92:95], v[60:63], a[236:239], v[92:95]
  ds_read_b64_tr_b16 v[52:53], v2 offset:53248
  s_add_u32 s71, s69, 32768
  v_mfma_f32_16x16x32_bf16 v[88:91], v[60:63], a[232:235], v[88:91]
  ds_read_b64_tr_b16 v[54:55], v2 offset:53504
  v_add3_u32 v121, v37, v127, s59
  v_mfma_f32_16x16x32_bf16 v[188:191], v[60:63], a[228:231], v[188:191]
  v_and_b32 v37, 3, v14
  v_min_u32 v38, 1, v37
  v_mfma_f32_16x16x32_bf16 v[184:187], v[60:63], a[224:227], v[184:187]
  s_waitcnt lgkmcnt(2)
  buffer_load_dwordx4 a[128:131], v17, s[8:11], s71 offen offset:0 sc1
  v_mfma_f32_16x16x32_bf16 v[160:163], v[48:51], a[240:243], v[160:163]
  ds_read_b64_tr_b16 v[56:57], v1 offset:61440
  v_mul_u32_u24 v38, 5, v38
  v_mfma_f32_16x16x32_bf16 v[164:167], v[48:51], a[244:247], v[164:167]
  ds_read_b64_tr_b16 v[58:59], v1 offset:61696
  v_sub_u32 v38, 4, v38
  v_mfma_f32_16x16x32_bf16 v[64:67], v[48:51], a[248:251], v[64:67]
  v_bfe_u32 v39, v14, 4, 1
  v_sub_u32 v38, v38, v37
  v_mfma_f32_16x16x32_bf16 v[68:71], v[48:51], a[252:255], v[68:71]
  s_waitcnt lgkmcnt(2)
  buffer_load_dwordx4 a[132:135], v17, s[8:11], s71 offen offset:1024 sc1
  v_mfma_f32_16x16x32_bf16 v[76:79], v[52:55], a[252:255], v[76:79]
  ds_read_b64_tr_b16 v[60:61], v2 offset:61440
  v_mad_i32_i24 v37, v38, v39, v37
  v_mfma_f32_16x16x32_bf16 v[72:75], v[52:55], a[248:251], v[72:75]
  ds_read_b64_tr_b16 v[62:63], v2 offset:61696
  v_add_u32 v37, 6, v37
  v_mfma_f32_16x16x32_bf16 v[172:175], v[52:55], a[244:247], v[172:175]
  v_mul_u32_u24 v37, 4128, v37
  v_bfe_u32 v38, v14, 2, 2
  v_mfma_f32_16x16x32_bf16 v[168:171], v[52:55], a[240:243], v[168:171]
  s_waitcnt lgkmcnt(2)
  v_lshl_add_u32 v38, v125, 2, v38
  v_lshl_add_u32 v37, v38, 3, v37
  v_add_u32 v122, s59, v37
  v_lshlrev_b32 v124, 4, v126
  v_lshl_add_u32 v123, v125, 10, v124
  v_mov_b32 v20, s64
  v_mov_b32 v21, 0x3f803f80
  v_mov_b32 v22, s64
  v_mov_b32 v23, 0x3f803f80
  v_add_u32 v38, 147456, v17
  s_waitcnt vmcnt(4)
  v_subrev_u32 v15, s85, v15
  v_subrev_u32 v15, 4, v15
  v_cmp_gt_u32 vcc, 4, v15
  s_nop 0
  s_cmp_eq_u64 vcc, -1
  s_cbranch_scc0 L_slow4
L_back4:
  s_barrier
  v_mfma_f32_16x16x32_bf16 v[176:179], v[56:59], a[240:243], v[176:179]
  ds_read_b64_tr_b16 v[48:49], v3 offset:0
  s_lshl_b32 s58, s3, 10
  v_mfma_f32_16x16x32_bf16 v[180:183], v[56:59], a[244:247], v[180:183]
  ds_read_b64_tr_b16 v[50:51], v3 offset:256
  s_add_u32 s58, s58, 0
  v_mfma_f32_16x16x32_bf16 v[80:83], v[56:59], a[248:251], v[80:83]
  s_add_u32 m0, s58, 0
  ds_read_b128 v[128:131], v38 offset:0
  v_mfma_f32_16x16x32_bf16 v[84:87], v[56:59], a[252:255], v[84:87]
  s_waitcnt lgkmcnt(3)
  buffer_load_dwordx4 v17, s[32:35], s61 offen sc1 lds
  v_mfma_f32_16x16x32_bf16 v[92:95], v[60:63], a[252:255], v[92:95]
  ds_read_b64_tr_b16 v[52:53], v4 offset:0
  s_add_u32 s61, s61, 16384
  v_mfma_f32_16x16x32_bf16 v[88:91], v[60:63], a[248:251], v[88:91]
  ds_read_b64_tr_b16 v[54:55], v4 offset:256
  s_add_u32 m0, s58, 4128
  v_mfma_f32_16x16x32_bf16 v[188:191], v[60:63], a[244:247], v[188:191]
  buffer_load_dwordx4 v17, s[32:35], s61 offen sc1 lds
  v_mfma_f32_16x16x32_bf16 v[184:187], v[60:63], a[240:243], v[184:187]
  s_waitcnt lgkmcnt(3)
  s_add_u32 s61, s61, 16384
  s_add_u32 m0, s58, 8256
  v_mfma_f32_16x16x32_bf16 v[160:163], v[48:51], v[192:195], v[160:163]
  ds_read_b64_tr_b16 v[56:57], v3 offset:8192
  v_mfma_f32_16x16x32_bf16 v[164:167], v[48:51], v[196:199], v[164:167]
  ds_read_b64_tr_b16 v[58:59], v3 offset:8448
  v_mfma_f32_16x16x32_bf16 v[64:67], v[48:51], v[200:203], v[64:67]
  buffer_load_dwordx4 v17, s[32:35], s61 offen sc1 lds
  v_mfma_f32_16x16x32_bf16 v[68:71], v[48:51], v[204:207], v[68:71]
  s_waitcnt lgkmcnt(2)
  s_add_u32 s61, s61, 16384
  s_add_u32 m0, s58, 12384
  v_mfma_f32_16x16x32_bf16 v[76:79], v[52:55], v[204:207], v[76:79]
  ds_read_b64_tr_b16 v[60:61], v4 offset:8192
  v_mfma_f32_16x16x32_bf16 v[72:75], v[52:55], v[200:203], v[72:75]
  ds_read_b64_tr_b16 v[62:63], v4 offset:8448
  v_mfma_f32_16x16x32_bf16 v[172:175], v[52:55], v[196:199], v[172:175]
  ds_read_b128 v[132:135], v38 offset:1024
  v_mfma_f32_16x16x32_bf16 v[168:171], v[52:55], v[192:195], v[168:171]
  s_waitcnt lgkmcnt(3)
  buffer_load_dwordx4 v17, s[32:35], s61 offen sc1 lds
  v_mfma_f32_16x16x32_bf16 v[176:179], v[56:59], v[192:195], v[176:179]
  ds_read_b64_tr_b16 v[48:49], v3 offset:4096
  s_add_u32 s61, s61, 16384
  v_mfma_f32_16x16x32_bf16 v[180:183], v[56:59], v[196:199], v[180:183]
  ds_read_b64_tr_b16 v[50:51], v3 offset:4352
  s_add_u32 m0, s58, 16512
  v_mfma_f32_16x16x32_bf16 v[80:83], v[56:59], v[200:203], v[80:83]
  ds_read_b128 v[136:139], v38 offset:2048
  v_mfma_f32_16x16x32_bf16 v[84:87], v[56:59], v[204:207], v[84:87]
  s_waitcnt lgkmcnt(4)
  buffer_load_dwordx4 v17, s[32:35], s61 offen sc1 lds
  v_mfma_f32_16x16x32_bf16 v[92:95], v[60:63], v[204:207], v[92:95]
  ds_read_b64_tr_b16 v[52:53], v4 offset:4096
  s_add_u32 s61, s61, 16384
  v_mfma_f32_16x16x32_bf16 v[88:91], v[60:63], v[200:203], v[88:91]
  ds_read_b64_tr_b16 v[54:55], v4 offset:4352
  v_add_u32 v110, s58, v17
  v_mfma_f32_16x16x32_bf16 v[188:191], v[60:63], v[196:199], v[188:191]
  ds_write_b128 v110, v[20:23] offset:20640
  s_add_u32 s61, s63, 16384
  v_mfma_f32_16x16x32_bf16 v[184:187], v[60:63], v[192:195], v[184:187]
  s_waitcnt lgkmcnt(4)
  ds_read_b128 v[140:143], v38 offset:3072
  v_mfma_f32_16x16x32_bf16 v[160:163], v[48:51], v[208:211], v[160:163]
  ds_read_b64_tr_b16 v[56:57], v3 offset:12288
  v_mfma_f32_16x16x32_bf16 v[164:167], v[48:51], v[212:215], v[164:167]
  ds_read_b64_tr_b16 v[58:59], v3 offset:12544
  v_mfma_f32_16x16x32_bf16 v[64:67], v[48:51], v[216:219], v[64:67]
  buffer_load_dwordx2 v[96:97], v108, s[32:35], s63 offen offset:0 sc1
  v_mfma_f32_16x16x32_bf16 v[68:71], v[48:51], v[220:223], v[68:71]
  s_waitcnt lgkmcnt(4)
  ds_read_b128 v[144:147], v38 offset:4096
  v_mfma_f32_16x16x32_bf16 v[76:79], v[52:55], v[220:223], v[76:79]
  ds_read_b64_tr_b16 v[60:61], v4 offset:12288
  v_mfma_f32_16x16x32_bf16 v[72:75], v[52:55], v[216:219], v[72:75]
  ds_read_b64_tr_b16 v[62:63], v4 offset:12544
  v_mfma_f32_16x16x32_bf16 v[172:175], v[52:55], v[212:215], v[172:175]
  buffer_load_dwordx2 v[98:99], v108, s[32:35], s61 offen offset:0 sc1
  v_mfma_f32_16x16x32_bf16 v[168:171], v[52:55], v[208:211], v[168:171]
  s_waitcnt lgkmcnt(3)
  s_barrier
  v_mfma_f32_16x16x32_bf16 v[176:179], v[56:59], v[208:211], v[176:179]
  ds_read_b64_tr_b16 v[48:49], v1 offset:0
  v_mfma_f32_16x16x32_bf16 v[180:183], v[56:59], v[212:215], v[180:183]
  ds_read_b64_tr_b16 v[50:51], v1 offset:256
  v_mfma_f32_16x16x32_bf16 v[80:83], v[56:59], v[216:219], v[80:83]
  buffer_load_dwordx2 v[102:103], v108, s[32:35], s63 offen offset:256 sc1
  v_mfma_f32_16x16x32_bf16 v[84:87], v[56:59], v[220:223], v[84:87]
  s_waitcnt lgkmcnt(2)
  ds_read_b128 v[148:151], v38 offset:5120
  v_mfma_f32_16x16x32_bf16 v[92:95], v[60:63], v[220:223], v[92:95]
  ds_read_b64_tr_b16 v[52:53], v2 offset:0
  v_mfma_f32_16x16x32_bf16 v[88:91], v[60:63], v[216:219], v[88:91]
  ds_read_b64_tr_b16 v[54:55], v2 offset:256
  v_mfma_f32_16x16x32_bf16 v[188:191], v[60:63], v[212:215], v[188:191]
  buffer_load_dwordx2 v[104:105], v108, s[32:35], s61 offen offset:256 sc1
  v_mfma_f32_16x16x32_bf16 v[184:187], v[60:63], v[208:211], v[184:187]
  s_waitcnt lgkmcnt(3)
  s_add_u32 s61, s63, 65536
  v_mfma_f32_16x16x32_bf16 v[160:163], v[48:51], v[224:227], v[160:163]
  ds_read_b64_tr_b16 v[56:57], v1 offset:8192
  v_mfma_f32_16x16x32_bf16 v[164:167], v[48:51], v[228:231], v[164:167]
  ds_read_b64_tr_b16 v[58:59], v1 offset:8448
  v_mfma_f32_16x16x32_bf16 v[64:67], v[48:51], v[232:235], v[64:67]
  buffer_load_dwordx2 v[100:101], v109, s[32:35], s61 offen offset:0 sc1
  v_mfma_f32_16x16x32_bf16 v[68:71], v[48:51], v[236:239], v[68:71]
  s_waitcnt lgkmcnt(2)
  ds_read_b128 v[152:155], v38 offset:6144
  v_mfma_f32_16x16x32_bf16 v[76:79], v[52:55], v[236:239], v[76:79]
  ds_read_b64_tr_b16 v[60:61], v2 offset:8192
  v_mfma_f32_16x16x32_bf16 v[72:75], v[52:55], v[232:235], v[72:75]
  ds_read_b64_tr_b16 v[62:63], v2 offset:8448
  v_mfma_f32_16x16x32_bf16 v[172:175], v[52:55], v[228:231], v[172:175]
  ds_read_b128 v[156:159], v38 offset:7168
  v_mfma_f32_16x16x32_bf16 v[168:171], v[52:55], v[224:227], v[168:171]
  s_waitcnt lgkmcnt(4)
  buffer_load_dwordx2 v[106:107], v109, s[32:35], s61 offen offset:256 sc1
  v_mfma_f32_16x16x32_bf16 v[176:179], v[56:59], v[224:227], v[176:179]
  ds_read_b64_tr_b16 v[48:49], v1 offset:4096
  s_add_u32 m0, s58, 24768
  v_mfma_f32_16x16x32_bf16 v[180:183], v[56:59], v[228:231], v[180:183]
  ds_read_b64_tr_b16 v[50:51], v1 offset:4352
  v_mfma_f32_16x16x32_bf16 v[80:83], v[56:59], v[232:235], v[80:83]
  v_mfma_f32_16x16x32_bf16 v[84:87], v[56:59], v[236:239], v[84:87]
  s_waitcnt lgkmcnt(3)
  buffer_load_dwordx4 v17, s[32:35], s62 offen sc1 lds
  v_mfma_f32_16x16x32_bf16 v[92:95], v[60:63], v[236:239], v[92:95]
  ds_read_b64_tr_b16 v[52:53], v2 offset:4096
  s_add_u32 s62, s62, 16384
  v_mfma_f32_16x16x32_bf16 v[88:91], v[60:63], v[232:235], v[88:91]
  ds_read_b64_tr_b16 v[54:55], v2 offset:4352
  s_add_u32 m0, s58, 28896
  v_mfma_f32_16x16x32_bf16 v[188:191], v[60:63], v[228:231], v[188:191]
  v_mfma_f32_16x16x32_bf16 v[184:187], v[60:63], v[224:227], v[184:187]
  s_waitcnt lgkmcnt(2)
  buffer_load_dwordx4 v17, s[32:35], s62 offen sc1 lds
  v_mfma_f32_16x16x32_bf16 v[160:163], v[48:51], v[240:243], v[160:163]
  ds_read_b64_tr_b16 v[56:57], v1 offset:12288
  s_add_u32 s62, s62, 16384
  v_mfma_f32_16x16x32_bf16 v[164:167], v[48:51], v[244:247], v[164:167]
  ds_read_b64_tr_b16 v[58:59], v1 offset:12544
  s_add_u32 m0, s58, 33024
  v_mfma_f32_16x16x32_bf16 v[64:67], v[48:51], v[248:251], v[64:67]
  v_mfma_f32_16x16x32_bf16 v[68:71], v[48:51], v[252:255], v[68:71]
  s_waitcnt lgkmcnt(2)
  v_mfma_f32_16x16x32_bf16 v[76:79], v[52:55], v[252:255], v[76:79]
  ds_read_b64_tr_b16 v[60:61], v2 offset:12288
  v_mfma_f32_16x16x32_bf16 v[72:75], v[52:55], v[248:251], v[72:75]
  ds_read_b64_tr_b16 v[62:63], v2 offset:12544
  v_mfma_f32_16x16x32_bf16 v[172:175], v[52:55], v[244:247], v[172:175]
  buffer_load_dwordx4 v17, s[32:35], s62 offen sc1 lds
  v_mfma_f32_16x16x32_bf16 v[168:171], v[52:55], v[240:243], v[168:171]
  s_waitcnt lgkmcnt(2)
  s_add_u32 s62, s62, 16384
  s_add_u32 m0, s58, 37152
  v_mfma_f32_16x16x32_bf16 v[176:179], v[56:59], v[240:243], v[176:179]
  v_mfma_f32_16x16x32_bf16 v[180:183], v[56:59], v[244:247], v[180:183]
  buffer_load_dwordx4 v17, s[32:35], s62 offen sc1 lds
  v_mfma_f32_16x16x32_bf16 v[80:83], v[56:59], v[248:251], v[80:83]
  s_add_u32 s62, s62, 16384
  s_add_u32 m0, s58, 41280
  v_mfma_f32_16x16x32_bf16 v[84:87], v[56:59], v[252:255], v[84:87]
  s_waitcnt lgkmcnt(0)
  v_mfma_f32_16x16x32_bf16 v[92:95], v[60:63], v[252:255], v[92:95]
  v_mfma_f32_16x16x32_bf16 v[88:91], v[60:63], v[248:251], v[88:91]
  buffer_load_dwordx4 v17, s[32:35], s62 offen sc1 lds
  v_mfma_f32_16x16x32_bf16 v[188:191], v[60:63], v[244:247], v[188:191]
  s_add_u32 s62, s62, 16384
  s_add_u32 s60, s85, 5
  s_mov_b32 s1, 163840
  v_mfma_f32_16x16x32_bf16 v[184:187], v[60:63], v[240:243], v[184:187]
  v_mov_b32 v44, s60
  s_mov_b32 s16, s4
  s_mov_b32 s17, s5
  s_mov_b32 s18, 0x280000
  s_mov_b32 s19, 0x20000
  v_and_b32 v36, 3, v14
  v_lshrrev_b32 v37, 2, v14
  v_mul_u32_u24 v37, 2560, v37
  v_lshl_add_u32 v5, v36, 3, v37
  s_mov_b32 s40, 0x3e60ec05
  s_mov_b32 s41, s40
  v_mov_b32 v48, v11
  v_mov_b32 v49, v11
  v_pk_fma_f32 v[36:37], v[160:161], v[160:161], v[48:49] neg_lo:[1,0,0] neg_hi:[1,0,0]
  v_pk_fma_f32 v[38:39], v[162:163], v[162:163], v[48:49] neg_lo:[1,0,0] neg_hi:[1,0,0]
  v_pk_fma_f32 v[40:41], v[168:169], v[168:169], v[48:49] neg_lo:[1,0,0] neg_hi:[1,0,0]
  v_pk_fma_f32 v[42:43], v[170:171], v[170:171], v[48:49] neg_lo:[1,0,0] neg_hi:[1,0,0]
  v_pk_mul_f32 v[36:37], v[36:37], v[160:161]
  v_pk_mul_f32 v[38:39], v[38:39], v[162:163]
  v_pk_mul_f32 v[40:41], v[40:41], v[168:169]
  v_pk_mul_f32 v[42:43], v[42:43], v[170:171]
  v_exp_f32 v36, v36
  v_exp_f32 v37, v37
  v_exp_f32 v38, v38
  v_exp_f32 v39, v39
  v_exp_f32 v40, v40
  buffer_store_dword v44, v13, s[12:15], s1 offen sc1
  v_exp_f32 v41, v41
  v_exp_f32 v42, v42
  v_exp_f32 v43, v43
  v_pk_mul_f32 v[176:177], v[160:161], v[176:177]
  v_pk_mul_f32 v[178:179], v[162:163], v[178:179]
  v_pk_mul_f32 v[184:185], v[168:169], v[184:185]
  v_pk_mul_f32 v[186:187], v[170:171], v[186:187]
  v_pk_fma_f32 v[36:37], v[36:37], s[40:41], s[40:41]
  v_pk_fma_f32 v[38:39], v[38:39], s[40:41], s[40:41]
  v_pk_fma_f32 v[40:41], v[40:41], s[40:41], s[40:41]
  v_pk_fma_f32 v[42:43], v[42:43], s[40:41], s[40:41]
  v_rcp_f32 v36, v36
  v_rcp_f32 v37, v37
  buffer_load_dwordx4 a[136:139], v17, s[8:11], s71 offen offset:2048 sc1
  v_rcp_f32 v38, v38
  v_rcp_f32 v39, v39
  v_rcp_f32 v40, v40
  v_rcp_f32 v41, v41
  v_rcp_f32 v42, v42
  v_rcp_f32 v43, v43
  v_pk_mul_f32 v[176:177], v[176:177], v[36:37]
  v_pk_mul_f32 v[178:179], v[178:179], v[38:39]
  v_pk_mul_f32 v[184:185], v[184:185], v[40:41]
  v_pk_mul_f32 v[186:187], v[186:187], v[42:43]
  v_cvt_pk_bf16_f32 v20, v176, v177
  v_cvt_pk_bf16_f32 v21, v178, v179
  buffer_load_dwordx4 a[140:143], v17, s[8:11], s71 offen offset:3072 sc1
  s_add_u32 s71, s69, 36864
  v_cvt_pk_bf16_f32 v22, v184, v185
  v_cvt_pk_bf16_f32 v23, v186, v187
  buffer_store_dwordx4 v[20:23], v10, s[36:39], s56 offen offset:0 sc1
  v_pk_fma_f32 v[36:37], v[164:165], v[164:165], v[48:49] neg_lo:[1,0,0] neg_hi:[1,0,0]
  v_pk_fma_f32 v[38:39], v[166:167], v[166:167], v[48:49] neg_lo:[1,0,0] neg_hi:[1,0,0]
  v_pk_fma_f32 v[40:41], v[172:173], v[172:173], v[48:49] neg_lo:[1,0,0] neg_hi:[1,0,0]
  v_pk_fma_f32 v[42:43], v[174:175], v[174:175], v[48:49] neg_lo:[1,0,0] neg_hi:[1,0,0]
  v_pk_mul_f32 v[36:37], v[36:37], v[164:165]
  v_pk_mul_f32 v[38:39], v[38:39], v[166:167]
  v_pk_mul_f32 v[40:41], v[40:41], v[172:173]
  v_pk_mul_f32 v[42:43], v[42:43], v[174:175]
  v_exp_f32 v36, v36
  v_exp_f32 v37, v37
  v_exp_f32 v38, v38
  v_exp_f32 v39, v39
  buffer_load_dwordx4 a[144:147], v17, s[8:11], s71 offen offset:0 sc1
  v_exp_f32 v40, v40
  v_exp_f32 v41, v41
  v_exp_f32 v42, v42
  v_exp_f32 v43, v43
  v_pk_mul_f32 v[180:181], v[164:165], v[180:181]
  v_pk_mul_f32 v[182:183], v[166:167], v[182:183]
  v_pk_mul_f32 v[188:189], v[172:173], v[188:189]
  v_pk_mul_f32 v[190:191], v[174:175], v[190:191]
  v_pk_fma_f32 v[36:37], v[36:37], s[40:41], s[40:41]
  v_pk_fma_f32 v[38:39], v[38:39], s[40:41], s[40:41]
  v_pk_fma_f32 v[40:41], v[40:41], s[40:41], s[40:41]
  v_pk_fma_f32 v[42:43], v[42:43], s[40:41], s[40:41]
  v_rcp_f32 v36, v36
  buffer_load_dwordx4 a[148:151], v17, s[8:11], s71 offen offset:1024 sc1
  v_rcp_f32 v37, v37
  v_rcp_f32 v38, v38
  v_rcp_f32 v39, v39
  v_rcp_f32 v40, v40
  v_rcp_f32 v41, v41
  v_rcp_f32 v42, v42
  v_rcp_f32 v43, v43
  v_pk_mul_f32 v[180:181], v[180:181], v[36:37]
  v_pk_mul_f32 v[182:183], v[182:183], v[38:39]
  v_pk_mul_f32 v[188:189], v[188:189], v[40:41]
  v_pk_mul_f32 v[190:191], v[190:191], v[42:43]
  buffer_load_dwordx4 a[152:155], v17, s[8:11], s71 offen offset:2048 sc1
  v_cvt_pk_bf16_f32 v24, v180, v181
  v_cvt_pk_bf16_f32 v25, v182, v183
  v_cvt_pk_bf16_f32 v26, v188, v189
  v_cvt_pk_bf16_f32 v27, v190, v191
  buffer_store_dwordx4 v[24:27], v10, s[36:39], s56 offen offset:256 sc1
  v_pk_fma_f32 v[36:37], v[64:65], v[64:65], v[48:49] neg_lo:[1,0,0] neg_hi:[1,0,0]
  v_pk_fma_f32 v[38:39], v[66:67], v[66:67], v[48:49] neg_lo:[1,0,0] neg_hi:[1,0,0]
  v_pk_fma_f32 v[40:41], v[72:73], v[72:73], v[48:49] neg_lo:[1,0,0] neg_hi:[1,0,0]
  v_pk_fma_f32 v[42:43], v[74:75], v[74:75], v[48:49] neg_lo:[1,0,0] neg_hi:[1,0,0]
  v_pk_mul_f32 v[36:37], v[36:37], v[64:65]
  v_pk_mul_f32 v[38:39], v[38:39], v[66:67]
  v_pk_mul_f32 v[40:41], v[40:41], v[72:73]
  v_pk_mul_f32 v[42:43], v[42:43], v[74:75]
  v_exp_f32 v36, v36
  v_exp_f32 v37, v37
  v_exp_f32 v38, v38
  buffer_load_dwordx4 a[156:159], v17, s[8:11], s71 offen offset:3072 sc1
  s_add_u32 s71, s69, 40960
  v_exp_f32 v39, v39
  v_exp_f32 v40, v40
  v_exp_f32 v41, v41
  v_exp_f32 v42, v42
  v_exp_f32 v43, v43
  v_pk_mul_f32 v[80:81], v[64:65], v[80:81]
  v_pk_mul_f32 v[82:83], v[66:67], v[82:83]
  v_pk_mul_f32 v[88:89], v[72:73], v[88:89]
  v_pk_mul_f32 v[90:91], v[74:75], v[90:91]
  v_pk_fma_f32 v[36:37], v[36:37], s[40:41], s[40:41]
  v_pk_fma_f32 v[38:39], v[38:39], s[40:41], s[40:41]
  v_pk_fma_f32 v[40:41], v[40:41], s[40:41], s[40:41]
  v_pk_fma_f32 v[42:43], v[42:43], s[40:41], s[40:41]
  buffer_load_dwordx4 a[160:163], v17, s[8:11], s71 offen offset:0 sc1
  v_rcp_f32 v36, v36
  v_rcp_f32 v37, v37
  v_rcp_f32 v38, v38
  v_rcp_f32 v39, v39
  v_rcp_f32 v40, v40
  v_rcp_f32 v41, v41
  v_rcp_f32 v42, v42
  v_rcp_f32 v43, v43
  v_pk_mul_f32 v[80:81], v[80:81], v[36:37]
  v_pk_mul_f32 v[82:83], v[82:83], v[38:39]
  buffer_load_dwordx4 a[164:167], v17, s[8:11], s71 offen offset:1024 sc1
  v_pk_mul_f32 v[88:89], v[88:89], v[40:41]
  v_pk_mul_f32 v[90:91], v[90:91], v[42:43]
  v_cvt_pk_bf16_f32 v28, v80, v81
  v_cvt_pk_bf16_f32 v29, v82, v83
  v_cvt_pk_bf16_f32 v30, v88, v89
  v_cvt_pk_bf16_f32 v31, v90, v91
  buffer_store_dwordx4 v[28:31], v10, s[36:39], s56 offen offset:512 sc1
  v_pk_fma_f32 v[36:37], v[68:69], v[68:69], v[48:49] neg_lo:[1,0,0] neg_hi:[1,0,0]
  v_pk_fma_f32 v[38:39], v[70:71], v[70:71], v[48:49] neg_lo:[1,0,0] neg_hi:[1,0,0]
  v_pk_fma_f32 v[40:41], v[76:77], v[76:77], v[48:49] neg_lo:[1,0,0] neg_hi:[1,0,0]
  v_pk_fma_f32 v[42:43], v[78:79], v[78:79], v[48:49] neg_lo:[1,0,0] neg_hi:[1,0,0]
  v_pk_mul_f32 v[36:37], v[36:37], v[68:69]
  v_pk_mul_f32 v[38:39], v[38:39], v[70:71]
  v_pk_mul_f32 v[40:41], v[40:41], v[76:77]
  v_pk_mul_f32 v[42:43], v[42:43], v[78:79]
  v_exp_f32 v36, v36
  v_exp_f32 v37, v37
  buffer_load_dwordx4 a[168:171], v17, s[8:11], s71 offen offset:2048 sc1
  v_exp_f32 v38, v38
  v_exp_f32 v39, v39
  v_exp_f32 v40, v40
  v_exp_f32 v41, v41
  v_exp_f32 v42, v42
  v_exp_f32 v43, v43
  v_pk_mul_f32 v[84:85], v[68:69], v[84:85]
  v_pk_mul_f32 v[86:87], v[70:71], v[86:87]
  v_pk_mul_f32 v[92:93], v[76:77], v[92:93]
  v_pk_mul_f32 v[94:95], v[78:79], v[94:95]
  v_pk_fma_f32 v[36:37], v[36:37], s[40:41], s[40:41]
  v_pk_fma_f32 v[38:39], v[38:39], s[40:41], s[40:41]
  buffer_load_dwordx4 a[172:175], v17, s[8:11], s71 offen offset:3072 sc1
  s_add_u32 s71, s69, 45056
  v_pk_fma_f32 v[40:41], v[40:41], s[40:41], s[40:41]
  v_pk_fma_f32 v[42:43], v[42:43], s[40:41], s[40:41]
  v_rcp_f32 v36, v36
  v_rcp_f32 v37, v37
  v_rcp_f32 v38, v38
  v_rcp_f32 v39, v39
  v_rcp_f32 v40, v40
  v_rcp_f32 v41, v41
  v_rcp_f32 v42, v42
  v_rcp_f32 v43, v43
  buffer_load_dwordx4 a[176:179], v17, s[8:11], s71 offen offset:0 sc1
  v_pk_mul_f32 v[84:85], v[84:85], v[36:37]
  v_pk_mul_f32 v[86:87], v[86:87], v[38:39]
  v_pk_mul_f32 v[92:93], v[92:93], v[40:41]
  v_pk_mul_f32 v[94:95], v[94:95], v[42:43]
  v_cvt_pk_bf16_f32 v32, v84, v85
  v_cvt_pk_bf16_f32 v33, v86, v87
  v_cvt_pk_bf16_f32 v34, v92, v93
  v_cvt_pk_bf16_f32 v35, v94, v95
  buffer_store_dwordx4 v[32:35], v10, s[36:39], s56 offen offset:768 sc1
  s_lshl_b32 s58, s3, 8
  v_add_u32 v1, s58, v10
  v_xor_b32 v2, 256, v1
  v_xor_b32 v3, 512, v1
  v_xor_b32 v4, 768, v1
  s_xor_b32 s58, s3, 1
  s_mul_i32 s58, s58, 15360
  s_add_u32 s58, s58, 0
  v_add_u32 v6, s58, v17
  s_xor_b32 s58, s3, 2
  s_mul_i32 s58, s58, 15360
  s_add_u32 s58, s58, 5120
  v_add_u32 v7, s58, v17
  s_xor_b32 s58, s3, 3
  s_mul_i32 s58, s58, 15360
  s_add_u32 s58, s58, 10240
  v_add_u32 v8, s58, v17
  s_mul_i32 s58, s3, 15360
  s_add_u32 s58, s58, 0
  v_add_u32 v9, s58, v17
  v_add_u32 v11, 61440, v17
  v_add_u32 v12, 126976, v17
  v_bfe_u32 v36, v14, 2, 2
  v_lshrrev_b32 v37, 4, v14
  v_lshl_add_u32 v36, v36, 3, v37
  v_add_u32 v36, s76, v36
  v_lshlrev_b32 v16, 7, v36
  v_cmp_gt_u32 vcc, 32, v14
  s_lshl_b32 s58, s3, 8
  s_add_u32 s58, s58, s2
  s_lshl_b32 s58, s58, 7
  v_lshl_add_u32 v36, v14, 2, s58
  v_bfrev_b32 v37, 1
  v_cndmask_b32 v13, v37, v36, vcc
  v_bfe_u32 v36, v14, 3, 2
  v_lshlrev_b32 v36, 10, v36
  v_lshrrev_b32 v37, 5, v14
  v_lshl_add_u32 v36, v37, 16, v36
  s_add_u32 s58, s76, s3
  s_lshl_b32 s58, s58, 7
  s_and_b32 s59, s77, 0x8000
  s_add_u32 s58, s58, s59
  v_add_u32 v18, s58, v36
  s_waitcnt vmcnt(21)
  s_mov_b32 exec_lo, 0
  v_mov_b32 v100, 0x3f80
  v_mov_b32 v101, 0
  v_mov_b32 v106, 0x3f80
  v_mov_b32 v107, 0
  s_mov_b32 exec_lo, -1
  s_waitcnt vmcnt(16) lgkmcnt(0)
  s_barrier
  ds_read_b64 v[108:109], v120 offset:0
  ds_read_b64 v[110:111], v120 offset:4128
  ds_read_b64 v[112:113], v121 offset:0
  ds_read_b64 v[114:115], v120 offset:256
  ds_read_b64 v[116:117], v120 offset:4384
  ds_read_b64 v[118:119], v121 offset:256
  ds_read_b64_tr_b16 v[20:21], v122 offset:0
  ds_read_b64_tr_b16 v[22:23], v122 offset:64
  ds_read_b64_tr_b16 v[24:25], v122 offset:128
  ds_read_b64_tr_b16 v[26:27], v122 offset:192
  s_waitcnt lgkmcnt(8)
  v_mfma_f32_32x32x16_bf16 v[64:79], v[108:111], v[96:99], v[128:143]
  s_waitcnt lgkmcnt(7)
  v_mfma_f32_32x32x8_bf16 v[64:79], v[112:113], v[100:101], v[64:79]
  s_waitcnt lgkmcnt(5)
  v_mfma_f32_32x32x16_bf16 v[80:95], v[114:117], v[96:99], 0
  ds_read_b64_tr_b16 v[28:29], v122 offset:256
  ds_read_b64_tr_b16 v[30:31], v122 offset:320
  ds_read_b64_tr_b16 v[32:33], v122 offset:384
  ds_read_b64_tr_b16 v[34:35], v122 offset:448
  s_nop 5
  v_exp_f32 v64, v64
  v_exp_f32 v65, v65
  v_exp_f32 v66, v66
  v_exp_f32 v67, v67
  s_waitcnt lgkmcnt(8)
  v_mfma_f32_32x32x8_bf16 v[80:95], v[118:119], v[100:101], v[80:95]
  buffer_load_dwordx4 a[180:183], v17, s[8:11], s71 offen offset:1024 sc1
  v_exp_f32 v68, v68
  v_exp_f32 v69, v69
  v_exp_f32 v70, v70
  v_exp_f32 v71, v71
  v_cvt_pk_bf16_f32 v48, v64, v65
  v_cvt_pk_bf16_f32 v49, v66, v67
  buffer_load_dwordx4 a[184:187], v17, s[8:11], s71 offen offset:2048 sc1
  v_exp_f32 v72, v72
  v_exp_f32 v73, v73
  v_exp_f32 v74, v74
  v_exp_f32 v75, v75
  v_cvt_pk_bf16_f32 v50, v68, v69
  v_cvt_pk_bf16_f32 v51, v70, v71
  buffer_load_dwordx4 a[188:191], v17, s[8:11], s71 offen offset:3072 sc1
  s_add_u32 s71, s69, 49152
  v_exp_f32 v76, v76
  v_exp_f32 v77, v77
  v_exp_f32 v78, v78
  v_exp_f32 v79, v79
  v_cvt_pk_bf16_f32 v52, v72, v73
  v_cvt_pk_bf16_f32 v53, v74, v75
  v_cvt_pk_bf16_f32 v54, v76, v77
  v_cvt_pk_bf16_f32 v55, v78, v79
  v_mfma_f32_32x32x16_bf16 v[64:79], v[114:117], v[102:105], v[128:143]
  v_exp_f32 v80, v80
  v_exp_f32 v81, v81
  v_exp_f32 v82, v82
  v_exp_f32 v83, v83
  v_mfma_f32_32x32x8_bf16 v[64:79], v[118:119], v[106:107], v[64:79]
  buffer_load_dwordx4 a[192:195], v17, s[8:11], s71 offen offset:0 sc1
  v_exp_f32 v84, v84
  v_exp_f32 v85, v85
  v_exp_f32 v86, v86
  v_exp_f32 v87, v87
  v_cvt_pk_bf16_f32 v56, v80, v81
  v_cvt_pk_bf16_f32 v57, v82, v83
  s_waitcnt lgkmcnt(6)
  v_mfma_f32_32x32x16_bf16 v[160:175], v[20:23], v[48:51], 0
  ds_read_b64 v[108:109], v120 offset:512
  ds_read_b64 v[110:111], v120 offset:4640
  ds_read_b64 v[112:113], v121 offset:512
  buffer_load_dwordx4 a[196:199], v17, s[8:11], s71 offen offset:1024 sc1
  v_exp_f32 v88, v88
  v_exp_f32 v89, v89
  v_exp_f32 v90, v90
  v_exp_f32 v91, v91
  v_cvt_pk_bf16_f32 v58, v84, v85
  v_cvt_pk_bf16_f32 v59, v86, v87
  s_waitcnt lgkmcnt(7)
  v_mfma_f32_32x32x16_bf16 v[160:175], v[24:27], v[52:55], v[160:175]
  buffer_load_dwordx4 a[200:203], v17, s[8:11], s71 offen offset:2048 sc1
  v_exp_f32 v92, v92
  v_exp_f32 v93, v93
  v_exp_f32 v94, v94
  v_exp_f32 v95, v95
  v_cvt_pk_bf16_f32 v60, v88, v89
  v_cvt_pk_bf16_f32 v61, v90, v91
  v_cvt_pk_bf16_f32 v62, v92, v93
  v_cvt_pk_bf16_f32 v63, v94, v95
  s_waitcnt lgkmcnt(1)
  v_mfma_f32_32x32x16_bf16 v[80:95], v[108:111], v[96:99], 0
  ds_read_b64_tr_b16 v[36:37], v122 offset:512
  ds_read_b64_tr_b16 v[38:39], v122 offset:576
  ds_read_b64_tr_b16 v[40:41], v122 offset:640
  ds_read_b64_tr_b16 v[42:43], v122 offset:704
  v_exp_f32 v64, v64
  v_exp_f32 v65, v65
  v_exp_f32 v66, v66
  v_exp_f32 v67, v67
  s_waitcnt lgkmcnt(4)
  v_mfma_f32_32x32x8_bf16 v[80:95], v[112:113], v[100:101], v[80:95]
  buffer_load_dwordx4 a[204:207], v17, s[8:11], s71 offen offset:3072 sc1
  s_add_u32 s71, s69, 53248
  v_exp_f32 v68, v68
  v_exp_f32 v69, v69
  v_exp_f32 v70, v70
  v_exp_f32 v71, v71
  v_cvt_pk_bf16_f32 v48, v64, v65
  v_cvt_pk_bf16_f32 v49, v66, v67
  v_mfma_f32_32x32x16_bf16 v[160:175], v[28:31], v[56:59], v[160:175]
  buffer_load_dwordx4 a[208:211], v17, s[8:11], s71 offen offset:0 sc1
  v_exp_f32 v72, v72
  v_exp_f32 v73, v73
  v_exp_f32 v74, v74
  v_exp_f32 v75, v75
  v_cvt_pk_bf16_f32 v50, v68, v69
  v_cvt_pk_bf16_f32 v51, v70, v71
  v_mfma_f32_32x32x16_bf16 v[160:175], v[32:35], v[60:63], v[160:175]
  buffer_load_dwordx4 a[212:215], v17, s[8:11], s71 offen offset:1024 sc1
  v_exp_f32 v76, v76
  v_exp_f32 v77, v77
  v_exp_f32 v78, v78
  v_exp_f32 v79, v79
  v_cvt_pk_bf16_f32 v52, v72, v73
  v_cvt_pk_bf16_f32 v53, v74, v75
  v_cvt_pk_bf16_f32 v54, v76, v77
  v_cvt_pk_bf16_f32 v55, v78, v79
  v_mfma_f32_32x32x16_bf16 v[64:79], v[108:111], v[102:105], 0
  v_exp_f32 v80, v80
  v_exp_f32 v81, v81
  v_exp_f32 v82, v82
  v_exp_f32 v83, v83
  v_mfma_f32_32x32x8_bf16 v[64:79], v[112:113], v[106:107], v[64:79]
L_pad8:
  s_cbranch_execz L_pad10
  buffer_load_dwordx4 a[216:219], v17, s[8:11], s71 offen offset:2048 sc1
  v_exp_f32 v84, v84
  v_exp_f32 v85, v85
  v_exp_f32 v86, v86
  v_exp_f32 v87, v87
  v_cvt_pk_bf16_f32 v56, v80, v81
  v_cvt_pk_bf16_f32 v57, v82, v83
  v_mfma_f32_32x32x16_bf16 v[176:191], v[28:31], v[48:51], 0
  ds_read_b64 v[114:115], v120 offset:768
  ds_read_b64 v[116:117], v120 offset:4896
  ds_read_b64 v[118:119], v121 offset:768
  buffer_load_dwordx4 a[220:223], v17, s[8:11], s71 offen offset:3072 sc1
  s_add_u32 s71, s69, 57344
  v_exp_f32 v88, v88
  v_exp_f32 v89, v89
  v_exp_f32 v90, v90
  v_exp_f32 v91, v91
  v_cvt_pk_bf16_f32 v58, v84, v85
  v_cvt_pk_bf16_f32 v59, v86, v87
  v_mfma_f32_32x32x16_bf16 v[176:191], v[32:35], v[52:55], v[176:191]
  buffer_load_dwordx4 a[224:227], v17, s[8:11], s71 offen offset:0 sc1
  v_exp_f32 v92, v92
  v_exp_f32 v93, v93
  v_exp_f32 v94, v94
  v_exp_f32 v95, v95
  v_cvt_pk_bf16_f32 v60, v88, v89
  v_cvt_pk_bf16_f32 v61, v90, v91
  v_cvt_pk_bf16_f32 v62, v92, v93
  v_cvt_pk_bf16_f32 v63, v94, v95
  s_waitcnt lgkmcnt(1)
  v_mfma_f32_32x32x16_bf16 v[80:95], v[114:117], v[96:99], 0
  ds_read_b64_tr_b16 v[20:21], v122 offset:768
  ds_read_b64_tr_b16 v[22:23], v122 offset:832
  ds_read_b64_tr_b16 v[24:25], v122 offset:896
  ds_read_b64_tr_b16 v[26:27], v122 offset:960
  v_exp_f32 v64, v64
  v_exp_f32 v65, v65
  v_exp_f32 v66, v66
  v_exp_f32 v67, v67
  s_waitcnt lgkmcnt(4)
  v_mfma_f32_32x32x8_bf16 v[80:95], v[118:119], v[100:101], v[80:95]
  s_mov_b32 s0, 163840
  buffer_load_dword v15, v16, s[12:15], s0 offen sc1
  buffer_load_dwordx4 a[228:231], v17, s[8:11], s71 offen offset:1024 sc1
  v_exp_f32 v68, v68
  v_exp_f32 v69, v69
  v_exp_f32 v70, v70
  v_exp_f32 v71, v71
  v_cvt_pk_bf16_f32 v48, v64, v65
  v_cvt_pk_bf16_f32 v49, v66, v67
  v_mfma_f32_32x32x16_bf16 v[160:175], v[36:39], v[56:59], v[160:175]
  buffer_load_dwordx4 a[232:235], v17, s[8:11], s71 offen offset:2048 sc1
  v_exp_f32 v72, v72
  v_exp_f32 v73, v73
  v_exp_f32 v74, v74
  v_exp_f32 v75, v75
  v_cvt_pk_bf16_f32 v50, v68, v69
  v_cvt_pk_bf16_f32 v51, v70, v71
  v_mfma_f32_32x32x16_bf16 v[160:175], v[40:43], v[60:63], v[160:175]
  s_waitcnt vmcnt(15)
  s_add_u32 s60, s85, 6
  s_mov_b32 s1, 196608
  v_mov_b32 v44, s60
  buffer_store_dword v44, v13, s[12:15], s1 offen sc1
  buffer_load_dwordx4 a[236:239], v17, s[8:11], s71 offen offset:3072 sc1
  s_add_u32 m0, s83, 0
  v_exp_f32 v76, v76
  v_exp_f32 v77, v77
  v_exp_f32 v78, v78
  v_exp_f32 v79, v79
  v_cvt_pk_bf16_f32 v52, v72, v73
  v_cvt_pk_bf16_f32 v53, v74, v75
  v_cvt_pk_bf16_f32 v54, v76, v77
  v_cvt_pk_bf16_f32 v55, v78, v79
  v_mfma_f32_32x32x16_bf16 v[64:79], v[114:117], v[102:105], 0
  v_exp_f32 v80, v80
  v_exp_f32 v81, v81
  v_exp_f32 v82, v82
  v_exp_f32 v83, v83
  v_mfma_f32_32x32x8_bf16 v[64:79], v[118:119], v[106:107], v[64:79]
  buffer_load_dwordx4 v17, s[8:11], s74 offen offset:0 sc1 lds
  v_exp_f32 v84, v84
  v_exp_f32 v85, v85
  v_exp_f32 v86, v86
  v_exp_f32 v87, v87
  v_cvt_pk_bf16_f32 v56, v80, v81
  v_cvt_pk_bf16_f32 v57, v82, v83
  v_mfma_f32_32x32x16_bf16 v[176:191], v[36:39], v[48:51], v[176:191]
  ds_read_b64 v[108:109], v120 offset:1024
  ds_read_b64 v[110:111], v120 offset:5152
  ds_read_b64 v[112:113], v121 offset:1024
  buffer_load_dwordx4 v17, s[8:11], s74 offen offset:1024 sc1 lds
  v_exp_f32 v88, v88
  v_exp_f32 v89, v89
  v_exp_f32 v90, v90
  v_exp_f32 v91, v91
  v_cvt_pk_bf16_f32 v58, v84, v85
  v_cvt_pk_bf16_f32 v59, v86, v87
  v_mfma_f32_32x32x16_bf16 v[176:191], v[40:43], v[52:55], v[176:191]
  buffer_load_dwordx4 v17, s[8:11], s74 offen offset:2048 sc1 lds
  v_exp_f32 v92, v92
  v_exp_f32 v93, v93
  v_exp_f32 v94, v94
  v_exp_f32 v95, v95
  v_cvt_pk_bf16_f32 v60, v88, v89
  v_cvt_pk_bf16_f32 v61, v90, v91
  v_cvt_pk_bf16_f32 v62, v92, v93
  v_cvt_pk_bf16_f32 v63, v94, v95
  s_waitcnt lgkmcnt(1)
  v_mfma_f32_32x32x16_bf16 v[80:95], v[108:111], v[96:99], 0
  ds_read_b64_tr_b16 v[28:29], v122 offset:1024
  ds_read_b64_tr_b16 v[30:31], v122 offset:1088
  ds_read_b64_tr_b16 v[32:33], v122 offset:1152
  ds_read_b64_tr_b16 v[34:35], v122 offset:1216
  v_exp_f32 v64, v64
  v_exp_f32 v65, v65
  v_exp_f32 v66, v66
  v_exp_f32 v67, v67
  s_waitcnt lgkmcnt(4)
  v_mfma_f32_32x32x8_bf16 v[80:95], v[112:113], v[100:101], v[80:95]
  buffer_load_dwordx4 v17, s[8:11], s74 offen offset:3072 sc1 lds
  s_add_u32 m0, s83, 4096
  s_add_u32 s74, s74, 4096
  v_exp_f32 v68, v68
  v_exp_f32 v69, v69
  v_exp_f32 v70, v70
  v_exp_f32 v71, v71
  v_cvt_pk_bf16_f32 v48, v64, v65
  v_cvt_pk_bf16_f32 v49, v66, v67
  v_mfma_f32_32x32x16_bf16 v[160:175], v[20:23], v[56:59], v[160:175]
  buffer_load_dwordx4 v17, s[8:11], s74 offen offset:0 sc1 lds
  v_exp_f32 v72, v72
  v_exp_f32 v73, v73
  v_exp_f32 v74, v74
  v_exp_f32 v75, v75
  v_cvt_pk_bf16_f32 v50, v68, v69
  v_cvt_pk_bf16_f32 v51, v70, v71
  v_mfma_f32_32x32x16_bf16 v[160:175], v[24:27], v[60:63], v[160:175]
  buffer_load_dwordx4 v17, s[8:11], s74 offen offset:1024 sc1 lds
  v_exp_f32 v76, v76
  v_exp_f32 v77, v77
  v_exp_f32 v78, v78
  v_exp_f32 v79, v79
  v_cvt_pk_bf16_f32 v52, v72, v73
  v_cvt_pk_bf16_f32 v53, v74, v75
  v_cvt_pk_bf16_f32 v54, v76, v77
  v_cvt_pk_bf16_f32 v55, v78, v79
  v_mfma_f32_32x32x16_bf16 v[64:79], v[108:111], v[102:105], 0
  v_exp_f32 v80, v80
  v_exp_f32 v81, v81
  v_exp_f32 v82, v82
  v_exp_f32 v83, v83
  v_mfma_f32_32x32x8_bf16 v[64:79], v[112:113], v[106:107], v[64:79]
  s_waitcnt vmcnt(10)
  v_subrev_u32 v15, s85, v15
  v_subrev_u32 v15, 5, v15
  v_cmp_gt_u32 vcc, 3, v15
  s_nop 0
  s_cmp_eq_u64 vcc, -1
  s_cbranch_scc0 L_slow5
L_back5:
  s_add_u32 s73, s68, 0
  buffer_load_dwordx4 v[192:195], v1, s[36:39], s73 offen sc1
  v_exp_f32 v84, v84
  v_exp_f32 v85, v85
  v_exp_f32 v86, v86
  v_exp_f32 v87, v87
  v_cvt_pk_bf16_f32 v56, v80, v81
  v_cvt_pk_bf16_f32 v57, v82, v83
  v_mfma_f32_32x32x16_bf16 v[176:191], v[20:23], v[48:51], v[176:191]
  ds_read_b64 v[114:115], v120 offset:1280
  ds_read_b64 v[116:117], v120 offset:5408
  ds_read_b64 v[118:119], v121 offset:1280
  buffer_load_dwordx4 v17, s[8:11], s74 offen offset:2048 sc1 lds
  v_exp_f32 v88, v88
  v_exp_f32 v89, v89
  v_exp_f32 v90, v90
  v_exp_f32 v91, v91
  v_cvt_pk_bf16_f32 v58, v84, v85
  v_cvt_pk_bf16_f32 v59, v86, v87
  v_mfma_f32_32x32x16_bf16 v[176:191], v[24:27], v[52:55], v[176:191]
  buffer_load_dwordx4 v[196:199], v2, s[36:39], s73 offen sc1
  v_exp_f32 v92, v92
  v_exp_f32 v93, v93
  v_exp_f32 v94, v94
  v_exp_f32 v95, v95
  v_cvt_pk_bf16_f32 v60, v88, v89
  v_cvt_pk_bf16_f32 v61, v90, v91
  v_cvt_pk_bf16_f32 v62, v92, v93
  v_cvt_pk_bf16_f32 v63, v94, v95
  s_waitcnt lgkmcnt(1)
  v_mfma_f32_32x32x16_bf16 v[80:95], v[114:117], v[96:99], 0
  ds_read_b64_tr_b16 v[36:37], v122 offset:1280
  ds_read_b64_tr_b16 v[38:39], v122 offset:1344
  ds_read_b64_tr_b16 v[40:41], v122 offset:1408
  ds_read_b64_tr_b16 v[42:43], v122 offset:1472
  v_exp_f32 v64, v64
  v_exp_f32 v65, v65
  v_exp_f32 v66, v66
  v_exp_f32 v67, v67
  s_waitcnt lgkmcnt(4)
  v_mfma_f32_32x32x8_bf16 v[80:95], v[118:119], v[100:101], v[80:95]
  buffer_load_dwordx4 v[200:203], v3, s[36:39], s73 offen sc1
  v_exp_f32 v68, v68
  v_exp_f32 v69, v69
  v_exp_f32 v70, v70
  v_exp_f32 v71, v71
  v_cvt_pk_bf16_f32 v48, v64, v65
  v_cvt_pk_bf16_f32 v49, v66, v67
  v_mfma_f32_32x32x16_bf16 v[160:175], v[28:31], v[56:59], v[160:175]
  buffer_load_dwordx4 v17, s[8:11], s74 offen offset:3072 sc1 lds
  s_add_u32 m0, s83, 8192
  s_add_u32 s74, s74, 4096
  v_exp_f32 v72, v72
  v_exp_f32 v73, v73
  v_exp_f32 v74, v74
  v_exp_f32 v75, v75
  v_cvt_pk_bf16_f32 v50, v68, v69
  v_cvt_pk_bf16_f32 v51, v70, v71
  v_mfma_f32_32x32x16_bf16 v[160:175], v[32:35], v[60:63], v[160:175]
  buffer_load_dwordx4 v[204:207], v4, s[36:39], s73 offen sc1
  s_add_u32 s73, s68, 4096
  v_exp_f32 v76, v76
  v_exp_f32 v77, v77
  v_exp_f32 v78, v78
  v_exp_f32 v79, v79
  v_cvt_pk_bf16_f32 v52, v72, v73
  v_cvt_pk_bf16_f32 v53, v74, v75
  v_cvt_pk_bf16_f32 v54, v76, v77
  v_cvt_pk_bf16_f32 v55, v78, v79
  v_mfma_f32_32x32x16_bf16 v[64:79], v[114:117], v[102:105], 0
  v_exp_f32 v80, v80
  v_exp_f32 v81, v81
  v_exp_f32 v82, v82
  v_exp_f32 v83, v83
  v_mfma_f32_32x32x8_bf16 v[64:79], v[118:119], v[106:107], v[64:79]
  buffer_load_dwordx4 v[208:211], v1, s[36:39], s73 offen sc1
  v_exp_f32 v84, v84
  v_exp_f32 v85, v85
  v_exp_f32 v86, v86
  v_exp_f32 v87, v87
  v_cvt_pk_bf16_f32 v56, v80, v81
  v_cvt_pk_bf16_f32 v57, v82, v83
  v_mfma_f32_32x32x16_bf16 v[176:191], v[28:31], v[48:51], v[176:191]
  ds_read_b64 v[108:109], v120 offset:1536
  ds_read_b64 v[110:111], v120 offset:5664
  ds_read_b64 v[112:113], v121 offset:1536
  buffer_load_dwordx4 v17, s[8:11], s74 offen offset:0 sc1 lds
  v_exp_f32 v88, v88
  v_exp_f32 v89, v89
  v_exp_f32 v90, v90
  v_exp_f32 v91, v91
  v_cvt_pk_bf16_f32 v58, v84, v85
  v_cvt_pk_bf16_f32 v59, v86, v87
  v_mfma_f32_32x32x16_bf16 v[176:191], v[32:35], v[52:55], v[176:191]
  buffer_load_dwordx4 v[212:215], v2, s[36:39], s73 offen sc1
  v_exp_f32 v92, v92
  v_exp_f32 v93, v93
  v_exp_f32 v94, v94
  v_exp_f32 v95, v95
  v_cvt_pk_bf16_f32 v60, v88, v89
  v_cvt_pk_bf16_f32 v61, v90, v91
  v_cvt_pk_bf16_f32 v62, v92, v93
  v_cvt_pk_bf16_f32 v63, v94, v95
  s_waitcnt lgkmcnt(1)
  v_mfma_f32_32x32x16_bf16 v[80:95], v[108:111], v[96:99], 0
  ds_read_b64_tr_b16 v[20:21], v122 offset:1536
  ds_read_b64_tr_b16 v[22:23], v122 offset:1600
  ds_read_b64_tr_b16 v[24:25], v122 offset:1664
  ds_read_b64_tr_b16 v[26:27], v122 offset:1728
  v_exp_f32 v64, v64
  v_exp_f32 v65, v65
  v_exp_f32 v66, v66
  v_exp_f32 v67, v67
  s_waitcnt lgkmcnt(4)
  v_mfma_f32_32x32x8_bf16 v[80:95], v[112:113], v[100:101], v[80:95]
  buffer_load_dwordx4 v[216:219], v3, s[36:39], s73 offen sc1
  v_exp_f32 v68, v68
  v_exp_f32 v69, v69
  v_exp_f32 v70, v70
  v_exp_f32 v71, v71
  v_cvt_pk_bf16_f32 v48, v64, v65
  v_cvt_pk_bf16_f32 v49, v66, v67
  v_mfma_f32_32x32x16_bf16 v[160:175], v[36:39], v[56:59], v[160:175]
  buffer_load_dwordx4 v17, s[8:11], s74 offen offset:1024 sc1 lds
  v_exp_f32 v72, v72
  v_exp_f32 v73, v73
  v_exp_f32 v74, v74
  v_exp_f32 v75, v75
  v_cvt_pk_bf16_f32 v50, v68, v69
  v_cvt_pk_bf16_f32 v51, v70, v71
  v_mfma_f32_32x32x16_bf16 v[160:175], v[40:43], v[60:63], v[160:175]
  buffer_load_dwordx4 v[220:223], v4, s[36:39], s73 offen sc1
  s_add_u32 s73, s68, 16384
  v_exp_f32 v76, v76
  v_exp_f32 v77, v77
  v_exp_f32 v78, v78
  v_exp_f32 v79, v79
  v_cvt_pk_bf16_f32 v52, v72, v73
  v_cvt_pk_bf16_f32 v53, v74, v75
  v_cvt_pk_bf16_f32 v54, v76, v77
  v_cvt_pk_bf16_f32 v55, v78, v79
  v_mfma_f32_32x32x16_bf16 v[64:79], v[108:111], v[102:105], 0
  v_exp_f32 v80, v80
  v_exp_f32 v81, v81
  v_exp_f32 v82, v82
  v_exp_f32 v83, v83
  v_mfma_f32_32x32x8_bf16 v[64:79], v[112:113], v[106:107], v[64:79]
  buffer_load_dwordx4 v[224:227], v1, s[36:39], s73 offen sc1
  v_exp_f32 v84, v84
  v_exp_f32 v85, v85
  v_exp_f32 v86, v86
  v_exp_f32 v87, v87
  v_cvt_pk_bf16_f32 v56, v80, v81
  v_cvt_pk_bf16_f32 v57, v82, v83
  v_mfma_f32_32x32x16_bf16 v[176:191], v[36:39], v[48:51], v[176:191]
  ds_read_b64 v[114:115], v120 offset:1792
  ds_read_b64 v[116:117], v120 offset:5920
  ds_read_b64 v[118:119], v121 offset:1792
  buffer_load_dwordx4 v17, s[8:11], s74 offen offset:2048 sc1 lds
  v_exp_f32 v88, v88
  v_exp_f32 v89, v89
  v_exp_f32 v90, v90
  v_exp_f32 v91, v91
  v_cvt_pk_bf16_f32 v58, v84, v85
  v_cvt_pk_bf16_f32 v59, v86, v87
  v_mfma_f32_32x32x16_bf16 v[176:191], v[40:43], v[52:55], v[176:191]
  buffer_load_dwordx4 v[228:231], v2, s[36:39], s73 offen sc1
  v_exp_f32 v92, v92
  v_exp_f32 v93, v93
  v_exp_f32 v94, v94
  v_exp_f32 v95, v95
  v_cvt_pk_bf16_f32 v60, v88, v89
  v_cvt_pk_bf16_f32 v61, v90, v91
  v_cvt_pk_bf16_f32 v62, v92, v93
  v_cvt_pk_bf16_f32 v63, v94, v95
  s_waitcnt lgkmcnt(1)
  v_mfma_f32_32x32x16_bf16 v[80:95], v[114:117], v[96:99], 0
  ds_read_b64_tr_b16 v[28:29], v122 offset:1792
  ds_read_b64_tr_b16 v[30:31], v122 offset:1856
  ds_read_b64_tr_b16 v[32:33], v122 offset:1920
  ds_read_b64_tr_b16 v[34:35], v122 offset:1984
  v_exp_f32 v64, v64
  v_exp_f32 v65, v65
  v_exp_f32 v66, v66
  v_exp_f32 v67, v67
  s_waitcnt lgkmcnt(4)
  v_mfma_f32_32x32x8_bf16 v[80:95], v[118:119], v[100:101], v[80:95]
  buffer_load_dwordx4 v[232:235], v3, s[36:39], s73 offen sc1
  v_exp_f32 v68, v68
  v_exp_f32 v69, v69
  v_exp_f32 v70, v70
  v_exp_f32 v71, v71
  v_cvt_pk_bf16_f32 v48, v64, v65
  v_cvt_pk_bf16_f32 v49, v66, v67
  v_mfma_f32_32x32x16_bf16 v[160:175], v[20:23], v[56:59], v[160:175]
  buffer_load_dwordx4 v17, s[8:11], s74 offen offset:3072 sc1 lds
  s_add_u32 m0, s83, 12288
  s_add_u32 s74, s74, 4096
  v_exp_f32 v72, v72
  v_exp_f32 v73, v73
  v_exp_f32 v74, v74
  v_exp_f32 v75, v75
  v_cvt_pk_bf16_f32 v50, v68, v69
  v_cvt_pk_bf16_f32 v51, v70, v71
  v_mfma_f32_32x32x16_bf16 v[160:175], v[24:27], v[60:63], v[160:175]
  buffer_load_dwordx4 v[236:239], v4, s[36:39], s73 offen sc1
  s_add_u32 s73, s68, 20480
  v_exp_f32 v76, v76
  v_exp_f32 v77, v77
  v_exp_f32 v78, v78
  v_exp_f32 v79, v79
  v_cvt_pk_bf16_f32 v52, v72, v73
  v_cvt_pk_bf16_f32 v53, v74, v75
  v_cvt_pk_bf16_f32 v54, v76, v77
  v_cvt_pk_bf16_f32 v55, v78, v79
  v_mfma_f32_32x32x16_bf16 v[64:79], v[114:117], v[102:105], 0
  v_exp_f32 v80, v80
  v_exp_f32 v81, v81
  v_exp_f32 v82, v82
  v_exp_f32 v83, v83
  v_mfma_f32_32x32x8_bf16 v[64:79], v[118:119], v[106:107], v[64:79]
  buffer_load_dwordx4 v[240:243], v1, s[36:39], s73 offen sc1
  v_exp_f32 v84, v84
  v_exp_f32 v85, v85
  v_exp_f32 v86, v86
  v_exp_f32 v87, v87
  v_cvt_pk_bf16_f32 v56, v80, v81
  v_cvt_pk_bf16_f32 v57, v82, v83
  v_mfma_f32_32x32x16_bf16 v[176:191], v[20:23], v[48:51], v[176:191]
  ds_read_b64 v[108:109], v120 offset:2048
  ds_read_b64 v[110:111], v120 offset:6176
  ds_read_b64 v[112:113], v121 offset:2048
  buffer_load_dwordx4 v17, s[8:11], s74 offen offset:0 sc1 lds
  v_exp_f32 v88, v88
  v_exp_f32 v89, v89
  v_exp_f32 v90, v90
  v_exp_f32 v91, v91
  v_cvt_pk_bf16_f32 v58, v84, v85
  v_cvt_pk_bf16_f32 v59, v86, v87
  v_mfma_f32_32x32x16_bf16 v[176:191], v[24:27], v[52:55], v[176:191]
  buffer_load_dwordx4 v[244:247], v2, s[36:39], s73 offen sc1
  v_exp_f32 v92, v92
  v_exp_f32 v93, v93
  v_exp_f32 v94, v94
  v_exp_f32 v95, v95
  v_cvt_pk_bf16_f32 v60, v88, v89
  v_cvt_pk_bf16_f32 v61, v90, v91
  v_cvt_pk_bf16_f32 v62, v92, v93
  v_cvt_pk_bf16_f32 v63, v94, v95
  s_waitcnt lgkmcnt(1)
  v_mfma_f32_32x32x16_bf16 v[80:95], v[108:111], v[96:99], v[144:159]
  ds_read_b64_tr_b16 v[36:37], v122 offset:2048
  ds_read_b64_tr_b16 v[38:39], v122 offset:2112
  ds_read_b64_tr_b16 v[40:41], v122 offset:2176
  ds_read_b64_tr_b16 v[42:43], v122 offset:2240
  v_exp_f32 v64, v64
  v_exp_f32 v65, v65
  v_exp_f32 v66, v66
  v_exp_f32 v67, v67
  s_waitcnt lgkmcnt(4)
  v_mfma_f32_32x32x8_bf16 v[80:95], v[112:113], v[100:101], v[80:95]
  v_mov_b32 v16, v18
  s_mov_b32 s0, 196608
  buffer_load_dword v15, v16, s[12:15], s0 offen sc1
  buffer_load_dwordx4 v[248:251], v3, s[36:39], s73 offen sc1
  v_exp_f32 v68, v68
  v_exp_f32 v69, v69
  v_exp_f32 v70, v70
  v_exp_f32 v71, v71
  v_cvt_pk_bf16_f32 v48, v64, v65
  v_cvt_pk_bf16_f32 v49, v66, v67
  v_mfma_f32_32x32x16_bf16 v[160:175], v[28:31], v[56:59], v[160:175]
  buffer_load_dwordx4 v17, s[8:11], s74 offen offset:1024 sc1 lds
  v_exp_f32 v72, v72
  v_exp_f32 v73, v73
  v_exp_f32 v74, v74
  v_exp_f32 v75, v75
  v_cvt_pk_bf16_f32 v50, v68, v69
  v_cvt_pk_bf16_f32 v51, v70, v71
  v_mfma_f32_32x32x16_bf16 v[160:175], v[32:35], v[60:63], v[160:175]
  buffer_load_dwordx4 v[252:255], v4, s[36:39], s73 offen sc1
  v_exp_f32 v76, v76
  v_exp_f32 v77, v77
  v_exp_f32 v78, v78
  v_exp_f32 v79, v79
  v_cvt_pk_bf16_f32 v52, v72, v73
  v_cvt_pk_bf16_f32 v53, v74, v75
  v_cvt_pk_bf16_f32 v54, v76, v77
  v_cvt_pk_bf16_f32 v55, v78, v79
  v_mfma_f32_32x32x16_bf16 v[64:79], v[108:111], v[102:105], 0
  v_exp_f32 v80, v80
  v_exp_f32 v81, v81
  v_exp_f32 v82, v82
  v_exp_f32 v83, v83
  v_mfma_f32_32x32x8_bf16 v[64:79], v[112:113], v[106:107], v[64:79]
  buffer_load_dwordx4 v17, s[8:11], s74 offen offset:2048 sc1 lds
  v_exp_f32 v84, v84
  v_exp_f32 v85, v85
  v_exp_f32 v86, v86
  v_exp_f32 v87, v87
  v_cvt_pk_bf16_f32 v56, v80, v81
  v_cvt_pk_bf16_f32 v57, v82, v83
  v_mfma_f32_32x32x16_bf16 v[176:191], v[28:31], v[48:51], v[176:191]
  ds_read_b64 v[114:115], v120 offset:2304
  ds_read_b64 v[116:117], v120 offset:6432
  ds_read_b64 v[118:119], v121 offset:2304
  buffer_load_dwordx4 v17, s[8:11], s74 offen offset:3072 sc1 lds
  s_add_u32 m0, s83, 16384
  s_add_u32 s74, s74, 4096
  v_exp_f32 v88, v88
  v_exp_f32 v89, v89
  v_exp_f32 v90, v90
  v_exp_f32 v91, v91
  v_cvt_pk_bf16_f32 v58, v84, v85
  v_cvt_pk_bf16_f32 v59, v86, v87
  v_mfma_f32_32x32x16_bf16 v[176:191], v[32:35], v[52:55], v[176:191]
  buffer_load_dwordx4 v17, s[8:11], s74 offen offset:0 sc1 lds
  v_exp_f32 v92, v92
  v_exp_f32 v93, v93
  v_exp_f32 v94, v94
  v_exp_f32 v95, v95
  v_cvt_pk_bf16_f32 v60, v88, v89
  v_cvt_pk_bf16_f32 v61, v90, v91
  v_cvt_pk_bf16_f32 v62, v92, v93
  v_cvt_pk_bf16_f32 v63, v94, v95
  s_waitcnt lgkmcnt(1)
  v_mfma_f32_32x32x16_bf16 v[80:95], v[114:117], v[102:105], v[144:159]
  ds_read_b64_tr_b16 v[20:21], v122 offset:2304
  ds_read_b64_tr_b16 v[22:23], v122 offset:2368
  ds_read_b64_tr_b16 v[24:25], v122 offset:2432
  ds_read_b64_tr_b16 v[26:27], v122 offset:2496
  v_exp_f32 v64, v64
  v_exp_f32 v65, v65
  v_exp_f32 v66, v66
  v_exp_f32 v67, v67
  s_waitcnt lgkmcnt(4)
  v_mfma_f32_32x32x8_bf16 v[80:95], v[118:119], v[106:107], v[80:95]
  buffer_load_dwordx4 v17, s[8:11], s74 offen offset:1024 sc1 lds
  v_exp_f32 v68, v68
  v_exp_f32 v69, v69
  v_exp_f32 v70, v70
  v_exp_f32 v71, v71
  v_cvt_pk_bf16_f32 v48, v64, v65
  v_cvt_pk_bf16_f32 v49, v66, v67
  v_mfma_f32_32x32x16_bf16 v[160:175], v[36:39], v[56:59], v[160:175]
  buffer_load_dwordx4 v17, s[8:11], s74 offen offset:2048 sc1 lds
  v_exp_f32 v72, v72
  v_exp_f32 v73, v73
  v_exp_f32 v74, v74
  v_exp_f32 v75, v75
  v_cvt_pk_bf16_f32 v50, v68, v69
  v_cvt_pk_bf16_f32 v51, v70, v71
  v_mfma_f32_32x32x16_bf16 v[160:175], v[40:43], v[60:63], v[160:175]
  buffer_load_dwordx4 v17, s[8:11], s74 offen offset:3072 sc1 lds
  s_add_u32 m0, s83, 20480
  s_add_u32 s74, s74, 4096
  v_exp_f32 v76, v76
  v_exp_f32 v77, v77
  v_exp_f32 v78, v78
  v_exp_f32 v79, v79
  v_cvt_pk_bf16_f32 v52, v72, v73
  v_cvt_pk_bf16_f32 v53, v74, v75
  v_cvt_pk_bf16_f32 v54, v76, v77
  v_cvt_pk_bf16_f32 v55, v78, v79
  v_exp_f32 v80, v80
  v_exp_f32 v81, v81
  v_exp_f32 v82, v82
  v_exp_f32 v83, v83
  buffer_load_dwordx4 v17, s[8:11], s74 offen offset:0 sc1 lds
  v_exp_f32 v84, v84
  v_exp_f32 v85, v85
  v_exp_f32 v86, v86
  v_exp_f32 v87, v87
  v_cvt_pk_bf16_f32 v56, v80, v81
  v_cvt_pk_bf16_f32 v57, v82, v83
  v_mfma_f32_32x32x16_bf16 v[176:191], v[36:39], v[48:51], v[176:191]
  buffer_load_dwordx4 v17, s[8:11], s74 offen offset:1024 sc1 lds
  v_exp_f32 v88, v88
  v_exp_f32 v89, v89
  v_exp_f32 v90, v90
  v_exp_f32 v91, v91
  v_cvt_pk_bf16_f32 v58, v84, v85
  v_cvt_pk_bf16_f32 v59, v86, v87
  v_mfma_f32_32x32x16_bf16 v[176:191], v[40:43], v[52:55], v[176:191]
  buffer_load_dwordx4 v17, s[8:11], s74 offen offset:2048 sc1 lds
  v_exp_f32 v92, v92
  v_exp_f32 v93, v93
  v_exp_f32 v94, v94
  v_exp_f32 v95, v95
  v_cvt_pk_bf16_f32 v60, v88, v89
  v_cvt_pk_bf16_f32 v61, v90, v91
  v_cvt_pk_bf16_f32 v62, v92, v93
  v_cvt_pk_bf16_f32 v63, v94, v95
  s_waitcnt lgkmcnt(2)
  v_mfma_f32_32x32x16_bf16 v[176:191], v[20:23], v[56:59], v[176:191]
  s_waitcnt lgkmcnt(0)
  v_mfma_f32_32x32x16_bf16 v[176:191], v[24:27], v[60:63], v[176:191]
  s_mov_b32 s58, 0x30800000
  s_mov_b32 s59, 0x4e800000
  v_pk_mul_f32 v[48:49], v[160:161], 0 op_sel_hi:[1,0]
  s_nop 8
  v_pk_mul_f32 v[50:51], v[176:177], 0 op_sel_hi:[1,0]
  v_pk_fma_f32 v[48:49], v[162:163], 0, v[48:49] op_sel_hi:[1,0,1]
  v_pk_fma_f32 v[50:51], v[178:179], 0, v[50:51] op_sel_hi:[1,0,1]
  v_pk_fma_f32 v[48:49], v[164:165], 0, v[48:49] op_sel_hi:[1,0,1]
  v_pk_fma_f32 v[50:51], v[180:181], 0, v[50:51] op_sel_hi:[1,0,1]
  v_pk_fma_f32 v[48:49], v[166:167], 0, v[48:49] op_sel_hi:[1,0,1]
  v_pk_fma_f32 v[50:51], v[182:183], 0, v[50:51] op_sel_hi:[1,0,1]
  v_pk_fma_f32 v[48:49], v[168:169], 0, v[48:49] op_sel_hi:[1,0,1]
  v_pk_fma_f32 v[50:51], v[184:185], 0, v[50:51] op_sel_hi:[1,0,1]
  v_pk_fma_f32 v[48:49], v[170:171], 0, v[48:49] op_sel_hi:[1,0,1]
  v_pk_fma_f32 v[50:51], v[186:187], 0, v[50:51] op_sel_hi:[1,0,1]
  v_add_f32 v44, v48, v173
  v_add_f32 v45, v50, v189
  v_add_f32 v44, v49, v44
  v_add_f32 v45, v51, v45
  v_cmp_le_f32 s[78:79], s58, v44
  v_cmp_ge_f32 s[80:81], s59, v44
  v_cmp_le_f32 s[40:41], s58, v45
  v_cmp_ge_f32 s[42:43], s59, v45
  s_and_b64 s[78:79], s[78:79], s[80:81]
  s_and_b64 s[40:41], s[40:41], s[42:43]
  s_and_b64 s[78:79], s[78:79], s[40:41]
  s_cmp_eq_u64 s[78:79], -1
  s_cbranch_scc0 L_fallback
L_fin:
  v_rcp_f32 v44, v173
  v_rcp_f32 v45, v189
  s_nop 0
  v_pk_mul_f32 v[160:161], v[160:161], v[44:45] op_sel:[0,0] op_sel_hi:[1,0]
  v_pk_mul_f32 v[162:163], v[162:163], v[44:45] op_sel:[0,0] op_sel_hi:[1,0]
  v_pk_mul_f32 v[164:165], v[164:165], v[44:45] op_sel:[0,0] op_sel_hi:[1,0]
  v_pk_mul_f32 v[166:167], v[166:167], v[44:45] op_sel:[0,0] op_sel_hi:[1,0]
  v_pk_mul_f32 v[168:169], v[168:169], v[44:45] op_sel:[0,0] op_sel_hi:[1,0]
  v_pk_mul_f32 v[170:171], v[170:171], v[44:45] op_sel:[0,0] op_sel_hi:[1,0]
  v_cvt_pk_bf16_f32 v160, v160, v161
  v_cvt_pk_bf16_f32 v161, v162, v163
  v_cvt_pk_bf16_f32 v162, v164, v165
  v_cvt_pk_bf16_f32 v163, v166, v167
  v_cvt_pk_bf16_f32 v164, v168, v169
  v_cvt_pk_bf16_f32 v165, v170, v171
  buffer_store_dwordx4 v[160:163], v123, s[36:39], s65 offen offset:0 sc1
  v_pk_mul_f32 v[176:177], v[176:177], v[44:45] op_sel:[0,1] op_sel_hi:[1,1]
  v_pk_mul_f32 v[178:179], v[178:179], v[44:45] op_sel:[0,1] op_sel_hi:[1,1]
  v_pk_mul_f32 v[180:181], v[180:181], v[44:45] op_sel:[0,1] op_sel_hi:[1,1]
  v_pk_mul_f32 v[182:183], v[182:183], v[44:45] op_sel:[0,1] op_sel_hi:[1,1]
  v_pk_mul_f32 v[184:185], v[184:185], v[44:45] op_sel:[0,1] op_sel_hi:[1,1]
  v_pk_mul_f32 v[186:187], v[186:187], v[44:45] op_sel:[0,1] op_sel_hi:[1,1]
  v_cvt_pk_bf16_f32 v176, v176, v177
  v_cvt_pk_bf16_f32 v177, v178, v179
  v_cvt_pk_bf16_f32 v178, v180, v181
  v_cvt_pk_bf16_f32 v179, v182, v183
  v_cvt_pk_bf16_f32 v180, v184, v185
  v_cvt_pk_bf16_f32 v181, v186, v187
  buffer_store_dwordx4 v[176:179], v123, s[36:39], s65 offen offset:512 sc1
  s_mov_b32 exec_hi, 0
  buffer_store_dwordx2 v[164:165], v127, s[36:39], s66 offen offset:0 sc1
  buffer_store_dwordx2 v[180:181], v127, s[36:39], s66 offen offset:256 sc1
  s_mov_b32 exec_hi, -1
  s_mov_b32 s20, s92
  s_mov_b32 s21, s93
  s_mov_b32 s22, 0x280000
  s_mov_b32 s23, 0x20000
  s_waitcnt vmcnt(37)
  v_mfma_f32_16x16x32_bf16 v[64:67], a[0:3], v[192:195], 0
  buffer_load_dwordx4 v17, s[8:11], s74 offen offset:3072 sc1 lds
  s_add_u32 m0, s83, 24576
  s_add_u32 s74, s74, 4096
  s_waitcnt vmcnt(36)
  v_mfma_f32_16x16x32_bf16 v[84:87], a[0:3], v[196:199], 0
  v_and_b32 v36, 0x3ff, v1
  v_lshrrev_b32 v36, 1, v36
  s_waitcnt vmcnt(35)
  v_mfma_f32_16x16x32_bf16 v[104:107], a[0:3], v[200:203], 0
  v_sub_u32 v10, v1, v36
  v_and_b32 v18, 15, v14
  s_waitcnt vmcnt(33)
  v_mfma_f32_16x16x32_bf16 v[124:127], a[0:3], v[204:207], 0
  v_lshrrev_b32 v36, 4, v14
  v_lshl_add_u32 v18, v18, 2, v36
  v_mfma_f32_16x16x32_bf16 v[128:131], a[4:7], v[204:207], 0
  buffer_load_dwordx4 v17, s[8:11], s74 offen offset:0 sc1 lds
  v_mfma_f32_16x16x32_bf16 v[108:111], a[4:7], v[200:203], 0
  v_lshlrev_b32 v18, 2, v18
  v_and_b32 v19, 3, v14
  v_mfma_f32_16x16x32_bf16 v[88:91], a[4:7], v[196:199], 0
  v_lshrrev_b32 v36, 2, v14
  v_lshl_add_u32 v19, v19, 4, v36
  v_mfma_f32_16x16x32_bf16 v[68:71], a[4:7], v[192:195], 0
  v_lshlrev_b32 v19, 2, v19
  v_mfma_f32_16x16x32_bf16 v[72:75], a[8:11], v[192:195], 0
  v_mfma_f32_16x16x32_bf16 v[92:95], a[8:11], v[196:199], 0
  v_mfma_f32_16x16x32_bf16 v[112:115], a[8:11], v[200:203], 0
  v_mfma_f32_16x16x32_bf16 v[132:135], a[8:11], v[204:207], 0
  v_mfma_f32_16x16x32_bf16 v[136:139], a[12:15], v[204:207], 0
  v_mfma_f32_16x16x32_bf16 v[116:119], a[12:15], v[200:203], 0
  v_mfma_f32_16x16x32_bf16 v[96:99], a[12:15], v[196:199], 0
  v_mfma_f32_16x16x32_bf16 v[76:79], a[12:15], v[192:195], 0
L_pad9:
  s_cbranch_execz L_padret
  v_mfma_f32_16x16x32_bf16 v[80:83], a[16:19], v[192:195], 0
  v_mfma_f32_16x16x32_bf16 v[100:103], a[16:19], v[196:199], 0
  v_mfma_f32_16x16x32_bf16 v[120:123], a[16:19], v[200:203], 0
  v_mfma_f32_16x16x32_bf16 v[140:143], a[16:19], v[204:207], 0
  s_waitcnt vmcnt(18)
  v_subrev_u32 v15, s85, v15
  v_subrev_u32 v15, 6, v15
  v_cmp_gt_u32 vcc, 2, v15
  s_nop 0
  s_cmp_eq_u64 vcc, -1
  s_cbranch_scc0 L_slow6
L_back6:
  v_mfma_f32_16x16x32_bf16 v[64:67], a[20:23], v[208:211], v[64:67]
  s_add_u32 s73, s68, 8192
  buffer_load_dwordx4 v[192:195], v1, s[36:39], s73 offen sc1
  v_mfma_f32_16x16x32_bf16 v[84:87], a[20:23], v[212:215], v[84:87]
  v_bfe_u32 v36, v14, 1, 3
  v_lshrrev_b32 v37, 4, v14
  v_mfma_f32_16x16x32_bf16 v[104:107], a[20:23], v[216:219], v[104:107]
  v_lshl_add_u32 v36, v36, 3, v37
  v_lshlrev_b32 v36, 7, v36
  v_mfma_f32_16x16x32_bf16 v[124:127], a[20:23], v[220:223], v[124:127]
  v_add_u32 v16, s77, v36
  v_mfma_f32_16x16x32_bf16 v[128:131], a[24:27], v[220:223], v[128:131]
  buffer_load_dwordx4 v[196:199], v2, s[36:39], s73 offen sc1
  v_mfma_f32_16x16x32_bf16 v[108:111], a[24:27], v[216:219], v[108:111]
  v_mfma_f32_16x16x32_bf16 v[88:91], a[24:27], v[212:215], v[88:91]
  v_mfma_f32_16x16x32_bf16 v[68:71], a[24:27], v[208:211], v[68:71]
  v_mfma_f32_16x16x32_bf16 v[72:75], a[28:31], v[208:211], v[72:75]
  buffer_load_dwordx4 v[200:203], v3, s[36:39], s73 offen sc1
  v_mfma_f32_16x16x32_bf16 v[92:95], a[28:31], v[212:215], v[92:95]
  v_mfma_f32_16x16x32_bf16 v[112:115], a[28:31], v[216:219], v[112:115]
  v_mfma_f32_16x16x32_bf16 v[132:135], a[28:31], v[220:223], v[132:135]
  v_mfma_f32_16x16x32_bf16 v[136:139], a[32:35], v[220:223], v[136:139]
  buffer_load_dwordx4 v[204:207], v4, s[36:39], s73 offen sc1
  v_mfma_f32_16x16x32_bf16 v[116:119], a[32:35], v[216:219], v[116:119]
  v_mfma_f32_16x16x32_bf16 v[96:99], a[32:35], v[212:215], v[96:99]
  v_mfma_f32_16x16x32_bf16 v[76:79], a[32:35], v[208:211], v[76:79]
  v_mfma_f32_16x16x32_bf16 v[80:83], a[36:39], v[208:211], v[80:83]
  v_mfma_f32_16x16x32_bf16 v[100:103], a[36:39], v[212:215], v[100:103]
  v_mfma_f32_16x16x32_bf16 v[120:123], a[36:39], v[216:219], v[120:123]
  v_mfma_f32_16x16x32_bf16 v[140:143], a[36:39], v[220:223], v[140:143]
  v_mfma_f32_16x16x32_bf16 v[64:67], a[40:43], v[224:227], v[64:67]
  s_add_u32 s73, s68, 12288
  buffer_load_dwordx4 v[208:211], v1, s[36:39], s73 offen sc1
  v_mfma_f32_16x16x32_bf16 v[84:87], a[40:43], v[228:231], v[84:87]
  v_mfma_f32_16x16x32_bf16 v[104:107], a[40:43], v[232:235], v[104:107]
  v_mfma_f32_16x16x32_bf16 v[124:127], a[40:43], v[236:239], v[124:127]
  v_mfma_f32_16x16x32_bf16 v[128:131], a[44:47], v[236:239], v[128:131]
  buffer_load_dwordx4 v[212:215], v2, s[36:39], s73 offen sc1
  v_mfma_f32_16x16x32_bf16 v[108:111], a[44:47], v[232:235], v[108:111]
  v_mfma_f32_16x16x32_bf16 v[88:91], a[44:47], v[228:231], v[88:91]
  v_mfma_f32_16x16x32_bf16 v[68:71], a[44:47], v[224:227], v[68:71]
  v_mfma_f32_16x16x32_bf16 v[72:75], a[48:51], v[224:227], v[72:75]
  buffer_load_dwordx4 v[216:219], v3, s[36:39], s73 offen sc1
  v_mfma_f32_16x16x32_bf16 v[92:95], a[48:51], v[228:231], v[92:95]
  v_mfma_f32_16x16x32_bf16 v[112:115], a[48:51], v[232:235], v[112:115]
  v_mfma_f32_16x16x32_bf16 v[132:135], a[48:51], v[236:239], v[132:135]
  v_mfma_f32_16x16x32_bf16 v[136:139], a[52:55], v[236:239], v[136:139]
  buffer_load_dwordx4 v[220:223], v4, s[36:39], s73 offen sc1
  v_mfma_f32_16x16x32_bf16 v[116:119], a[52:55], v[232:235], v[116:119]
  v_mfma_f32_16x16x32_bf16 v[96:99], a[52:55], v[228:231], v[96:99]
  v_mfma_f32_16x16x32_bf16 v[76:79], a[52:55], v[224:227], v[76:79]
  v_mfma_f32_16x16x32_bf16 v[80:83], a[56:59], v[224:227], v[80:83]
  v_mfma_f32_16x16x32_bf16 v[100:103], a[56:59], v[228:231], v[100:103]
  v_mfma_f32_16x16x32_bf16 v[120:123], a[56:59], v[232:235], v[120:123]
  v_mfma_f32_16x16x32_bf16 v[140:143], a[56:59], v[236:239], v[140:143]
  s_waitcnt vmcnt(10)
  s_add_u32 s60, s85, 7
  s_mov_b32 s1, 327680
  v_mov_b32 v44, s60
  buffer_store_dword v44, v13, s[12:15], s1 offen sc1
  v_mfma_f32_16x16x32_bf16 v[64:67], a[60:63], v[240:243], v[64:67]
  s_add_u32 s73, s68, 24576
  buffer_load_dwordx4 v[224:227], v1, s[36:39], s73 offen sc1
  v_mfma_f32_16x16x32_bf16 v[84:87], a[60:63], v[244:247], v[84:87]
  v_mfma_f32_16x16x32_bf16 v[104:107], a[60:63], v[248:251], v[104:107]
  v_mfma_f32_16x16x32_bf16 v[124:127], a[60:63], v[252:255], v[124:127]
  v_mfma_f32_16x16x32_bf16 v[128:131], a[64:67], v[252:255], v[128:131]
  buffer_load_dwordx4 v[228:231], v2, s[36:39], s73 offen sc1
  v_mfma_f32_16x16x32_bf16 v[108:111], a[64:67], v[248:251], v[108:111]
  v_mfma_f32_16x16x32_bf16 v[88:91], a[64:67], v[244:247], v[88:91]
  v_mfma_f32_16x16x32_bf16 v[68:71], a[64:67], v[240:243], v[68:71]
  v_mfma_f32_16x16x32_bf16 v[72:75], a[68:71], v[240:243], v[72:75]
  buffer_load_dwordx4 v[232:235], v3, s[36:39], s73 offen sc1
  v_mfma_f32_16x16x32_bf16 v[92:95], a[68:71], v[244:247], v[92:95]
  v_mfma_f32_16x16x32_bf16 v[112:115], a[68:71], v[248:251], v[112:115]
  v_mfma_f32_16x16x32_bf16 v[132:135], a[68:71], v[252:255], v[132:135]
  v_mfma_f32_16x16x32_bf16 v[136:139], a[72:75], v[252:255], v[136:139]
  buffer_load_dwordx4 v[236:239], v4, s[36:39], s73 offen sc1
  v_mfma_f32_16x16x32_bf16 v[116:119], a[72:75], v[248:251], v[116:119]
  v_mfma_f32_16x16x32_bf16 v[96:99], a[72:75], v[244:247], v[96:99]
  v_mfma_f32_16x16x32_bf16 v[76:79], a[72:75], v[240:243], v[76:79]
  v_mfma_f32_16x16x32_bf16 v[80:83], a[76:79], v[240:243], v[80:83]
  v_mfma_f32_16x16x32_bf16 v[100:103], a[76:79], v[244:247], v[100:103]
  v_mfma_f32_16x16x32_bf16 v[120:123], a[76:79], v[248:251], v[120:123]
  v_mfma_f32_16x16x32_bf16 v[140:143], a[76:79], v[252:255], v[140:143]
  s_waitcnt vmcnt(12)
  v_mfma_f32_16x16x32_bf16 v[64:67], a[80:83], v[192:195], v[64:67]
  s_add_u32 s73, s68, 28672
  buffer_load_dwordx4 v[240:243], v1, s[36:39], s73 offen sc1
  s_waitcnt vmcnt(12)
  v_mfma_f32_16x16x32_bf16 v[84:87], a[80:83], v[196:199], v[84:87]
  s_waitcnt vmcnt(11)
  v_mfma_f32_16x16x32_bf16 v[104:107], a[80:83], v[200:203], v[104:107]
  s_waitcnt vmcnt(10)
  v_mfma_f32_16x16x32_bf16 v[124:127], a[80:83], v[204:207], v[124:127]
  v_mfma_f32_16x16x32_bf16 v[128:131], a[84:87], v[204:207], v[128:131]
  buffer_load_dwordx4 v[244:247], v2, s[36:39], s73 offen sc1
  v_mfma_f32_16x16x32_bf16 v[108:111], a[84:87], v[200:203], v[108:111]
  v_mfma_f32_16x16x32_bf16 v[88:91], a[84:87], v[196:199], v[88:91]
  v_mfma_f32_16x16x32_bf16 v[68:71], a[84:87], v[192:195], v[68:71]
  v_mfma_f32_16x16x32_bf16 v[72:75], a[88:91], v[192:195], v[72:75]
  buffer_load_dwordx4 v[248:251], v3, s[36:39], s73 offen sc1
  v_mfma_f32_16x16x32_bf16 v[92:95], a[88:91], v[196:199], v[92:95]
  v_mfma_f32_16x16x32_bf16 v[112:115], a[88:91], v[200:203], v[112:115]
  v_mfma_f32_16x16x32_bf16 v[132:135], a[88:91], v[204:207], v[132:135]
  v_mfma_f32_16x16x32_bf16 v[136:139], a[92:95], v[204:207], v[136:139]
  buffer_load_dwordx4 v[252:255], v4, s[36:39], s73 offen sc1
  v_mfma_f32_16x16x32_bf16 v[116:119], a[92:95], v[200:203], v[116:119]
  v_mfma_f32_16x16x32_bf16 v[96:99], a[92:95], v[196:199], v[96:99]
  v_mfma_f32_16x16x32_bf16 v[76:79], a[92:95], v[192:195], v[76:79]
  v_mfma_f32_16x16x32_bf16 v[80:83], a[96:99], v[192:195], v[80:83]
  v_mfma_f32_16x16x32_bf16 v[100:103], a[96:99], v[196:199], v[100:103]
  v_mfma_f32_16x16x32_bf16 v[120:123], a[96:99], v[200:203], v[120:123]
  v_mfma_f32_16x16x32_bf16 v[140:143], a[96:99], v[204:207], v[140:143]
  s_barrier
  s_waitcnt vmcnt(12)
  v_mfma_f32_16x16x32_bf16 v[64:67], a[100:103], v[208:211], v[64:67]
  s_add_u32 s73, s68, 32768
  buffer_load_dwordx4 v[192:195], v1, s[36:39], s73 offen sc1
  s_waitcnt vmcnt(12)
  v_mfma_f32_16x16x32_bf16 v[84:87], a[100:103], v[212:215], v[84:87]
  ds_read_b128 a[240:243], v11 offset:0
  s_waitcnt vmcnt(11)
  v_mfma_f32_16x16x32_bf16 v[104:107], a[100:103], v[216:219], v[104:107]
  ds_read_b128 a[244:247], v11 offset:1024
  s_waitcnt vmcnt(10)
  v_mfma_f32_16x16x32_bf16 v[124:127], a[100:103], v[220:223], v[124:127]
  ds_read_b128 a[248:251], v11 offset:2048
  v_mfma_f32_16x16x32_bf16 v[128:131], a[104:107], v[220:223], v[128:131]
  buffer_load_dwordx4 v[196:199], v2, s[36:39], s73 offen sc1
  v_mfma_f32_16x16x32_bf16 v[108:111], a[104:107], v[216:219], v[108:111]
  ds_read_b128 a[252:255], v11 offset:3072
  v_mfma_f32_16x16x32_bf16 v[88:91], a[104:107], v[212:215], v[88:91]
  ds_read_b128 a[0:3], v11 offset:4096
  v_mfma_f32_16x16x32_bf16 v[68:71], a[104:107], v[208:211], v[68:71]
  ds_read_b128 a[4:7], v11 offset:5120
  v_mfma_f32_16x16x32_bf16 v[72:75], a[108:111], v[208:211], v[72:75]
  buffer_load_dwordx4 v[200:203], v3, s[36:39], s73 offen sc1
  v_mfma_f32_16x16x32_bf16 v[92:95], a[108:111], v[212:215], v[92:95]
  ds_read_b128 a[8:11], v11 offset:6144
  v_mfma_f32_16x16x32_bf16 v[112:115], a[108:111], v[216:219], v[112:115]
  ds_read_b128 a[12:15], v11 offset:7168
  v_mfma_f32_16x16x32_bf16 v[132:135], a[108:111], v[220:223], v[132:135]
  ds_read_b128 a[16:19], v11 offset:8192
  v_mfma_f32_16x16x32_bf16 v[136:139], a[112:115], v[220:223], v[136:139]
  buffer_load_dwordx4 v[204:207], v4, s[36:39], s73 offen sc1
  v_mfma_f32_16x16x32_bf16 v[116:119], a[112:115], v[216:219], v[116:119]
  ds_read_b128 a[20:23], v11 offset:9216
  v_mfma_f32_16x16x32_bf16 v[96:99], a[112:115], v[212:215], v[96:99]
  ds_read_b128 a[24:27], v11 offset:10240
  v_mfma_f32_16x16x32_bf16 v[76:79], a[112:115], v[208:211], v[76:79]
  ds_read_b128 a[28:31], v11 offset:11264
  v_mfma_f32_16x16x32_bf16 v[80:83], a[116:119], v[208:211], v[80:83]
  buffer_load_dwordx2 v[144:145], v5, s[16:19], s70 offen offset:0
  v_mfma_f32_16x16x32_bf16 v[100:103], a[116:119], v[212:215], v[100:103]
  ds_read_b128 a[32:35], v11 offset:12288
  v_mfma_f32_16x16x32_bf16 v[120:123], a[116:119], v[216:219], v[120:123]
  ds_read_b128 a[36:39], v11 offset:13312
  v_mfma_f32_16x16x32_bf16 v[140:143], a[116:119], v[220:223], v[140:143]
  ds_read_b128 a[40:43], v11 offset:14336
  buffer_load_dwordx2 v[146:147], v5, s[16:19], s70 offen offset:32
  buffer_load_dwordx2 v[148:149], v5, s[16:19], s70 offen offset:64
  buffer_load_dwordx2 v[150:151], v5, s[16:19], s70 offen offset:96
  buffer_load_dwordx2 v[152:153], v5, s[16:19], s70 offen offset:128
  s_waitcnt vmcnt(16)
  v_mfma_f32_16x16x32_bf16 v[64:67], a[120:123], v[224:227], v[64:67]
  s_add_u32 s73, s68, 36864
  buffer_load_dwordx4 v[208:211], v1, s[36:39], s73 offen sc1
  s_waitcnt vmcnt(16)
  v_mfma_f32_16x16x32_bf16 v[84:87], a[120:123], v[228:231], v[84:87]
  ds_read_b128 a[44:47], v11 offset:15360
  s_waitcnt vmcnt(15)
  v_mfma_f32_16x16x32_bf16 v[104:107], a[120:123], v[232:235], v[104:107]
  ds_read_b128 a[48:51], v11 offset:16384
  s_waitcnt vmcnt(14)
  v_mfma_f32_16x16x32_bf16 v[124:127], a[120:123], v[236:239], v[124:127]
  ds_read_b128 a[52:55], v11 offset:17408
  v_mfma_f32_16x16x32_bf16 v[128:131], a[124:127], v[236:239], v[128:131]
  buffer_load_dwordx4 v[212:215], v2, s[36:39], s73 offen sc1
  v_mfma_f32_16x16x32_bf16 v[108:111], a[124:127], v[232:235], v[108:111]
  ds_read_b128 a[56:59], v11 offset:18432
  v_mfma_f32_16x16x32_bf16 v[88:91], a[124:127], v[228:231], v[88:91]
  ds_read_b128 a[60:63], v11 offset:19456
  v_mfma_f32_16x16x32_bf16 v[68:71], a[124:127], v[224:227], v[68:71]
  ds_read_b128 a[64:67], v11 offset:20480
  v_mfma_f32_16x16x32_bf16 v[72:75], a[128:131], v[224:227], v[72:75]
  buffer_load_dwordx4 v[216:219], v3, s[36:39], s73 offen sc1
  v_mfma_f32_16x16x32_bf16 v[92:95], a[128:131], v[228:231], v[92:95]
  ds_read_b128 a[68:71], v11 offset:21504
  v_mfma_f32_16x16x32_bf16 v[112:115], a[128:131], v[232:235], v[112:115]
  ds_read_b128 a[72:75], v11 offset:22528
  v_mfma_f32_16x16x32_bf16 v[132:135], a[128:131], v[236:239], v[132:135]
  ds_read_b128 a[76:79], v11 offset:23552
  v_mfma_f32_16x16x32_bf16 v[136:139], a[132:135], v[236:239], v[136:139]
  buffer_load_dwordx4 v[220:223], v4, s[36:39], s73 offen sc1
  v_mfma_f32_16x16x32_bf16 v[116:119], a[132:135], v[232:235], v[116:119]
  ds_read_b128 a[80:83], v11 offset:24576
  v_mfma_f32_16x16x32_bf16 v[96:99], a[132:135], v[228:231], v[96:99]
  ds_read_b128 a[84:87], v11 offset:25600
  v_mfma_f32_16x16x32_bf16 v[76:79], a[132:135], v[224:227], v[76:79]
  ds_read_b128 a[88:91], v11 offset:26624
  v_mfma_f32_16x16x32_bf16 v[80:83], a[136:139], v[224:227], v[80:83]
  v_mfma_f32_16x16x32_bf16 v[100:103], a[136:139], v[228:231], v[100:103]
  ds_read_b128 a[92:95], v11 offset:27648
  v_mfma_f32_16x16x32_bf16 v[120:123], a[136:139], v[232:235], v[120:123]
  ds_read_b128 a[96:99], v11 offset:28672
  v_mfma_f32_16x16x32_bf16 v[140:143], a[136:139], v[236:239], v[140:143]
  ds_read_b128 a[100:103], v11 offset:29696
  s_waitcnt vmcnt(16)
  v_mfma_f32_16x16x32_bf16 v[64:67], a[140:143], v[240:243], v[64:67]
  s_add_u32 s73, s68, 40960
  buffer_load_dwordx4 v[224:227], v1, s[36:39], s73 offen sc1
  s_waitcnt vmcnt(16)
  v_mfma_f32_16x16x32_bf16 v[84:87], a[140:143], v[244:247], v[84:87]
  ds_read_b128 a[104:107], v11 offset:30720
  s_waitcnt vmcnt(15)
  v_mfma_f32_16x16x32_bf16 v[104:107], a[140:143], v[248:251], v[104:107]
  ds_read_b128 a[108:111], v11 offset:31744
  s_waitcnt vmcnt(14)
  v_mfma_f32_16x16x32_bf16 v[124:127], a[140:143], v[252:255], v[124:127]
  ds_read_b128 a[112:115], v11 offset:32768
  v_mfma_f32_16x16x32_bf16 v[128:131], a[144:147], v[252:255], v[128:131]
  buffer_load_dwordx4 v[228:231], v2, s[36:39], s73 offen sc1
  v_mfma_f32_16x16x32_bf16 v[108:111], a[144:147], v[248:251], v[108:111]
  ds_read_b128 a[116:119], v11 offset:33792
  v_mfma_f32_16x16x32_bf16 v[88:91], a[144:147], v[244:247], v[88:91]
  ds_read_b128 a[120:123], v11 offset:34816
  v_mfma_f32_16x16x32_bf16 v[68:71], a[144:147], v[240:243], v[68:71]
  ds_read_b128 a[124:127], v11 offset:35840
  v_mfma_f32_16x16x32_bf16 v[72:75], a[148:151], v[240:243], v[72:75]
  buffer_load_dwordx4 v[232:235], v3, s[36:39], s73 offen sc1
  v_mfma_f32_16x16x32_bf16 v[92:95], a[148:151], v[244:247], v[92:95]
  ds_read_b128 a[128:131], v11 offset:36864
  v_mfma_f32_16x16x32_bf16 v[112:115], a[148:151], v[248:251], v[112:115]
  ds_read_b128 a[132:135], v11 offset:37888
  v_mfma_f32_16x16x32_bf16 v[132:135], a[148:151], v[252:255], v[132:135]
  ds_read_b128 a[136:139], v11 offset:38912
  v_mfma_f32_16x16x32_bf16 v[136:139], a[152:155], v[252:255], v[136:139]
  buffer_load_dwordx4 v[236:239], v4, s[36:39], s73 offen sc1
  v_mfma_f32_16x16x32_bf16 v[116:119], a[152:155], v[248:251], v[116:119]
  v_mfma_f32_16x16x32_bf16 v[96:99], a[152:155], v[244:247], v[96:99]
  v_mfma_f32_16x16x32_bf16 v[76:79], a[152:155], v[240:243], v[76:79]
  v_mfma_f32_16x16x32_bf16 v[80:83], a[156:159], v[240:243], v[80:83]
  v_mfma_f32_16x16x32_bf16 v[100:103], a[156:159], v[244:247], v[100:103]
  v_mfma_f32_16x16x32_bf16 v[120:123], a[156:159], v[248:251], v[120:123]
  v_mfma_f32_16x16x32_bf16 v[140:143], a[156:159], v[252:255], v[140:143]
  s_waitcnt vmcnt(16)
  v_mfma_f32_16x16x32_bf16 v[64:67], a[160:163], v[192:195], v[64:67]
  s_add_u32 s73, s68, 45056
  buffer_load_dwordx4 v[240:243], v1, s[36:39], s73 offen sc1
  s_waitcnt vmcnt(16)
  v_mfma_f32_16x16x32_bf16 v[84:87], a[160:163], v[196:199], v[84:87]
  ds_read_b128 a[140:143], v11 offset:39936
  s_waitcnt vmcnt(15)
  v_mfma_f32_16x16x32_bf16 v[104:107], a[160:163], v[200:203], v[104:107]
  ds_read_b128 a[144:147], v11 offset:40960
  s_waitcnt vmcnt(14)
  v_mfma_f32_16x16x32_bf16 v[124:127], a[160:163], v[204:207], v[124:127]
  ds_read_b128 a[148:151], v11 offset:41984
  v_mfma_f32_16x16x32_bf16 v[128:131], a[164:167], v[204:207], v[128:131]
  buffer_load_dwordx4 v[244:247], v2, s[36:39], s73 offen sc1
  v_mfma_f32_16x16x32_bf16 v[108:111], a[164:167], v[200:203], v[108:111]
  s_waitcnt vmcnt(14)
  ds_bpermute_b32 v144, v18, v144
  v_mfma_f32_16x16x32_bf16 v[88:91], a[164:167], v[196:199], v[88:91]
  ds_bpermute_b32 v145, v18, v145
  v_mfma_f32_16x16x32_bf16 v[68:71], a[164:167], v[192:195], v[68:71]
  s_waitcnt vmcnt(13)
  ds_bpermute_b32 v146, v18, v146
  v_mfma_f32_16x16x32_bf16 v[72:75], a[168:171], v[192:195], v[72:75]
  buffer_load_dwordx4 v[248:251], v3, s[36:39], s73 offen sc1
  v_mfma_f32_16x16x32_bf16 v[92:95], a[168:171], v[196:199], v[92:95]
  ds_bpermute_b32 v147, v18, v147
  v_mfma_f32_16x16x32_bf16 v[112:115], a[168:171], v[200:203], v[112:115]
  s_waitcnt vmcnt(13)
  ds_bpermute_b32 v148, v18, v148
  v_mfma_f32_16x16x32_bf16 v[132:135], a[168:171], v[204:207], v[132:135]
  ds_bpermute_b32 v149, v18, v149
  v_mfma_f32_16x16x32_bf16 v[136:139], a[172:175], v[204:207], v[136:139]
  buffer_load_dwordx4 v[252:255], v4, s[36:39], s73 offen sc1
  v_mfma_f32_16x16x32_bf16 v[116:119], a[172:175], v[200:203], v[116:119]
  s_waitcnt vmcnt(13)
  ds_bpermute_b32 v150, v18, v150
  v_mfma_f32_16x16x32_bf16 v[96:99], a[172:175], v[196:199], v[96:99]
  ds_bpermute_b32 v151, v18, v151
  v_mfma_f32_16x16x32_bf16 v[76:79], a[172:175], v[192:195], v[76:79]
  s_waitcnt vmcnt(12)
  ds_bpermute_b32 v152, v18, v152
  v_mfma_f32_16x16x32_bf16 v[80:83], a[176:179], v[192:195], v[80:83]
  v_mfma_f32_16x16x32_bf16 v[100:103], a[176:179], v[196:199], v[100:103]
  ds_bpermute_b32 v153, v18, v153
  v_mfma_f32_16x16x32_bf16 v[120:123], a[176:179], v[200:203], v[120:123]
  ds_read_b128 a[152:155], v11 offset:43008
  v_mfma_f32_16x16x32_bf16 v[140:143], a[176:179], v[204:207], v[140:143]
  ds_read_b128 a[156:159], v11 offset:44032
  s_waitcnt vmcnt(10)
  v_mfma_f32_16x16x32_bf16 v[84:87], a[180:183], v[212:215], v[84:87]
  s_mov_b32 s0, 327680
  buffer_load_dword v15, v16, s[12:15], s0 offen sc1
  v_mfma_f32_16x16x32_bf16 v[88:91], a[184:187], v[212:215], v[88:91]
  v_mfma_f32_16x16x32_bf16 v[92:95], a[188:191], v[212:215], v[92:95]
  s_waitcnt lgkmcnt(11)
  v_lshlrev_b32 v36, 16, v144
  v_and_b32 v37, 0xffff0000, v144
  v_mfma_f32_16x16x32_bf16 v[96:99], a[192:195], v[212:215], v[96:99]
  s_waitcnt lgkmcnt(10)
  v_lshlrev_b32 v38, 16, v145
  v_and_b32 v39, 0xffff0000, v145
  v_mfma_f32_16x16x32_bf16 v[100:103], a[196:199], v[212:215], v[100:103]
  s_waitcnt vmcnt(7)
  v_mfma_f32_16x16x32_bf16 v[84:87], a[200:203], v[228:231], v[84:87]
  v_add_f32 v64, v64, v36
  v_add_f32 v65, v65, v37
  v_mfma_f32_16x16x32_bf16 v[88:91], a[204:207], v[228:231], v[88:91]
  v_add_f32 v66, v66, v38
  v_add_f32 v67, v67, v39
  v_mfma_f32_16x16x32_bf16 v[92:95], a[208:211], v[228:231], v[92:95]
  s_waitcnt lgkmcnt(9)
  v_lshlrev_b32 v36, 16, v146
  v_and_b32 v37, 0xffff0000, v146
  v_mfma_f32_16x16x32_bf16 v[96:99], a[212:215], v[228:231], v[96:99]
  v_mfma_f32_16x16x32_bf16 v[100:103], a[216:219], v[228:231], v[100:103]
  s_waitcnt lgkmcnt(8)
  v_lshlrev_b32 v38, 16, v147
  v_and_b32 v39, 0xffff0000, v147
  s_waitcnt vmcnt(3)
  v_mfma_f32_16x16x32_bf16 v[84:87], a[220:223], v[244:247], v[84:87]
  v_add_f32 v68, v68, v36
  v_add_f32 v69, v69, v37
  v_mfma_f32_16x16x32_bf16 v[88:91], a[224:227], v[244:247], v[88:91]
  v_add_f32 v70, v70, v38
  v_add_f32 v71, v71, v39
  v_mfma_f32_16x16x32_bf16 v[92:95], a[228:231], v[244:247], v[92:95]
  v_mfma_f32_16x16x32_bf16 v[96:99], a[232:235], v[244:247], v[96:99]
  s_waitcnt lgkmcnt(7)
  v_lshlrev_b32 v36, 16, v148
  v_and_b32 v37, 0xffff0000, v148
  v_mfma_f32_16x16x32_bf16 v[100:103], a[236:239], v[244:247], v[100:103]
  s_waitcnt lgkmcnt(6)
  v_lshlrev_b32 v38, 16, v149
  v_and_b32 v39, 0xffff0000, v149
  v_mfma_f32_16x16x32_bf16 v[104:107], a[180:183], v[216:219], v[104:107]
  v_add_f32 v72, v72, v36
  v_add_f32 v73, v73, v37
  v_mfma_f32_16x16x32_bf16 v[108:111], a[184:187], v[216:219], v[108:111]
  v_mfma_f32_16x16x32_bf16 v[112:115], a[188:191], v[216:219], v[112:115]
  ds_write_b128 v6, v[84:87] offset:0
  v_mfma_f32_16x16x32_bf16 v[116:119], a[192:195], v[216:219], v[116:119]
  v_add_f32 v74, v74, v38
  v_add_f32 v75, v75, v39
  v_mfma_f32_16x16x32_bf16 v[120:123], a[196:199], v[216:219], v[120:123]
  ds_write_b128 v6, v[88:91] offset:1024
  v_mfma_f32_16x16x32_bf16 v[104:107], a[200:203], v[232:235], v[104:107]
  v_mfma_f32_16x16x32_bf16 v[108:111], a[204:207], v[232:235], v[108:111]
  ds_write_b128 v6, v[92:95] offset:2048
  v_mfma_f32_16x16x32_bf16 v[112:115], a[208:211], v[232:235], v[112:115]
  s_waitcnt lgkmcnt(8)
  v_lshlrev_b32 v36, 16, v150
  v_and_b32 v37, 0xffff0000, v150
  v_mfma_f32_16x16x32_bf16 v[116:119], a[212:215], v[232:235], v[116:119]
  ds_write_b128 v6, v[96:99] offset:3072
  v_mfma_f32_16x16x32_bf16 v[120:123], a[216:219], v[232:235], v[120:123]
  s_waitcnt vmcnt(2)
  v_mfma_f32_16x16x32_bf16 v[104:107], a[220:223], v[248:251], v[104:107]
  ds_write_b128 v6, v[100:103] offset:4096
  v_mfma_f32_16x16x32_bf16 v[108:111], a[224:227], v[248:251], v[108:111]
  s_waitcnt lgkmcnt(9)
  v_lshlrev_b32 v38, 16, v151
  v_and_b32 v39, 0xffff0000, v151
  v_mfma_f32_16x16x32_bf16 v[112:115], a[228:231], v[248:251], v[112:115]
  v_add_f32 v76, v76, v36
  v_add_f32 v77, v77, v37
  v_mfma_f32_16x16x32_bf16 v[116:119], a[232:235], v[248:251], v[116:119]
  v_mfma_f32_16x16x32_bf16 v[120:123], a[236:239], v[248:251], v[120:123]
  v_add_f32 v78, v78, v38
  v_add_f32 v79, v79, v39
  v_mfma_f32_16x16x32_bf16 v[124:127], a[180:183], v[220:223], v[124:127]
  s_waitcnt lgkmcnt(8)
  v_lshlrev_b32 v36, 16, v152
  v_and_b32 v37, 0xffff0000, v152
  v_mfma_f32_16x16x32_bf16 v[128:131], a[184:187], v[220:223], v[128:131]
  s_waitcnt vmcnt(0)
  v_subrev_u32 v15, s85, v15
  v_subrev_u32 v15, 7, v15
  v_cmp_gt_u32 vcc, 1, v15
  s_nop 0
  s_cmp_eq_u64 vcc, -1
  s_cbranch_scc0 L_slow7
L_back7:
  ds_write_b128 v7, v[104:107] offset:0
  v_mfma_f32_16x16x32_bf16 v[132:135], a[188:191], v[220:223], v[132:135]
  buffer_load_dwordx4 v[160:163], v1, s[36:39], s75 offen sc1
  s_add_u32 s75, s75, 4096
  v_mfma_f32_16x16x32_bf16 v[136:139], a[192:195], v[220:223], v[136:139]
  ds_write_b128 v7, v[108:111] offset:1024
  v_mfma_f32_16x16x32_bf16 v[140:143], a[196:199], v[220:223], v[140:143]
  buffer_load_dwordx4 v[164:167], v1, s[36:39], s75 offen sc1
  s_add_u32 s75, s75, 4096
  v_mfma_f32_16x16x32_bf16 v[124:127], a[200:203], v[236:239], v[124:127]
  ds_write_b128 v7, v[112:115] offset:2048
  v_mfma_f32_16x16x32_bf16 v[128:131], a[204:207], v[236:239], v[128:131]
  buffer_load_dwordx4 v[168:171], v1, s[36:39], s75 offen sc1
  s_add_u32 s75, s75, 4096
  v_mfma_f32_16x16x32_bf16 v[132:135], a[208:211], v[236:239], v[132:135]
  ds_write_b128 v7, v[116:119] offset:3072
  v_mfma_f32_16x16x32_bf16 v[136:139], a[212:215], v[236:239], v[136:139]
  buffer_load_dwordx4 v[172:175], v1, s[36:39], s75 offen sc1
  s_add_u32 s75, s75, 4096
  v_mfma_f32_16x16x32_bf16 v[140:143], a[216:219], v[236:239], v[140:143]
  ds_write_b128 v7, v[120:123] offset:4096
  v_mfma_f32_16x16x32_bf16 v[124:127], a[220:223], v[252:255], v[124:127]
  buffer_load_dwordx4 v[176:179], v1, s[36:39], s75 offen sc1
  s_add_u32 s75, s75, 4096
  v_mfma_f32_16x16x32_bf16 v[128:131], a[224:227], v[252:255], v[128:131]
  s_waitcnt lgkmcnt(12)
  v_lshlrev_b32 v38, 16, v153
  v_and_b32 v39, 0xffff0000, v153
  v_mfma_f32_16x16x32_bf16 v[132:135], a[228:231], v[252:255], v[132:135]
  buffer_load_dwordx4 v[180:183], v1, s[36:39], s75 offen sc1
  s_add_u32 s75, s75, 4096
  v_mfma_f32_16x16x32_bf16 v[136:139], a[232:235], v[252:255], v[136:139]
  v_add_f32 v80, v80, v36
  v_add_f32 v81, v81, v37
  v_mfma_f32_16x16x32_bf16 v[140:143], a[236:239], v[252:255], v[140:143]
  buffer_load_dwordx4 v[184:187], v1, s[36:39], s75 offen sc1
  s_add_u32 s75, s75, 4096
  v_add_f32 v82, v82, v38
  v_add_f32 v83, v83, v39
  v_mfma_f32_16x16x32_bf16 v[64:67], a[180:183], v[208:211], v[64:67]
  v_mfma_f32_16x16x32_bf16 v[68:71], a[184:187], v[208:211], v[68:71]
  buffer_load_dwordx4 v[188:191], v1, s[36:39], s75 offen sc1
  s_add_u32 s75, s75, 4096
  v_mfma_f32_16x16x32_bf16 v[72:75], a[188:191], v[208:211], v[72:75]
  ds_write_b128 v8, v[124:127] offset:0
  v_mfma_f32_16x16x32_bf16 v[76:79], a[192:195], v[208:211], v[76:79]
  buffer_load_dwordx4 v[20:23], v1, s[36:39], s75 offen sc1
  s_add_u32 s75, s75, 4096
  v_mfma_f32_16x16x32_bf16 v[80:83], a[196:199], v[208:211], v[80:83]
  ds_write_b128 v8, v[128:131] offset:1024
  v_mfma_f32_16x16x32_bf16 v[64:67], a[200:203], v[224:227], v[64:67]
  buffer_load_dwordx4 v[24:27], v1, s[36:39], s75 offen sc1
  s_add_u32 s75, s75, 4096
  v_mfma_f32_16x16x32_bf16 v[68:71], a[204:207], v[224:227], v[68:71]
  ds_write_b128 v8, v[132:135] offset:2048
  v_mfma_f32_16x16x32_bf16 v[72:75], a[208:211], v[224:227], v[72:75]
  buffer_load_dwordx4 v[28:31], v1, s[36:39], s75 offen sc1
  s_add_u32 s75, s75, 4096
  v_mfma_f32_16x16x32_bf16 v[76:79], a[212:215], v[224:227], v[76:79]
  ds_write_b128 v8, v[136:139] offset:3072
  v_mfma_f32_16x16x32_bf16 v[80:83], a[216:219], v[224:227], v[80:83]
  buffer_load_dwordx4 v[32:35], v1, s[36:39], s75 offen sc1
  s_add_u32 s75, s75, 4096
  v_mfma_f32_16x16x32_bf16 v[64:67], a[220:223], v[240:243], v[64:67]
  ds_write_b128 v8, v[140:143] offset:4096
  v_mfma_f32_16x16x32_bf16 v[68:71], a[224:227], v[240:243], v[68:71]
  buffer_load_dwordx4 v[48:51], v1, s[36:39], s75 offen sc1
  s_add_u32 s75, s75, 4096
  v_mfma_f32_16x16x32_bf16 v[72:75], a[228:231], v[240:243], v[72:75]
  v_mfma_f32_16x16x32_bf16 v[76:79], a[232:235], v[240:243], v[76:79]
  buffer_load_dwordx4 v[52:55], v1, s[36:39], s75 offen sc1
  s_add_u32 s75, s75, 4096
  v_mfma_f32_16x16x32_bf16 v[80:83], a[236:239], v[240:243], v[80:83]
  s_waitcnt vmcnt(13)
  v_mfma_f32_16x16x32_bf16 v[64:67], a[240:243], v[160:163], v[64:67]
  ds_read_b128 a[160:163], v11 offset:45056
  v_and_b32 v36, 15, v14
  v_mfma_f32_16x16x32_bf16 v[68:71], a[244:247], v[160:163], v[68:71]
  buffer_load_dwordx4 v[56:59], v1, s[36:39], s75 offen sc1
  s_add_u32 s75, s75, 4096
  v_mfma_f32_16x16x32_bf16 v[72:75], a[248:251], v[160:163], v[72:75]
  ds_read_b128 a[164:167], v11 offset:46080
  v_mul_u32_u24 v36, 160, v36
  v_mfma_f32_16x16x32_bf16 v[76:79], a[252:255], v[160:163], v[76:79]
  ds_read_b128 a[168:171], v11 offset:47104
  v_lshrrev_b32 v37, 4, v14
  v_mfma_f32_16x16x32_bf16 v[80:83], a[0:3], v[160:163], v[80:83]
  s_waitcnt vmcnt(13)
  ds_read_b128 a[172:175], v11 offset:48128
  v_mfma_f32_16x16x32_bf16 v[64:67], a[4:7], v[164:167], v[64:67]
  ds_read_b128 a[176:179], v11 offset:49152
  v_lshl_add_u32 v36, v37, 3, v36
  v_mfma_f32_16x16x32_bf16 v[68:71], a[8:11], v[164:167], v[68:71]
  buffer_load_dwordx4 v[60:63], v1, s[36:39], s75 offen sc1
  s_add_u32 s75, s75, 4096
  v_mfma_f32_16x16x32_bf16 v[72:75], a[12:15], v[164:167], v[72:75]
  v_sub_u32 v37, v9, v17
  v_add_u32 v19, v36, v37
  v_mfma_f32_16x16x32_bf16 v[76:79], a[16:19], v[164:167], v[76:79]
  v_add_u32 v36, 0, v14
  v_mul_u32_u24 v37, 6554, v36
  v_mfma_f32_16x16x32_bf16 v[80:83], a[20:23], v[164:167], v[80:83]
  s_waitcnt vmcnt(13)
  v_lshrrev_b32 v37, 16, v37
  v_mul_u32_u24 v37, 2400, v37
  v_mfma_f32_16x16x32_bf16 v[64:67], a[24:27], v[168:171], v[64:67]
  s_waitcnt lgkmcnt(0)
  s_barrier
  v_mfma_f32_16x16x32_bf16 v[68:71], a[28:31], v[168:171], v[68:71]
  buffer_load_dwordx2 v[192:193], v10, s[36:39], s75 offen offset:0 sc1
  buffer_load_dwordx2 v[194:195], v10, s[36:39], s75 offen offset:512 sc1
  s_add_u32 s75, s75, 4096
  v_mfma_f32_16x16x32_bf16 v[72:75], a[32:35], v[168:171], v[72:75]
  ds_read_b128 v[84:87], v9 offset:0
  v_lshl_add_u32 v40, v36, 4, v37
  v_mfma_f32_16x16x32_bf16 v[76:79], a[36:39], v[168:171], v[76:79]
  ds_read_b128 v[88:91], v9 offset:5120
  v_add_u32 v36, 64, v14
  v_mfma_f32_16x16x32_bf16 v[80:83], a[40:43], v[168:171], v[80:83]
  s_waitcnt vmcnt(14)
  ds_read_b128 v[92:95], v9 offset:10240
  v_mfma_f32_16x16x32_bf16 v[64:67], a[44:47], v[172:175], v[64:67]
  ds_read_b128 v[96:99], v9 offset:1024
  v_mul_u32_u24 v37, 6554, v36
  v_mfma_f32_16x16x32_bf16 v[68:71], a[48:51], v[172:175], v[68:71]
  buffer_load_dwordx2 v[196:197], v10, s[36:39], s75 offen offset:0 sc1
  buffer_load_dwordx2 v[198:199], v10, s[36:39], s75 offen offset:512 sc1
  s_add_u32 s75, s75, 4096
  v_mfma_f32_16x16x32_bf16 v[72:75], a[52:55], v[172:175], v[72:75]
  ds_read_b128 v[100:103], v9 offset:6144
  v_lshrrev_b32 v37, 16, v37
  v_mfma_f32_16x16x32_bf16 v[76:79], a[56:59], v[172:175], v[76:79]
  ds_read_b128 v[104:107], v9 offset:11264
  v_mul_u32_u24 v37, 2400, v37
  v_mfma_f32_16x16x32_bf16 v[80:83], a[60:63], v[172:175], v[80:83]
  s_waitcnt vmcnt(15)
  ds_read_b128 a[180:183], v11 offset:50176
  v_mfma_f32_16x16x32_bf16 v[64:67], a[64:67], v[176:179], v[64:67]
  ds_read_b128 v[108:111], v9 offset:2048
  v_lshl_add_u32 v41, v36, 4, v37
  v_mfma_f32_16x16x32_bf16 v[68:71], a[68:71], v[176:179], v[68:71]
  buffer_load_dwordx2 v[200:201], v10, s[36:39], s75 offen offset:0 sc1
  buffer_load_dwordx2 v[202:203], v10, s[36:39], s75 offen offset:512 sc1
  s_add_u32 s75, s75, 4096
  v_mfma_f32_16x16x32_bf16 v[72:75], a[72:75], v[176:179], v[72:75]
  ds_read_b128 v[112:115], v9 offset:7168
  v_add_u32 v36, 128, v14
  v_mfma_f32_16x16x32_bf16 v[76:79], a[76:79], v[176:179], v[76:79]
  ds_read_b128 a[184:187], v11 offset:51200
  v_mul_u32_u24 v37, 6554, v36
  v_mfma_f32_16x16x32_bf16 v[80:83], a[80:83], v[176:179], v[80:83]
  s_waitcnt vmcnt(16)
  ds_read_b128 v[116:119], v9 offset:12288
  v_mfma_f32_16x16x32_bf16 v[64:67], a[84:87], v[180:183], v[64:67]
  ds_read_b128 a[188:191], v11 offset:52224
  v_lshrrev_b32 v37, 16, v37
  v_mfma_f32_16x16x32_bf16 v[68:71], a[88:91], v[180:183], v[68:71]
  buffer_load_dwordx2 v[204:205], v10, s[36:39], s75 offen offset:0 sc1
  buffer_load_dwordx2 v[206:207], v10, s[36:39], s75 offen offset:512 sc1
  s_add_u32 s75, s75, 4096
  v_mfma_f32_16x16x32_bf16 v[72:75], a[92:95], v[180:183], v[72:75]
  ds_read_b128 a[192:195], v11 offset:53248
  v_mul_u32_u24 v37, 2400, v37
  v_mfma_f32_16x16x32_bf16 v[76:79], a[96:99], v[180:183], v[76:79]
  ds_read_b128 v[120:123], v9 offset:3072
  v_lshl_add_u32 v42, v36, 4, v37
  v_mfma_f32_16x16x32_bf16 v[80:83], a[100:103], v[180:183], v[80:83]
L_pad10:
  s_cbranch_execz L_padret
  s_waitcnt vmcnt(17)
  ds_read_b128 a[196:199], v11 offset:54272
  v_mfma_f32_16x16x32_bf16 v[64:67], a[104:107], v[184:187], v[64:67]
  ds_read_b128 v[124:127], v9 offset:8192
  v_lshrrev_b32 v36, 5, v14
  v_mfma_f32_16x16x32_bf16 v[68:71], a[108:111], v[184:187], v[68:71]
  ds_read_b128 a[200:203], v11 offset:55296
  v_lshl_add_u32 v42, v36, 30, v42
  v_mfma_f32_16x16x32_bf16 v[72:75], a[112:115], v[184:187], v[72:75]
  ds_read_b128 v[128:131], v9 offset:13312
  v_mfma_f32_16x16x32_bf16 v[76:79], a[116:119], v[184:187], v[76:79]
  ds_read_b128 a[204:207], v11 offset:56320
  v_mfma_f32_16x16x32_bf16 v[80:83], a[120:123], v[184:187], v[80:83]
  s_waitcnt vmcnt(16)
  ds_read_b128 v[132:135], v9 offset:4096
  v_mfma_f32_16x16x32_bf16 v[64:67], a[124:127], v[188:191], v[64:67]
  ds_read_b128 a[208:211], v11 offset:57344
  v_mfma_f32_16x16x32_bf16 v[68:71], a[128:131], v[188:191], v[68:71]
  ds_read_b128 v[136:139], v9 offset:9216
  v_mfma_f32_16x16x32_bf16 v[72:75], a[132:135], v[188:191], v[72:75]
  ds_read_b128 a[212:215], v11 offset:58368
  v_mfma_f32_16x16x32_bf16 v[76:79], a[136:139], v[188:191], v[76:79]
  ds_read_b128 v[140:143], v9 offset:14336
  v_mfma_f32_16x16x32_bf16 v[80:83], a[140:143], v[188:191], v[80:83]
  s_waitcnt vmcnt(15)
  ds_read_b128 a[216:219], v11 offset:59392
  v_mfma_f32_16x16x32_bf16 v[64:67], a[144:147], v[20:23], v[64:67]
  ds_read_b128 a[220:223], v11 offset:60416
  v_mfma_f32_16x16x32_bf16 v[68:71], a[148:151], v[20:23], v[68:71]
  ds_read_b128 a[224:227], v11 offset:61440
  v_mfma_f32_16x16x32_bf16 v[72:75], a[152:155], v[20:23], v[72:75]
  ds_read_b128 a[228:231], v11 offset:62464
  v_mfma_f32_16x16x32_bf16 v[76:79], a[156:159], v[20:23], v[76:79]
  ds_read_b128 a[232:235], v11 offset:63488
  v_mfma_f32_16x16x32_bf16 v[80:83], a[160:163], v[20:23], v[80:83]
  s_waitcnt vmcnt(14) lgkmcnt(15)
  ds_read_b128 a[236:239], v11 offset:64512
  v_mfma_f32_16x16x32_bf16 v[64:67], a[164:167], v[24:27], v[64:67]
  ds_read_b128 a[240:243], v12 offset:0
  v_add_f32 v88, v88, v92
  v_mfma_f32_16x16x32_bf16 v[68:71], a[168:171], v[24:27], v[68:71]
  ds_read_b128 a[244:247], v12 offset:1024
  v_add_f32 v89, v89, v93
  v_mfma_f32_16x16x32_bf16 v[72:75], a[172:175], v[24:27], v[72:75]
  ds_read_b128 a[248:251], v12 offset:2048
  v_add_f32 v90, v90, v94
  v_mfma_f32_16x16x32_bf16 v[76:79], a[176:179], v[24:27], v[76:79]
  ds_read_b128 a[252:255], v12 offset:3072
  v_add_f32 v91, v91, v95
  v_mfma_f32_16x16x32_bf16 v[80:83], a[180:183], v[24:27], v[80:83]
  s_waitcnt vmcnt(13) lgkmcnt(15)
  ds_read_b128 a[0:3], v12 offset:4096
  v_mfma_f32_16x16x32_bf16 v[64:67], a[184:187], v[28:31], v[64:67]
  ds_read_b128 a[4:7], v12 offset:5120
  v_add_f32 v84, v84, v88
  v_mfma_f32_16x16x32_bf16 v[68:71], a[188:191], v[28:31], v[68:71]
  ds_read_b128 a[8:11], v12 offset:6144
  v_add_f32 v85, v85, v89
  v_mfma_f32_16x16x32_bf16 v[72:75], a[192:195], v[28:31], v[72:75]
  ds_read_b128 a[12:15], v12 offset:7168
  v_add_f32 v86, v86, v90
  v_mfma_f32_16x16x32_bf16 v[76:79], a[196:199], v[28:31], v[76:79]
  ds_read_b128 a[16:19], v12 offset:8192
  v_add_f32 v87, v87, v91
  v_mfma_f32_16x16x32_bf16 v[80:83], a[200:203], v[28:31], v[80:83]
  s_waitcnt vmcnt(12) lgkmcnt(13)
  ds_read_b128 a[20:23], v12 offset:9216
  v_mfma_f32_16x16x32_bf16 v[64:67], a[204:207], v[32:35], v[64:67]
  ds_read_b128 a[24:27], v12 offset:10240
  v_add_f32 v100, v100, v104
  v_mfma_f32_16x16x32_bf16 v[68:71], a[208:211], v[32:35], v[68:71]
  ds_read_b128 a[28:31], v12 offset:11264
  v_add_f32 v101, v101, v105
  v_mfma_f32_16x16x32_bf16 v[72:75], a[212:215], v[32:35], v[72:75]
  ds_read_b128 a[32:35], v12 offset:12288
  v_add_f32 v102, v102, v106
  v_mfma_f32_16x16x32_bf16 v[76:79], a[216:219], v[32:35], v[76:79]
  ds_read_b128 a[36:39], v12 offset:13312
  v_add_f32 v103, v103, v107
  v_mfma_f32_16x16x32_bf16 v[80:83], a[220:223], v[32:35], v[80:83]
  s_waitcnt vmcnt(11) lgkmcnt(13)
  ds_read_b128 a[40:43], v12 offset:14336
  v_mfma_f32_16x16x32_bf16 v[64:67], a[224:227], v[48:51], v[64:67]
  ds_read_b128 a[44:47], v12 offset:15360
  v_add_f32 v96, v96, v100
  v_mfma_f32_16x16x32_bf16 v[68:71], a[228:231], v[48:51], v[68:71]
  ds_read_b128 a[48:51], v12 offset:16384
  v_add_f32 v97, v97, v101
  v_mfma_f32_16x16x32_bf16 v[72:75], a[232:235], v[48:51], v[72:75]
  ds_read_b128 a[52:55], v12 offset:17408
  v_add_f32 v98, v98, v102
  v_mfma_f32_16x16x32_bf16 v[76:79], a[236:239], v[48:51], v[76:79]
  ds_read_b128 a[56:59], v12 offset:18432
  v_add_f32 v99, v99, v103
  v_mfma_f32_16x16x32_bf16 v[80:83], a[240:243], v[48:51], v[80:83]
  s_waitcnt vmcnt(10) lgkmcnt(13)
  ds_read_b128 a[60:63], v12 offset:19456
  v_mfma_f32_16x16x32_bf16 v[64:67], a[244:247], v[52:55], v[64:67]
  ds_read_b128 a[64:67], v12 offset:20480
  v_add_f32 v112, v112, v116
  v_mfma_f32_16x16x32_bf16 v[68:71], a[248:251], v[52:55], v[68:71]
  ds_read_b128 a[68:71], v12 offset:21504
  v_add_f32 v113, v113, v117
  v_mfma_f32_16x16x32_bf16 v[72:75], a[252:255], v[52:55], v[72:75]
  ds_read_b128 a[72:75], v12 offset:22528
  v_add_f32 v114, v114, v118
  v_mfma_f32_16x16x32_bf16 v[76:79], a[0:3], v[52:55], v[76:79]
  ds_read_b128 a[76:79], v12 offset:23552
  v_add_f32 v115, v115, v119
  v_mfma_f32_16x16x32_bf16 v[80:83], a[4:7], v[52:55], v[80:83]
  s_waitcnt vmcnt(9) lgkmcnt(13)
  ds_read_b128 a[80:83], v12 offset:24576
  v_mfma_f32_16x16x32_bf16 v[64:67], a[8:11], v[56:59], v[64:67]
  ds_read_b128 a[84:87], v12 offset:25600
  v_add_f32 v108, v108, v112
  v_mfma_f32_16x16x32_bf16 v[68:71], a[12:15], v[56:59], v[68:71]
  ds_read_b128 a[88:91], v12 offset:26624
  v_add_f32 v109, v109, v113
  v_mfma_f32_16x16x32_bf16 v[72:75], a[16:19], v[56:59], v[72:75]
  ds_read_b128 a[92:95], v12 offset:27648
  v_add_f32 v110, v110, v114
  v_mfma_f32_16x16x32_bf16 v[76:79], a[20:23], v[56:59], v[76:79]
  ds_read_b128 a[96:99], v12 offset:28672
  v_add_f32 v111, v111, v115
  v_mfma_f32_16x16x32_bf16 v[80:83], a[24:27], v[56:59], v[80:83]
  s_waitcnt vmcnt(8) lgkmcnt(13)
  ds_read_b128 a[100:103], v12 offset:29696
  v_mfma_f32_16x16x32_bf16 v[64:67], a[28:31], v[60:63], v[64:67]
  ds_read_b128 a[104:107], v12 offset:30720
  v_add_f32 v124, v124, v128
  v_mfma_f32_16x16x32_bf16 v[68:71], a[32:35], v[60:63], v[68:71]
  ds_read_b128 a[108:111], v12 offset:31744
  v_add_f32 v125, v125, v129
  v_mfma_f32_16x16x32_bf16 v[72:75], a[36:39], v[60:63], v[72:75]
  ds_read_b128 a[112:115], v12 offset:32768
  v_add_f32 v126, v126, v130
  v_mfma_f32_16x16x32_bf16 v[76:79], a[40:43], v[60:63], v[76:79]
  ds_read_b128 a[116:119], v12 offset:33792
  v_add_f32 v127, v127, v131
  v_mfma_f32_16x16x32_bf16 v[80:83], a[44:47], v[60:63], v[80:83]
  s_waitcnt vmcnt(6) lgkmcnt(13)
  ds_read_b128 a[120:123], v12 offset:34816
  v_mfma_f32_16x16x32_bf16 v[64:67], a[48:51], v[192:195], v[64:67]
  ds_read_b128 a[124:127], v12 offset:35840
  v_add_f32 v120, v120, v124
  v_mfma_f32_16x16x32_bf16 v[68:71], a[52:55], v[192:195], v[68:71]
  v_add_f32 v121, v121, v125
  v_add_f32 v122, v122, v126
  v_mfma_f32_16x16x32_bf16 v[72:75], a[56:59], v[192:195], v[72:75]
  v_add_f32 v123, v123, v127
  v_add_f32 v136, v136, v140
  v_mfma_f32_16x16x32_bf16 v[76:79], a[60:63], v[192:195], v[76:79]
  v_add_f32 v137, v137, v141
  v_add_f32 v138, v138, v142
  v_mfma_f32_16x16x32_bf16 v[80:83], a[64:67], v[192:195], v[80:83]
  s_waitcnt vmcnt(4) lgkmcnt(10)
  v_add_f32 v139, v139, v143
  v_add_f32 v132, v132, v136
  v_mfma_f32_16x16x32_bf16 v[64:67], a[68:71], v[196:199], v[64:67]
  v_add_f32 v133, v133, v137
  v_add_f32 v134, v134, v138
  v_mfma_f32_16x16x32_bf16 v[68:71], a[72:75], v[196:199], v[68:71]
  v_add_f32 v135, v135, v139
  v_mfma_f32_16x16x32_bf16 v[72:75], a[76:79], v[196:199], v[72:75]
  v_mfma_f32_16x16x32_bf16 v[76:79], a[80:83], v[196:199], v[76:79]
  v_mfma_f32_16x16x32_bf16 v[80:83], a[84:87], v[196:199], v[80:83]
  s_waitcnt vmcnt(2) lgkmcnt(5)
  v_mfma_f32_16x16x32_bf16 v[64:67], a[88:91], v[200:203], v[64:67]
  v_mfma_f32_16x16x32_bf16 v[68:71], a[92:95], v[200:203], v[68:71]
  v_mfma_f32_16x16x32_bf16 v[72:75], a[96:99], v[200:203], v[72:75]
  v_mfma_f32_16x16x32_bf16 v[76:79], a[100:103], v[200:203], v[76:79]
  v_mfma_f32_16x16x32_bf16 v[80:83], a[104:107], v[200:203], v[80:83]
  s_waitcnt vmcnt(0) lgkmcnt(0)
  v_mfma_f32_16x16x32_bf16 v[64:67], a[108:111], v[204:207], v[64:67]
  v_mfma_f32_16x16x32_bf16 v[68:71], a[112:115], v[204:207], v[68:71]
  v_mfma_f32_16x16x32_bf16 v[72:75], a[116:119], v[204:207], v[72:75]
  v_mfma_f32_16x16x32_bf16 v[76:79], a[120:123], v[204:207], v[76:79]
  v_mfma_f32_16x16x32_bf16 v[80:83], a[124:127], v[204:207], v[80:83]
  s_nop 3
  v_pk_add_f32 v[64:65], v[64:65], v[84:85]
  v_pk_add_f32 v[66:67], v[66:67], v[86:87]
  v_cvt_pk_bf16_f32 v64, v64, v65
  v_cvt_pk_bf16_f32 v65, v66, v67
  ds_write_b64 v19, v[64:65] offset:0
  v_pk_add_f32 v[68:69], v[68:69], v[96:97]
  v_pk_add_f32 v[70:71], v[70:71], v[98:99]
  v_cvt_pk_bf16_f32 v68, v68, v69
  v_cvt_pk_bf16_f32 v69, v70, v71
  ds_write_b64 v19, v[68:69] offset:32
  v_pk_add_f32 v[72:73], v[72:73], v[108:109]
  v_pk_add_f32 v[74:75], v[74:75], v[110:111]
  v_cvt_pk_bf16_f32 v72, v72, v73
  v_cvt_pk_bf16_f32 v73, v74, v75
  ds_write_b64 v19, v[72:73] offset:64
  v_pk_add_f32 v[76:77], v[76:77], v[120:121]
  v_pk_add_f32 v[78:79], v[78:79], v[122:123]
  v_cvt_pk_bf16_f32 v76, v76, v77
  v_cvt_pk_bf16_f32 v77, v78, v79
  ds_write_b64 v19, v[76:77] offset:96
  v_pk_add_f32 v[80:81], v[80:81], v[132:133]
  v_pk_add_f32 v[82:83], v[82:83], v[134:135]
  v_cvt_pk_bf16_f32 v80, v80, v81
  v_cvt_pk_bf16_f32 v81, v82, v83
  ds_write_b64 v19, v[80:81] offset:128
  ds_read_b128 v[84:87], v9 offset:0
  ds_read_b128 v[88:91], v9 offset:1024
  ds_read_b128 v[92:95], v9 offset:2048
  s_waitcnt lgkmcnt(2)
  buffer_store_dwordx4 v[84:87], v40, s[20:23], s70 offen nt
  s_waitcnt lgkmcnt(1)
  buffer_store_dwordx4 v[88:91], v41, s[20:23], s70 offen nt
  s_waitcnt lgkmcnt(0)
  buffer_store_dwordx4 v[92:95], v42, s[20:23], s70 offen nt
L_end:
  s_endpgm
L_fallback:
  v_mov_b32 v44, 0xf149f2ca
  v_mov_b32 v45, 0xf149f2ca
  ds_read_b64 v[108:109], v120 offset:0
  ds_read_b64 v[110:111], v120 offset:4128
  ds_read_b64 v[112:113], v121 offset:0
  s_waitcnt lgkmcnt(1)
  v_mfma_f32_32x32x16_bf16 v[64:79], v[108:111], v[96:99], v[128:143]
  s_waitcnt lgkmcnt(0)
  v_mfma_f32_32x32x8_bf16 v[64:79], v[112:113], v[100:101], v[64:79]
  s_nop 11
  v_max3_f32 v44, v64, v65, v44
  v_max3_f32 v44, v66, v67, v44
  v_max3_f32 v44, v68, v69, v44
  v_max3_f32 v44, v70, v71, v44
  v_max3_f32 v44, v72, v73, v44
  v_max3_f32 v44, v74, v75, v44
  v_max3_f32 v44, v76, v77, v44
  v_max3_f32 v44, v78, v79, v44
  ds_read_b64 v[114:115], v120 offset:256
  ds_read_b64 v[116:117], v120 offset:4384
  ds_read_b64 v[118:119], v121 offset:256
  s_waitcnt lgkmcnt(1)
  v_mfma_f32_32x32x16_bf16 v[80:95], v[114:117], v[96:99], 0
  s_waitcnt lgkmcnt(0)
  v_mfma_f32_32x32x8_bf16 v[80:95], v[118:119], v[100:101], v[80:95]
  s_nop 11
  v_max3_f32 v44, v80, v81, v44
  v_max3_f32 v44, v82, v83, v44
  v_max3_f32 v44, v84, v85, v44
  v_max3_f32 v44, v86, v87, v44
  v_max3_f32 v44, v88, v89, v44
  v_max3_f32 v44, v90, v91, v44
  v_max3_f32 v44, v92, v93, v44
  v_max3_f32 v44, v94, v95, v44
  v_mfma_f32_32x32x16_bf16 v[64:79], v[114:117], v[102:105], v[128:143]
  v_mfma_f32_32x32x8_bf16 v[64:79], v[118:119], v[106:107], v[64:79]
  s_nop 11
  v_max3_f32 v45, v64, v65, v45
  v_max3_f32 v45, v66, v67, v45
  v_max3_f32 v45, v68, v69, v45
  v_max3_f32 v45, v70, v71, v45
  v_max3_f32 v45, v72, v73, v45
  v_max3_f32 v45, v74, v75, v45
  v_max3_f32 v45, v76, v77, v45
  v_max3_f32 v45, v78, v79, v45
  ds_read_b64 v[108:109], v120 offset:512
  ds_read_b64 v[110:111], v120 offset:4640
  ds_read_b64 v[112:113], v121 offset:512
  s_waitcnt lgkmcnt(1)
  v_mfma_f32_32x32x16_bf16 v[80:95], v[108:111], v[96:99], 0
  s_waitcnt lgkmcnt(0)
  v_mfma_f32_32x32x8_bf16 v[80:95], v[112:113], v[100:101], v[80:95]
  s_nop 11
  v_max3_f32 v44, v80, v81, v44
  v_max3_f32 v44, v82, v83, v44
  v_max3_f32 v44, v84, v85, v44
  v_max3_f32 v44, v86, v87, v44
  v_max3_f32 v44, v88, v89, v44
  v_max3_f32 v44, v90, v91, v44
  v_max3_f32 v44, v92, v93, v44
  v_max3_f32 v44, v94, v95, v44
  v_mfma_f32_32x32x16_bf16 v[64:79], v[108:111], v[102:105], 0
  v_mfma_f32_32x32x8_bf16 v[64:79], v[112:113], v[106:107], v[64:79]
  s_nop 11
  v_max3_f32 v45, v64, v65, v45
  v_max3_f32 v45, v66, v67, v45
  v_max3_f32 v45, v68, v69, v45
  v_max3_f32 v45, v70, v71, v45
  v_max3_f32 v45, v72, v73, v45
  v_max3_f32 v45, v74, v75, v45
  v_max3_f32 v45, v76, v77, v45
  v_max3_f32 v45, v78, v79, v45
  ds_read_b64 v[114:115], v120 offset:768
  ds_read_b64 v[116:117], v120 offset:4896
  ds_read_b64 v[118:119], v121 offset:768
  s_waitcnt lgkmcnt(1)
  v_mfma_f32_32x32x16_bf16 v[80:95], v[114:117], v[96:99], 0
  s_waitcnt lgkmcnt(0)
  v_mfma_f32_32x32x8_bf16 v[80:95], v[118:119], v[100:101], v[80:95]
  s_nop 11
  v_max3_f32 v44, v80, v81, v44
  v_max3_f32 v44, v82, v83, v44
  v_max3_f32 v44, v84, v85, v44
  v_max3_f32 v44, v86, v87, v44
  v_max3_f32 v44, v88, v89, v44
  v_max3_f32 v44, v90, v91, v44
  v_max3_f32 v44, v92, v93, v44
  v_max3_f32 v44, v94, v95, v44
  v_mfma_f32_32x32x16_bf16 v[64:79], v[114:117], v[102:105], 0
  v_mfma_f32_32x32x8_bf16 v[64:79], v[118:119], v[106:107], v[64:79]
  s_nop 11
  v_max3_f32 v45, v64, v65, v45
  v_max3_f32 v45, v66, v67, v45
  v_max3_f32 v45, v68, v69, v45
  v_max3_f32 v45, v70, v71, v45
  v_max3_f32 v45, v72, v73, v45
  v_max3_f32 v45, v74, v75, v45
  v_max3_f32 v45, v76, v77, v45
  v_max3_f32 v45, v78, v79, v45
  ds_read_b64 v[108:109], v120 offset:1024
  ds_read_b64 v[110:111], v120 offset:5152
  ds_read_b64 v[112:113], v121 offset:1024
  s_waitcnt lgkmcnt(1)
  v_mfma_f32_32x32x16_bf16 v[80:95], v[108:111], v[96:99], 0
  s_waitcnt lgkmcnt(0)
  v_mfma_f32_32x32x8_bf16 v[80:95], v[112:113], v[100:101], v[80:95]
  s_nop 11
  v_max3_f32 v44, v80, v81, v44
  v_max3_f32 v44, v82, v83, v44
  v_max3_f32 v44, v84, v85, v44
  v_max3_f32 v44, v86, v87, v44
  v_max3_f32 v44, v88, v89, v44
  v_max3_f32 v44, v90, v91, v44
  v_max3_f32 v44, v92, v93, v44
  v_max3_f32 v44, v94, v95, v44
  v_mfma_f32_32x32x16_bf16 v[64:79], v[108:111], v[102:105], 0
  v_mfma_f32_32x32x8_bf16 v[64:79], v[112:113], v[106:107], v[64:79]
  s_nop 11
  v_max3_f32 v45, v64, v65, v45
  v_max3_f32 v45, v66, v67, v45
  v_max3_f32 v45, v68, v69, v45
  v_max3_f32 v45, v70, v71, v45
  v_max3_f32 v45, v72, v73, v45
  v_max3_f32 v45, v74, v75, v45
  v_max3_f32 v45, v76, v77, v45
  v_max3_f32 v45, v78, v79, v45
  ds_read_b64 v[114:115], v120 offset:1280
  ds_read_b64 v[116:117], v120 offset:5408
  ds_read_b64 v[118:119], v121 offset:1280
  s_waitcnt lgkmcnt(1)
  v_mfma_f32_32x32x16_bf16 v[80:95], v[114:117], v[96:99], 0
  s_waitcnt lgkmcnt(0)
  v_mfma_f32_32x32x8_bf16 v[80:95], v[118:119], v[100:101], v[80:95]
  s_nop 11
  v_max3_f32 v44, v80, v81, v44
  v_max3_f32 v44, v82, v83, v44
  v_max3_f32 v44, v84, v85, v44
  v_max3_f32 v44, v86, v87, v44
  v_max3_f32 v44, v88, v89, v44
  v_max3_f32 v44, v90, v91, v44
  v_max3_f32 v44, v92, v93, v44
  v_max3_f32 v44, v94, v95, v44
  v_mfma_f32_32x32x16_bf16 v[64:79], v[114:117], v[102:105], 0
  v_mfma_f32_32x32x8_bf16 v[64:79], v[118:119], v[106:107], v[64:79]
  s_nop 11
  v_max3_f32 v45, v64, v65, v45
  v_max3_f32 v45, v66, v67, v45
  v_max3_f32 v45, v68, v69, v45
  v_max3_f32 v45, v70, v71, v45
  v_max3_f32 v45, v72, v73, v45
  v_max3_f32 v45, v74, v75, v45
  v_max3_f32 v45, v76, v77, v45
  v_max3_f32 v45, v78, v79, v45
  ds_read_b64 v[108:109], v120 offset:1536
  ds_read_b64 v[110:111], v120 offset:5664
  ds_read_b64 v[112:113], v121 offset:1536
  s_waitcnt lgkmcnt(1)
  v_mfma_f32_32x32x16_bf16 v[80:95], v[108:111], v[96:99], 0
  s_waitcnt lgkmcnt(0)
  v_mfma_f32_32x32x8_bf16 v[80:95], v[112:113], v[100:101], v[80:95]
  s_nop 11
  v_max3_f32 v44, v80, v81, v44
  v_max3_f32 v44, v82, v83, v44
  v_max3_f32 v44, v84, v85, v44
  v_max3_f32 v44, v86, v87, v44
  v_max3_f32 v44, v88, v89, v44
  v_max3_f32 v44, v90, v91, v44
  v_max3_f32 v44, v92, v93, v44
  v_max3_f32 v44, v94, v95, v44
  v_mfma_f32_32x32x16_bf16 v[64:79], v[108:111], v[102:105], 0
  v_mfma_f32_32x32x8_bf16 v[64:79], v[112:113], v[106:107], v[64:79]
  s_nop 11
  v_max3_f32 v45, v64, v65, v45
  v_max3_f32 v45, v66, v67, v45
  v_max3_f32 v45, v68, v69, v45
  v_max3_f32 v45, v70, v71, v45
  v_max3_f32 v45, v72, v73, v45
  v_max3_f32 v45, v74, v75, v45
  v_max3_f32 v45, v76, v77, v45
  v_max3_f32 v45, v78, v79, v45
  ds_read_b64 v[114:115], v120 offset:1792
  ds_read_b64 v[116:117], v120 offset:5920
  ds_read_b64 v[118:119], v121 offset:1792
  s_waitcnt lgkmcnt(1)
  v_mfma_f32_32x32x16_bf16 v[80:95], v[114:117], v[96:99], 0
  s_waitcnt lgkmcnt(0)
  v_mfma_f32_32x32x8_bf16 v[80:95], v[118:119], v[100:101], v[80:95]
  s_nop 11
  v_max3_f32 v44, v80, v81, v44
  v_max3_f32 v44, v82, v83, v44
  v_max3_f32 v44, v84, v85, v44
  v_max3_f32 v44, v86, v87, v44
  v_max3_f32 v44, v88, v89, v44
  v_max3_f32 v44, v90, v91, v44
  v_max3_f32 v44, v92, v93, v44
  v_max3_f32 v44, v94, v95, v44
  v_mfma_f32_32x32x16_bf16 v[64:79], v[114:117], v[102:105], 0
  v_mfma_f32_32x32x8_bf16 v[64:79], v[118:119], v[106:107], v[64:79]
  s_nop 11
  v_max3_f32 v45, v64, v65, v45
  v_max3_f32 v45, v66, v67, v45
  v_max3_f32 v45, v68, v69, v45
  v_max3_f32 v45, v70, v71, v45
  v_max3_f32 v45, v72, v73, v45
  v_max3_f32 v45, v74, v75, v45
  v_max3_f32 v45, v76, v77, v45
  v_max3_f32 v45, v78, v79, v45
  ds_read_b64 v[108:109], v120 offset:2048
  ds_read_b64 v[110:111], v120 offset:6176
  ds_read_b64 v[112:113], v121 offset:2048
  s_waitcnt lgkmcnt(1)
  v_mfma_f32_32x32x16_bf16 v[80:95], v[108:111], v[96:99], v[144:159]
  s_waitcnt lgkmcnt(0)
  v_mfma_f32_32x32x8_bf16 v[80:95], v[112:113], v[100:101], v[80:95]
  s_nop 11
  v_max3_f32 v44, v80, v81, v44
  v_max3_f32 v44, v82, v83, v44
  v_max3_f32 v44, v84, v85, v44
  v_max3_f32 v44, v86, v87, v44
  v_max3_f32 v44, v88, v89, v44
  v_max3_f32 v44, v90, v91, v44
  v_max3_f32 v44, v92, v93, v44
  v_max3_f32 v44, v94, v95, v44
  v_mfma_f32_32x32x16_bf16 v[64:79], v[108:111], v[102:105], 0
  v_mfma_f32_32x32x8_bf16 v[64:79], v[112:113], v[106:107], v[64:79]
  s_nop 11
  v_max3_f32 v45, v64, v65, v45
  v_max3_f32 v45, v66, v67, v45
  v_max3_f32 v45, v68, v69, v45
  v_max3_f32 v45, v70, v71, v45
  v_max3_f32 v45, v72, v73, v45
  v_max3_f32 v45, v74, v75, v45
  v_max3_f32 v45, v76, v77, v45
  v_max3_f32 v45, v78, v79, v45
  ds_read_b64 v[114:115], v120 offset:2304
  ds_read_b64 v[116:117], v120 offset:6432
  ds_read_b64 v[118:119], v121 offset:2304
  s_waitcnt lgkmcnt(1)
  v_mfma_f32_32x32x16_bf16 v[80:95], v[114:117], v[102:105], v[144:159]
  s_waitcnt lgkmcnt(0)
  v_mfma_f32_32x32x8_bf16 v[80:95], v[118:119], v[106:107], v[80:95]
  s_nop 11
  v_max3_f32 v45, v80, v81, v45
  v_max3_f32 v45, v82, v83, v45
  v_max3_f32 v45, v84, v85, v45
  v_max3_f32 v45, v86, v87, v45
  v_max3_f32 v45, v88, v89, v45
  v_max3_f32 v45, v90, v91, v45
  v_max3_f32 v45, v92, v93, v45
  v_max3_f32 v45, v94, v95, v45
  v_mov_b32 v48, v44
  s_nop 1
  v_permlane32_swap_b32 v48, v44
  v_max_f32 v44, v48, v44
  v_sub_f32 v44, 0, v44
  v_and_b32 v48, 0xffff0000, v44
  v_sub_f32 v49, v44, v48
  v_and_b32 v50, 0xffff0000, v49
  v_sub_f32 v49, v49, v50
  v_and_b32 v49, 0xffff0000, v49
  v_lshrrev_b32 v50, 16, v50
  s_mov_b32 exec_lo, 0
  v_or_b32 v100, 0x3f80, v48
  v_or_b32 v101, v50, v49
  s_mov_b32 exec_lo, -1
  v_mov_b32 v48, v45
  s_nop 1
  v_permlane32_swap_b32 v48, v45
  v_max_f32 v45, v48, v45
  v_sub_f32 v45, 0, v45
  v_and_b32 v48, 0xffff0000, v45
  v_sub_f32 v49, v45, v48
  v_and_b32 v50, 0xffff0000, v49
  v_sub_f32 v49, v49, v50
  v_and_b32 v49, 0xffff0000, v49
  v_lshrrev_b32 v50, 16, v50
  s_mov_b32 exec_lo, 0
  v_or_b32 v106, 0x3f80, v48
  v_or_b32 v107, v50, v49
  s_mov_b32 exec_lo, -1
  ds_read_b64 v[108:109], v120 offset:0
  ds_read_b64 v[110:111], v120 offset:4128
  ds_read_b64 v[112:113], v121 offset:0
  ds_read_b64 v[114:115], v120 offset:256
  ds_read_b64 v[116:117], v120 offset:4384
  ds_read_b64 v[118:119], v121 offset:256
  ds_read_b64_tr_b16 v[20:21], v122 offset:0
  ds_read_b64_tr_b16 v[22:23], v122 offset:64
  ds_read_b64_tr_b16 v[24:25], v122 offset:128
  ds_read_b64_tr_b16 v[26:27], v122 offset:192
  s_waitcnt lgkmcnt(8)
  v_mfma_f32_32x32x16_bf16 v[64:79], v[108:111], v[96:99], v[128:143]
  s_waitcnt lgkmcnt(7)
  v_mfma_f32_32x32x8_bf16 v[64:79], v[112:113], v[100:101], v[64:79]
  s_waitcnt lgkmcnt(5)
  v_mfma_f32_32x32x16_bf16 v[80:95], v[114:117], v[96:99], 0
  ds_read_b64_tr_b16 v[28:29], v122 offset:256
  ds_read_b64_tr_b16 v[30:31], v122 offset:320
  ds_read_b64_tr_b16 v[32:33], v122 offset:384
  ds_read_b64_tr_b16 v[34:35], v122 offset:448
  s_nop 5
  v_exp_f32 v64, v64
  v_exp_f32 v65, v65
  v_exp_f32 v66, v66
  v_exp_f32 v67, v67
  s_waitcnt lgkmcnt(8)
  v_mfma_f32_32x32x8_bf16 v[80:95], v[118:119], v[100:101], v[80:95]
  v_exp_f32 v68, v68
  v_exp_f32 v69, v69
  v_exp_f32 v70, v70
  v_exp_f32 v71, v71
  v_cvt_pk_bf16_f32 v48, v64, v65
  v_cvt_pk_bf16_f32 v49, v66, v67
  v_exp_f32 v72, v72
  v_exp_f32 v73, v73
  v_exp_f32 v74, v74
  v_exp_f32 v75, v75
  v_cvt_pk_bf16_f32 v50, v68, v69
  v_cvt_pk_bf16_f32 v51, v70, v71
  v_exp_f32 v76, v76
  v_exp_f32 v77, v77
  v_exp_f32 v78, v78
  v_exp_f32 v79, v79
  v_cvt_pk_bf16_f32 v52, v72, v73
  v_cvt_pk_bf16_f32 v53, v74, v75
  v_cvt_pk_bf16_f32 v54, v76, v77
  v_cvt_pk_bf16_f32 v55, v78, v79
  v_mfma_f32_32x32x16_bf16 v[64:79], v[114:117], v[102:105], v[128:143]
  v_exp_f32 v80, v80
  v_exp_f32 v81, v81
  v_exp_f32 v82, v82
  v_exp_f32 v83, v83
  v_mfma_f32_32x32x8_bf16 v[64:79], v[118:119], v[106:107], v[64:79]
  v_exp_f32 v84, v84
  v_exp_f32 v85, v85
  v_exp_f32 v86, v86
  v_exp_f32 v87, v87
  v_cvt_pk_bf16_f32 v56, v80, v81
  v_cvt_pk_bf16_f32 v57, v82, v83
  s_waitcnt lgkmcnt(6)
  v_mfma_f32_32x32x16_bf16 v[160:175], v[20:23], v[48:51], 0
  ds_read_b64 v[108:109], v120 offset:512
  ds_read_b64 v[110:111], v120 offset:4640
  ds_read_b64 v[112:113], v121 offset:512
  v_exp_f32 v88, v88
  v_exp_f32 v89, v89
  v_exp_f32 v90, v90
  v_exp_f32 v91, v91
  v_cvt_pk_bf16_f32 v58, v84, v85
  v_cvt_pk_bf16_f32 v59, v86, v87
  s_waitcnt lgkmcnt(7)
  v_mfma_f32_32x32x16_bf16 v[160:175], v[24:27], v[52:55], v[160:175]
  v_exp_f32 v92, v92
  v_exp_f32 v93, v93
  v_exp_f32 v94, v94
  v_exp_f32 v95, v95
  v_cvt_pk_bf16_f32 v60, v88, v89
  v_cvt_pk_bf16_f32 v61, v90, v91
  v_cvt_pk_bf16_f32 v62, v92, v93
  v_cvt_pk_bf16_f32 v63, v94, v95
  s_waitcnt lgkmcnt(1)
  v_mfma_f32_32x32x16_bf16 v[80:95], v[108:111], v[96:99], 0
  ds_read_b64_tr_b16 v[36:37], v122 offset:512
  ds_read_b64_tr_b16 v[38:39], v122 offset:576
  ds_read_b64_tr_b16 v[40:41], v122 offset:640
  ds_read_b64_tr_b16 v[42:43], v122 offset:704
  v_exp_f32 v64, v64
  v_exp_f32 v65, v65
  v_exp_f32 v66, v66
  v_exp_f32 v67, v67
  s_waitcnt lgkmcnt(4)
  v_mfma_f32_32x32x8_bf16 v[80:95], v[112:113], v[100:101], v[80:95]
  v_exp_f32 v68, v68
  v_exp_f32 v69, v69
  v_exp_f32 v70, v70
  v_exp_f32 v71, v71
  v_cvt_pk_bf16_f32 v48, v64, v65
  v_cvt_pk_bf16_f32 v49, v66, v67
  v_mfma_f32_32x32x16_bf16 v[160:175], v[28:31], v[56:59], v[160:175]
  v_exp_f32 v72, v72
  v_exp_f32 v73, v73
  v_exp_f32 v74, v74
  v_exp_f32 v75, v75
  v_cvt_pk_bf16_f32 v50, v68, v69
  v_cvt_pk_bf16_f32 v51, v70, v71
  v_mfma_f32_32x32x16_bf16 v[160:175], v[32:35], v[60:63], v[160:175]
  v_exp_f32 v76, v76
  v_exp_f32 v77, v77
  v_exp_f32 v78, v78
  v_exp_f32 v79, v79
  v_cvt_pk_bf16_f32 v52, v72, v73
  v_cvt_pk_bf16_f32 v53, v74, v75
  v_cvt_pk_bf16_f32 v54, v76, v77
  v_cvt_pk_bf16_f32 v55, v78, v79
  v_mfma_f32_32x32x16_bf16 v[64:79], v[108:111], v[102:105], 0
  v_exp_f32 v80, v80
  v_exp_f32 v81, v81
  v_exp_f32 v82, v82
  v_exp_f32 v83, v83
  v_mfma_f32_32x32x8_bf16 v[64:79], v[112:113], v[106:107], v[64:79]
  v_exp_f32 v84, v84
  v_exp_f32 v85, v85
  v_exp_f32 v86, v86
  v_exp_f32 v87, v87
  v_cvt_pk_bf16_f32 v56, v80, v81
  v_cvt_pk_bf16_f32 v57, v82, v83
  v_mfma_f32_32x32x16_bf16 v[176:191], v[28:31], v[48:51], 0
  ds_read_b64 v[114:115], v120 offset:768
  ds_read_b64 v[116:117], v120 offset:4896
  ds_read_b64 v[118:119], v121 offset:768
  v_exp_f32 v88, v88
  v_exp_f32 v89, v89
  v_exp_f32 v90, v90
  v_exp_f32 v91, v91
  v_cvt_pk_bf16_f32 v58, v84, v85
  v_cvt_pk_bf16_f32 v59, v86, v87
  v_mfma_f32_32x32x16_bf16 v[176:191], v[32:35], v[52:55], v[176:191]
  v_exp_f32 v92, v92
  v_exp_f32 v93, v93
  v_exp_f32 v94, v94
  v_exp_f32 v95, v95
  v_cvt_pk_bf16_f32 v60, v88, v89
  v_cvt_pk_bf16_f32 v61, v90, v91
  v_cvt_pk_bf16_f32 v62, v92, v93
  v_cvt_pk_bf16_f32 v63, v94, v95
  s_waitcnt lgkmcnt(1)
  v_mfma_f32_32x32x16_bf16 v[80:95], v[114:117], v[96:99], 0
  ds_read_b64_tr_b16 v[20:21], v122 offset:768
  ds_read_b64_tr_b16 v[22:23], v122 offset:832
  ds_read_b64_tr_b16 v[24:25], v122 offset:896
  ds_read_b64_tr_b16 v[26:27], v122 offset:960
  v_exp_f32 v64, v64
  v_exp_f32 v65, v65
  v_exp_f32 v66, v66
  v_exp_f32 v67, v67
  s_waitcnt lgkmcnt(4)
  v_mfma_f32_32x32x8_bf16 v[80:95], v[118:119], v[100:101], v[80:95]
  v_exp_f32 v68, v68
  v_exp_f32 v69, v69
  v_exp_f32 v70, v70
  v_exp_f32 v71, v71
  v_cvt_pk_bf16_f32 v48, v64, v65
  v_cvt_pk_bf16_f32 v49, v66, v67
  v_mfma_f32_32x32x16_bf16 v[160:175], v[36:39], v[56:59], v[160:175]
  v_exp_f32 v72, v72
  v_exp_f32 v73, v73
  v_exp_f32 v74, v74
  v_exp_f32 v75, v75
  v_cvt_pk_bf16_f32 v50, v68, v69
  v_cvt_pk_bf16_f32 v51, v70, v71
  v_mfma_f32_32x32x16_bf16 v[160:175], v[40:43], v[60:63], v[160:175]
  v_exp_f32 v76, v76
  v_exp_f32 v77, v77
  v_exp_f32 v78, v78
  v_exp_f32 v79, v79
  v_cvt_pk_bf16_f32 v52, v72, v73
  v_cvt_pk_bf16_f32 v53, v74, v75
  v_cvt_pk_bf16_f32 v54, v76, v77
  v_cvt_pk_bf16_f32 v55, v78, v79
  v_mfma_f32_32x32x16_bf16 v[64:79], v[114:117], v[102:105], 0
  v_exp_f32 v80, v80
  v_exp_f32 v81, v81
  v_exp_f32 v82, v82
  v_exp_f32 v83, v83
  v_mfma_f32_32x32x8_bf16 v[64:79], v[118:119], v[106:107], v[64:79]
  v_exp_f32 v84, v84
  v_exp_f32 v85, v85
  v_exp_f32 v86, v86
  v_exp_f32 v87, v87
  v_cvt_pk_bf16_f32 v56, v80, v81
  v_cvt_pk_bf16_f32 v57, v82, v83
  v_mfma_f32_32x32x16_bf16 v[176:191], v[36:39], v[48:51], v[176:191]
  ds_read_b64 v[108:109], v120 offset:1024
  ds_read_b64 v[110:111], v120 offset:5152
  ds_read_b64 v[112:113], v121 offset:1024
  v_exp_f32 v88, v88
  v_exp_f32 v89, v89
  v_exp_f32 v90, v90
  v_exp_f32 v91, v91
  v_cvt_pk_bf16_f32 v58, v84, v85
  v_cvt_pk_bf16_f32 v59, v86, v87
  v_mfma_f32_32x32x16_bf16 v[176:191], v[40:43], v[52:55], v[176:191]
  v_exp_f32 v92, v92
  v_exp_f32 v93, v93
  v_exp_f32 v94, v94
  v_exp_f32 v95, v95
  v_cvt_pk_bf16_f32 v60, v88, v89
  v_cvt_pk_bf16_f32 v61, v90, v91
  v_cvt_pk_bf16_f32 v62, v92, v93
  v_cvt_pk_bf16_f32 v63, v94, v95
  s_waitcnt lgkmcnt(1)
  v_mfma_f32_32x32x16_bf16 v[80:95], v[108:111], v[96:99], 0
  ds_read_b64_tr_b16 v[28:29], v122 offset:1024
  ds_read_b64_tr_b16 v[30:31], v122 offset:1088
  ds_read_b64_tr_b16 v[32:33], v122 offset:1152
  ds_read_b64_tr_b16 v[34:35], v122 offset:1216
  v_exp_f32 v64, v64
  v_exp_f32 v65, v65
  v_exp_f32 v66, v66
  v_exp_f32 v67, v67
  s_waitcnt lgkmcnt(4)
  v_mfma_f32_32x32x8_bf16 v[80:95], v[112:113], v[100:101], v[80:95]
  v_exp_f32 v68, v68
  v_exp_f32 v69, v69
  v_exp_f32 v70, v70
  v_exp_f32 v71, v71
  v_cvt_pk_bf16_f32 v48, v64, v65
  v_cvt_pk_bf16_f32 v49, v66, v67
  v_mfma_f32_32x32x16_bf16 v[160:175], v[20:23], v[56:59], v[160:175]
  v_exp_f32 v72, v72
  v_exp_f32 v73, v73
  v_exp_f32 v74, v74
  v_exp_f32 v75, v75
  v_cvt_pk_bf16_f32 v50, v68, v69
  v_cvt_pk_bf16_f32 v51, v70, v71
  v_mfma_f32_32x32x16_bf16 v[160:175], v[24:27], v[60:63], v[160:175]
  v_exp_f32 v76, v76
  v_exp_f32 v77, v77
  v_exp_f32 v78, v78
  v_exp_f32 v79, v79
  v_cvt_pk_bf16_f32 v52, v72, v73
  v_cvt_pk_bf16_f32 v53, v74, v75
  v_cvt_pk_bf16_f32 v54, v76, v77
  v_cvt_pk_bf16_f32 v55, v78, v79
  v_mfma_f32_32x32x16_bf16 v[64:79], v[108:111], v[102:105], 0
  v_exp_f32 v80, v80
  v_exp_f32 v81, v81
  v_exp_f32 v82, v82
  v_exp_f32 v83, v83
  v_mfma_f32_32x32x8_bf16 v[64:79], v[112:113], v[106:107], v[64:79]
  v_exp_f32 v84, v84
  v_exp_f32 v85, v85
  v_exp_f32 v86, v86
  v_exp_f32 v87, v87
  v_cvt_pk_bf16_f32 v56, v80, v81
  v_cvt_pk_bf16_f32 v57, v82, v83
  v_mfma_f32_32x32x16_bf16 v[176:191], v[20:23], v[48:51], v[176:191]
  ds_read_b64 v[114:115], v120 offset:1280
  ds_read_b64 v[116:117], v120 offset:5408
  ds_read_b64 v[118:119], v121 offset:1280
  v_exp_f32 v88, v88
  v_exp_f32 v89, v89
  v_exp_f32 v90, v90
  v_exp_f32 v91, v91
  v_cvt_pk_bf16_f32 v58, v84, v85
  v_cvt_pk_bf16_f32 v59, v86, v87
  v_mfma_f32_32x32x16_bf16 v[176:191], v[24:27], v[52:55], v[176:191]
  v_exp_f32 v92, v92
  v_exp_f32 v93, v93
  v_exp_f32 v94, v94
  v_exp_f32 v95, v95
  v_cvt_pk_bf16_f32 v60, v88, v89
  v_cvt_pk_bf16_f32 v61, v90, v91
  v_cvt_pk_bf16_f32 v62, v92, v93
  v_cvt_pk_bf16_f32 v63, v94, v95
  s_waitcnt lgkmcnt(1)
  v_mfma_f32_32x32x16_bf16 v[80:95], v[114:117], v[96:99], 0
  ds_read_b64_tr_b16 v[36:37], v122 offset:1280
  ds_read_b64_tr_b16 v[38:39], v122 offset:1344
  ds_read_b64_tr_b16 v[40:41], v122 offset:1408
  ds_read_b64_tr_b16 v[42:43], v122 offset:1472
  v_exp_f32 v64, v64
  v_exp_f32 v65, v65
  v_exp_f32 v66, v66
  v_exp_f32 v67, v67
  s_waitcnt lgkmcnt(4)
  v_mfma_f32_32x32x8_bf16 v[80:95], v[118:119], v[100:101], v[80:95]
  v_exp_f32 v68, v68
  v_exp_f32 v69, v69
  v_exp_f32 v70, v70
  v_exp_f32 v71, v71
  v_cvt_pk_bf16_f32 v48, v64, v65
  v_cvt_pk_bf16_f32 v49, v66, v67
  v_mfma_f32_32x32x16_bf16 v[160:175], v[28:31], v[56:59], v[160:175]
  v_exp_f32 v72, v72
  v_exp_f32 v73, v73
  v_exp_f32 v74, v74
  v_exp_f32 v75, v75
  v_cvt_pk_bf16_f32 v50, v68, v69
  v_cvt_pk_bf16_f32 v51, v70, v71
  v_mfma_f32_32x32x16_bf16 v[160:175], v[32:35], v[60:63], v[160:175]
  v_exp_f32 v76, v76
  v_exp_f32 v77, v77
  v_exp_f32 v78, v78
  v_exp_f32 v79, v79
  v_cvt_pk_bf16_f32 v52, v72, v73
  v_cvt_pk_bf16_f32 v53, v74, v75
  v_cvt_pk_bf16_f32 v54, v76, v77
  v_cvt_pk_bf16_f32 v55, v78, v79
  v_mfma_f32_32x32x16_bf16 v[64:79], v[114:117], v[102:105], 0
  v_exp_f32 v80, v80
  v_exp_f32 v81, v81
  v_exp_f32 v82, v82
  v_exp_f32 v83, v83
  v_mfma_f32_32x32x8_bf16 v[64:79], v[118:119], v[106:107], v[64:79]
  v_exp_f32 v84, v84
  v_exp_f32 v85, v85
  v_exp_f32 v86, v86
  v_exp_f32 v87, v87
  v_cvt_pk_bf16_f32 v56, v80, v81
  v_cvt_pk_bf16_f32 v57, v82, v83
  v_mfma_f32_32x32x16_bf16 v[176:191], v[28:31], v[48:51], v[176:191]
  ds_read_b64 v[108:109], v120 offset:1536
  ds_read_b64 v[110:111], v120 offset:5664
  ds_read_b64 v[112:113], v121 offset:1536
  v_exp_f32 v88, v88
  v_exp_f32 v89, v89
  v_exp_f32 v90, v90
  v_exp_f32 v91, v91
  v_cvt_pk_bf16_f32 v58, v84, v85
  v_cvt_pk_bf16_f32 v59, v86, v87
  v_mfma_f32_32x32x16_bf16 v[176:191], v[32:35], v[52:55], v[176:191]
  v_exp_f32 v92, v92
  v_exp_f32 v93, v93
  v_exp_f32 v94, v94
  v_exp_f32 v95, v95
  v_cvt_pk_bf16_f32 v60, v88, v89
  v_cvt_pk_bf16_f32 v61, v90, v91
  v_cvt_pk_bf16_f32 v62, v92, v93
  v_cvt_pk_bf16_f32 v63, v94, v95
  s_waitcnt lgkmcnt(1)
  v_mfma_f32_32x32x16_bf16 v[80:95], v[108:111], v[96:99], 0
  ds_read_b64_tr_b16 v[20:21], v122 offset:1536
  ds_read_b64_tr_b16 v[22:23], v122 offset:1600
  ds_read_b64_tr_b16 v[24:25], v122 offset:1664
  ds_read_b64_tr_b16 v[26:27], v122 offset:1728
  v_exp_f32 v64, v64
  v_exp_f32 v65, v65
  v_exp_f32 v66, v66
  v_exp_f32 v67, v67
  s_waitcnt lgkmcnt(4)
  v_mfma_f32_32x32x8_bf16 v[80:95], v[112:113], v[100:101], v[80:95]
  v_exp_f32 v68, v68
  v_exp_f32 v69, v69
  v_exp_f32 v70, v70
  v_exp_f32 v71, v71
  v_cvt_pk_bf16_f32 v48, v64, v65
  v_cvt_pk_bf16_f32 v49, v66, v67
  v_mfma_f32_32x32x16_bf16 v[160:175], v[36:39], v[56:59], v[160:175]
  v_exp_f32 v72, v72
  v_exp_f32 v73, v73
  v_exp_f32 v74, v74
  v_exp_f32 v75, v75
  v_cvt_pk_bf16_f32 v50, v68, v69
  v_cvt_pk_bf16_f32 v51, v70, v71
  v_mfma_f32_32x32x16_bf16 v[160:175], v[40:43], v[60:63], v[160:175]
  v_exp_f32 v76, v76
  v_exp_f32 v77, v77
  v_exp_f32 v78, v78
  v_exp_f32 v79, v79
  v_cvt_pk_bf16_f32 v52, v72, v73
  v_cvt_pk_bf16_f32 v53, v74, v75
  v_cvt_pk_bf16_f32 v54, v76, v77
  v_cvt_pk_bf16_f32 v55, v78, v79
  v_mfma_f32_32x32x16_bf16 v[64:79], v[108:111], v[102:105], 0
  v_exp_f32 v80, v80
  v_exp_f32 v81, v81
  v_exp_f32 v82, v82
  v_exp_f32 v83, v83
  v_mfma_f32_32x32x8_bf16 v[64:79], v[112:113], v[106:107], v[64:79]
  v_exp_f32 v84, v84
  v_exp_f32 v85, v85
  v_exp_f32 v86, v86
  v_exp_f32 v87, v87
  v_cvt_pk_bf16_f32 v56, v80, v81
  v_cvt_pk_bf16_f32 v57, v82, v83
  v_mfma_f32_32x32x16_bf16 v[176:191], v[36:39], v[48:51], v[176:191]
  ds_read_b64 v[114:115], v120 offset:1792
  ds_read_b64 v[116:117], v120 offset:5920
  ds_read_b64 v[118:119], v121 offset:1792
  v_exp_f32 v88, v88
  v_exp_f32 v89, v89
  v_exp_f32 v90, v90
  v_exp_f32 v91, v91
  v_cvt_pk_bf16_f32 v58, v84, v85
  v_cvt_pk_bf16_f32 v59, v86, v87
  v_mfma_f32_32x32x16_bf16 v[176:191], v[40:43], v[52:55], v[176:191]
  v_exp_f32 v92, v92
  v_exp_f32 v93, v93
  v_exp_f32 v94, v94
  v_exp_f32 v95, v95
  v_cvt_pk_bf16_f32 v60, v88, v89
  v_cvt_pk_bf16_f32 v61, v90, v91
  v_cvt_pk_bf16_f32 v62, v92, v93
  v_cvt_pk_bf16_f32 v63, v94, v95
  s_waitcnt lgkmcnt(1)
  v_mfma_f32_32x32x16_bf16 v[80:95], v[114:117], v[96:99], 0
  ds_read_b64_tr_b16 v[28:29], v122 offset:1792
  ds_read_b64_tr_b16 v[30:31], v122 offset:1856
  ds_read_b64_tr_b16 v[32:33], v122 offset:1920
  ds_read_b64_tr_b16 v[34:35], v122 offset:1984
  v_exp_f32 v64, v64
  v_exp_f32 v65, v65
  v_exp_f32 v66, v66
  v_exp_f32 v67, v67
  s_waitcnt lgkmcnt(4)
  v_mfma_f32_32x32x8_bf16 v[80:95], v[118:119], v[100:101], v[80:95]
  v_exp_f32 v68, v68
  v_exp_f32 v69, v69
  v_exp_f32 v70, v70
  v_exp_f32 v71, v71
  v_cvt_pk_bf16_f32 v48, v64, v65
  v_cvt_pk_bf16_f32 v49, v66, v67
  v_mfma_f32_32x32x16_bf16 v[160:175], v[20:23], v[56:59], v[160:175]
  v_exp_f32 v72, v72
  v_exp_f32 v73, v73
  v_exp_f32 v74, v74
  v_exp_f32 v75, v75
  v_cvt_pk_bf16_f32 v50, v68, v69
  v_cvt_pk_bf16_f32 v51, v70, v71
  v_mfma_f32_32x32x16_bf16 v[160:175], v[24:27], v[60:63], v[160:175]
  v_exp_f32 v76, v76
  v_exp_f32 v77, v77
  v_exp_f32 v78, v78
  v_exp_f32 v79, v79
  v_cvt_pk_bf16_f32 v52, v72, v73
  v_cvt_pk_bf16_f32 v53, v74, v75
  v_cvt_pk_bf16_f32 v54, v76, v77
  v_cvt_pk_bf16_f32 v55, v78, v79
  v_mfma_f32_32x32x16_bf16 v[64:79], v[114:117], v[102:105], 0
  v_exp_f32 v80, v80
  v_exp_f32 v81, v81
  v_exp_f32 v82, v82
  v_exp_f32 v83, v83
  v_mfma_f32_32x32x8_bf16 v[64:79], v[118:119], v[106:107], v[64:79]
  v_exp_f32 v84, v84
  v_exp_f32 v85, v85
  v_exp_f32 v86, v86
  v_exp_f32 v87, v87
  v_cvt_pk_bf16_f32 v56, v80, v81
  v_cvt_pk_bf16_f32 v57, v82, v83
  v_mfma_f32_32x32x16_bf16 v[176:191], v[20:23], v[48:51], v[176:191]
  ds_read_b64 v[108:109], v120 offset:2048
  ds_read_b64 v[110:111], v120 offset:6176
  ds_read_b64 v[112:113], v121 offset:2048
  v_exp_f32 v88, v88
  v_exp_f32 v89, v89
  v_exp_f32 v90, v90
  v_exp_f32 v91, v91
  v_cvt_pk_bf16_f32 v58, v84, v85
  v_cvt_pk_bf16_f32 v59, v86, v87
  v_mfma_f32_32x32x16_bf16 v[176:191], v[24:27], v[52:55], v[176:191]
  v_exp_f32 v92, v92
  v_exp_f32 v93, v93
  v_exp_f32 v94, v94
  v_exp_f32 v95, v95
  v_cvt_pk_bf16_f32 v60, v88, v89
  v_cvt_pk_bf16_f32 v61, v90, v91
  v_cvt_pk_bf16_f32 v62, v92, v93
  v_cvt_pk_bf16_f32 v63, v94, v95
  s_waitcnt lgkmcnt(1)
  v_mfma_f32_32x32x16_bf16 v[80:95], v[108:111], v[96:99], v[144:159]
  ds_read_b64_tr_b16 v[36:37], v122 offset:2048
  ds_read_b64_tr_b16 v[38:39], v122 offset:2112
  ds_read_b64_tr_b16 v[40:41], v122 offset:2176
  ds_read_b64_tr_b16 v[42:43], v122 offset:2240
  v_exp_f32 v64, v64
  v_exp_f32 v65, v65
  v_exp_f32 v66, v66
  v_exp_f32 v67, v67
  s_waitcnt lgkmcnt(4)
  v_mfma_f32_32x32x8_bf16 v[80:95], v[112:113], v[100:101], v[80:95]
  v_exp_f32 v68, v68
  v_exp_f32 v69, v69
  v_exp_f32 v70, v70
  v_exp_f32 v71, v71
  v_cvt_pk_bf16_f32 v48, v64, v65
  v_cvt_pk_bf16_f32 v49, v66, v67
  v_mfma_f32_32x32x16_bf16 v[160:175], v[28:31], v[56:59], v[160:175]
  v_exp_f32 v72, v72
  v_exp_f32 v73, v73
  v_exp_f32 v74, v74
  v_exp_f32 v75, v75
  v_cvt_pk_bf16_f32 v50, v68, v69
  v_cvt_pk_bf16_f32 v51, v70, v71
  v_mfma_f32_32x32x16_bf16 v[160:175], v[32:35], v[60:63], v[160:175]
  v_exp_f32 v76, v76
  v_exp_f32 v77, v77
  v_exp_f32 v78, v78
  v_exp_f32 v79, v79
  v_cvt_pk_bf16_f32 v52, v72, v73
  v_cvt_pk_bf16_f32 v53, v74, v75
  v_cvt_pk_bf16_f32 v54, v76, v77
  v_cvt_pk_bf16_f32 v55, v78, v79
  v_mfma_f32_32x32x16_bf16 v[64:79], v[108:111], v[102:105], 0
  v_exp_f32 v80, v80
  v_exp_f32 v81, v81
  v_exp_f32 v82, v82
  v_exp_f32 v83, v83
  v_mfma_f32_32x32x8_bf16 v[64:79], v[112:113], v[106:107], v[64:79]
  v_exp_f32 v84, v84
  v_exp_f32 v85, v85
  v_exp_f32 v86, v86
  v_exp_f32 v87, v87
  v_cvt_pk_bf16_f32 v56, v80, v81
  v_cvt_pk_bf16_f32 v57, v82, v83
  v_mfma_f32_32x32x16_bf16 v[176:191], v[28:31], v[48:51], v[176:191]
  ds_read_b64 v[114:115], v120 offset:2304
  ds_read_b64 v[116:117], v120 offset:6432
  ds_read_b64 v[118:119], v121 offset:2304
  v_exp_f32 v88, v88
  v_exp_f32 v89, v89
  v_exp_f32 v90, v90
  v_exp_f32 v91, v91
  v_cvt_pk_bf16_f32 v58, v84, v85
  v_cvt_pk_bf16_f32 v59, v86, v87
  v_mfma_f32_32x32x16_bf16 v[176:191], v[32:35], v[52:55], v[176:191]
  v_exp_f32 v92, v92
  v_exp_f32 v93, v93
  v_exp_f32 v94, v94
  v_exp_f32 v95, v95
  v_cvt_pk_bf16_f32 v60, v88, v89
  v_cvt_pk_bf16_f32 v61, v90, v91
  v_cvt_pk_bf16_f32 v62, v92, v93
  v_cvt_pk_bf16_f32 v63, v94, v95
  s_waitcnt lgkmcnt(1)
  v_mfma_f32_32x32x16_bf16 v[80:95], v[114:117], v[102:105], v[144:159]
  ds_read_b64_tr_b16 v[20:21], v122 offset:2304
  ds_read_b64_tr_b16 v[22:23], v122 offset:2368
  ds_read_b64_tr_b16 v[24:25], v122 offset:2432
  ds_read_b64_tr_b16 v[26:27], v122 offset:2496
  v_exp_f32 v64, v64
  v_exp_f32 v65, v65
  v_exp_f32 v66, v66
  v_exp_f32 v67, v67
  s_waitcnt lgkmcnt(4)
  v_mfma_f32_32x32x8_bf16 v[80:95], v[118:119], v[106:107], v[80:95]
  v_exp_f32 v68, v68
  v_exp_f32 v69, v69
  v_exp_f32 v70, v70
  v_exp_f32 v71, v71
  v_cvt_pk_bf16_f32 v48, v64, v65
  v_cvt_pk_bf16_f32 v49, v66, v67
  v_mfma_f32_32x32x16_bf16 v[160:175], v[36:39], v[56:59], v[160:175]
  v_exp_f32 v72, v72
  v_exp_f32 v73, v73
  v_exp_f32 v74, v74
  v_exp_f32 v75, v75
  v_cvt_pk_bf16_f32 v50, v68, v69
  v_cvt_pk_bf16_f32 v51, v70, v71
  v_mfma_f32_32x32x16_bf16 v[160:175], v[40:43], v[60:63], v[160:175]
  v_exp_f32 v76, v76
  v_exp_f32 v77, v77
  v_exp_f32 v78, v78
  v_exp_f32 v79, v79
  v_cvt_pk_bf16_f32 v52, v72, v73
  v_cvt_pk_bf16_f32 v53, v74, v75
  v_cvt_pk_bf16_f32 v54, v76, v77
  v_cvt_pk_bf16_f32 v55, v78, v79
  v_exp_f32 v80, v80
  v_exp_f32 v81, v81
  v_exp_f32 v82, v82
  v_exp_f32 v83, v83
  v_exp_f32 v84, v84
  v_exp_f32 v85, v85
  v_exp_f32 v86, v86
  v_exp_f32 v87, v87
  v_cvt_pk_bf16_f32 v56, v80, v81
  v_cvt_pk_bf16_f32 v57, v82, v83
  v_mfma_f32_32x32x16_bf16 v[176:191], v[36:39], v[48:51], v[176:191]
  v_exp_f32 v88, v88
  v_exp_f32 v89, v89
  v_exp_f32 v90, v90
  v_exp_f32 v91, v91
  v_cvt_pk_bf16_f32 v58, v84, v85
  v_cvt_pk_bf16_f32 v59, v86, v87
  v_mfma_f32_32x32x16_bf16 v[176:191], v[40:43], v[52:55], v[176:191]
  v_exp_f32 v92, v92
  v_exp_f32 v93, v93
  v_exp_f32 v94, v94
  v_exp_f32 v95, v95
  v_cvt_pk_bf16_f32 v60, v88, v89
  v_cvt_pk_bf16_f32 v61, v90, v91
  v_cvt_pk_bf16_f32 v62, v92, v93
  v_cvt_pk_bf16_f32 v63, v94, v95
  s_waitcnt lgkmcnt(2)
  v_mfma_f32_32x32x16_bf16 v[176:191], v[20:23], v[56:59], v[176:191]
  s_waitcnt lgkmcnt(0)
  v_mfma_f32_32x32x16_bf16 v[176:191], v[24:27], v[60:63], v[176:191]
  s_nop 15
  s_branch L_fin
L_slow0:
  s_mov_b32 s86, 0
L_spin0:
  buffer_load_dword v15, v68, s[36:39], 0 offen sc1
  s_add_u32 s86, s86, 1
  s_cmp_gt_u32 s86, 0x40000
  s_cbranch_scc1 L_end
  s_waitcnt vmcnt(0)
  v_cmp_ne_u32 vcc, 0, v15
  s_nop 0
  s_cmp_eq_u64 vcc, -1
  s_cbranch_scc1 L_back0
  s_sleep 1
  s_branch L_spin0
L_slow1:
  s_mov_b32 s86, 0
L_spin1:
  buffer_load_dword v15, v68, s[36:39], 0 offen sc1
  s_add_u32 s86, s86, 1
  s_cmp_gt_u32 s86, 0x40000
  s_cbranch_scc1 L_end
  s_waitcnt vmcnt(0)
  v_cmp_ne_u32 vcc, 0, v15
  s_nop 0
  s_cmp_eq_u64 vcc, -1
  s_cbranch_scc1 L_back1
  s_sleep 1
  s_branch L_spin1
L_slow2:
  s_mov_b32 s86, 0
L_spin2:
  buffer_load_dword v15, v16, s[12:15], s0 offen sc1
  s_add_u32 s86, s86, 1
  s_cmp_gt_u32 s86, 0x40000
  s_cbranch_scc1 L_end
  s_waitcnt vmcnt(0)
  v_subrev_u32 v15, s85, v15
  v_subrev_u32 v15, 2, v15
  v_cmp_gt_u32 vcc, 6, v15
  s_nop 0
  s_cmp_eq_u64 vcc, -1
  s_cbranch_scc1 L_back2
  s_sleep 1
  s_branch L_spin2
L_slow3:
  s_mov_b32 s86, 0
L_spin3:
  buffer_load_dword v15, v16, s[12:15], s0 offen sc1
  s_add_u32 s86, s86, 1
  s_cmp_gt_u32 s86, 0x40000
  s_cbranch_scc1 L_end
  s_waitcnt vmcnt(0)
  v_subrev_u32 v15, s85, v15
  v_subrev_u32 v15, 2, v15
  v_cmp_gt_u32 vcc, 6, v15
  s_nop 0
  s_cmp_eq_u64 vcc, -1
  s_cbranch_scc1 L_back3
  s_sleep 1
  s_branch L_spin3
L_slow4:
  s_mov_b32 s86, 0
L_spin4:
  buffer_load_dword v15, v16, s[12:15], s0 offen sc1
  s_add_u32 s86, s86, 1
  s_cmp_gt_u32 s86, 0x40000
  s_cbranch_scc1 L_end
  s_waitcnt vmcnt(0)
  v_subrev_u32 v15, s85, v15
  v_subrev_u32 v15, 4, v15
  v_cmp_gt_u32 vcc, 4, v15
  s_nop 0
  s_cmp_eq_u64 vcc, -1
  s_cbranch_scc1 L_back4
  s_sleep 1
  s_branch L_spin4
L_slow5:
  s_mov_b32 s86, 0
L_spin5:
  buffer_load_dword v15, v16, s[12:15], s0 offen sc1
  s_add_u32 s86, s86, 1
  s_cmp_gt_u32 s86, 0x40000
  s_cbranch_scc1 L_end
  s_waitcnt vmcnt(0)
  v_subrev_u32 v15, s85, v15
  v_subrev_u32 v15, 5, v15
  v_cmp_gt_u32 vcc, 3, v15
  s_nop 0
  s_cmp_eq_u64 vcc, -1
  s_cbranch_scc1 L_back5
  s_sleep 1
  s_branch L_spin5
L_slow6:
  s_mov_b32 s86, 0
L_spin6:
  buffer_load_dword v15, v16, s[12:15], s0 offen sc1
  s_add_u32 s86, s86, 1
  s_cmp_gt_u32 s86, 0x40000
  s_cbranch_scc1 L_end
  s_waitcnt vmcnt(0)
  v_subrev_u32 v15, s85, v15
  v_subrev_u32 v15, 6, v15
  v_cmp_gt_u32 vcc, 2, v15
  s_nop 0
  s_cmp_eq_u64 vcc, -1
  s_cbranch_scc1 L_back6
  s_sleep 1
  s_branch L_spin6
L_slow7:
  s_mov_b32 s86, 0
L_spin7:
  buffer_load_dword v15, v16, s[12:15], s0 offen sc1
  s_add_u32 s86, s86, 1
  s_cmp_gt_u32 s86, 0x40000
  s_cbranch_scc1 L_end
  s_waitcnt vmcnt(0)
  v_subrev_u32 v15, s85, v15
  v_subrev_u32 v15, 7, v15
  v_cmp_gt_u32 vcc, 1, v15
  s_nop 0
  s_cmp_eq_u64 vcc, -1
  s_cbranch_scc1 L_back7
  s_sleep 1
  s_branch L_spin7

.section .rodata,"a"
.p2align 6
.amdhsa_kernel parallel_sum__sliding_block__glu_gated_geglu__prompt_kernel
  .amdhsa_next_free_vgpr 512
  .amdhsa_next_free_sgpr 102
  .amdhsa_accum_offset 256
  .amdhsa_group_segment_fixed_size 0
  .amdhsa_kernarg_size 80
  .amdhsa_user_sgpr_count 2
  .amdhsa_user_sgpr_kernarg_segment_ptr 1
  .amdhsa_system_sgpr_workgroup_id_x 1
.end_amdhsa_kernel
```
